```python
import torch

def _softmax(x, axis=-1):
    return torch.softmax(x, dim=axis)
def _gelu(x):
    return torch.nn.functional.gelu(x, approximate="tanh")
def _silu(x):
    return torch.nn.functional.silu(x)
def _sigmoid(x):
    return torch.sigmoid(x)
def _layernorm(x, axis=-1, eps=1e-5):
    m = x.mean(dim=axis, keepdim=True)
    v = x.var(dim=axis, keepdim=True, unbiased=False)
    return (x - m) / torch.sqrt(v + eps)
def _scatter_add(tgt, idx, src, axis=0):
    return tgt.clone().index_add_(axis, idx, src)
def _segment_sum(src, seg, n):
    out = torch.zeros((n,) + src.shape[1:], dtype=src.dtype)
    return out.index_add_(0, seg, src)
def _pad(x, pw):
    flat = tuple(v for pair in reversed(pw) for v in pair)
    return torch.nn.functional.pad(x, flat)

kernel_name = 'concat_heads__gqa_block_cached__mha_block_cached__near_ridge'

def setup_inputs():

    _w = (lambda a: (lambda t: t.to(torch.bfloat16) if t.is_floating_point() else t)(torch.as_tensor(a)))
    def _A_setup():
        B, Sq, D = 8, 144, 512
        Hq, Hkv, Sk, Dh = 32, 32, 512, 128
        assert Hq % Hkv == 0, (Hq, Hkv)
        return {
            "x": _w((lambda *s: torch.randn(*s, dtype=torch.bfloat16) * 0.8)(B, Sq, D)),
            "k_cache": _w((lambda *s: torch.randn(*s, dtype=torch.bfloat16) * 0.8)(B, Hkv, Sk, Dh)),
            "v_cache": _w((lambda *s: torch.randn(*s, dtype=torch.bfloat16) * 0.05)(B, Hkv, Sk, Dh)),
            "wq": _w((lambda *s: torch.randn(*s, dtype=torch.bfloat16) * 0.8)(D, Hq * Dh) * (D ** -0.5)),
            "wo": _w((lambda *s: torch.randn(*s, dtype=torch.bfloat16) * 0.05)(Hq * Dh, D) * ((Hq * Dh) ** -0.5)),
        }
    _A_in = _A_setup()

    def _B_setup():
        B, Sq, D = 8, 144, 512
        H, Sk, Dh = 32, 512, 128
        return {
            "x": _w((lambda *s: torch.randn(*s, dtype=torch.bfloat16) * 0.8)(B, Sq, D)),
            "k_cache": _w((lambda *s: torch.randn(*s, dtype=torch.bfloat16) * 0.8)(B, H, Sk, Dh)),
            "v_cache": _w((lambda *s: torch.randn(*s, dtype=torch.bfloat16) * 0.05)(B, H, Sk, Dh)),
            "wq": _w((lambda *s: torch.randn(*s, dtype=torch.bfloat16) * 0.8)(D, H * Dh) * (D ** -0.5)),
            "wo": _w((lambda *s: torch.randn(*s, dtype=torch.bfloat16) * 0.05)(H * Dh, D) * ((H * Dh) ** -0.5)),
        }
    _B_in = _B_setup()

    return {
        "A_x": _A_in["x"],
        "A_k_cache": _A_in["k_cache"],
        "A_v_cache": _A_in["v_cache"],
        "A_wq": _A_in["wq"],
        "A_wo": _A_in["wo"],
        "B_x": _B_in["x"],
        "B_k_cache": _B_in["k_cache"],
        "B_v_cache": _B_in["v_cache"],
        "B_wq": _B_in["wq"],
        "B_wo": _B_in["wo"],
    }

def reference(A_x, A_k_cache, A_v_cache, A_wq, A_wo, B_x, B_k_cache, B_v_cache, B_wq, B_wo):
    def _A_ref(x, k_cache, v_cache, wq, wo):
        B, Sq, D = x.shape
        Hq, Dh = 32, 128
        Hkv = k_cache.shape[1]
        rep = Hq // Hkv
        q = (lambda x, *d: x.permute(*d))((x @ wq).reshape(B, Sq, Hq, Dh), 0, 2, 1, 3)
        k = (lambda x, n, axis: torch.repeat_interleave(x, n, dim=axis))(k_cache, rep, axis=1)
        v = (lambda x, n, axis: torch.repeat_interleave(x, n, dim=axis))(v_cache, rep, axis=1)
        scores = torch.einsum("bhqd,bhkd->bhqk", q, k) * (Dh ** -0.5)
        p = _softmax(scores, axis=-1)
        o = torch.einsum("bhqk,bhkd->bhqd", p, v)
        return (lambda x, *d: x.permute(*d))(o, 0, 2, 1, 3).reshape(B, Sq, Hq * Dh) @ wo

    def _B_ref(x, k_cache, v_cache, wq, wo):
        B, Sq, D = x.shape
        H, Dh = 32, 128
        q = (lambda x, *d: x.permute(*d))((x @ wq).reshape(B, Sq, H, Dh), 0, 2, 1, 3)
        scores = torch.einsum("bhqd,bhkd->bhqk", q, k_cache) * (Dh ** -0.5)
        p = _softmax(scores, axis=-1)
        o = torch.einsum("bhqk,bhkd->bhqd", p, v_cache)
        return (lambda x, *d: x.permute(*d))(o, 0, 2, 1, 3).reshape(B, Sq, H * Dh) @ wo

    a = _A_ref(A_x, A_k_cache, A_v_cache, A_wq, A_wo)
    b = _B_ref(B_x, B_k_cache, B_v_cache, B_wq, B_wo)
    return torch.concatenate([a, b], axis=-1)
```

```asm
; @launch grid=(256,1,1) block=(256,1,1) lds=163840
.amdgcn_target "amdgcn-amd-amdhsa--gfx950"
.text
.globl concat_heads__gqa_block_cached__mha_block_cached__near_ridge_kernel
.p2align 8
.type concat_heads__gqa_block_cached__mha_block_cached__near_ridge_kernel,@function
concat_heads__gqa_block_cached__mha_block_cached__near_ridge_kernel:
  s_cmp_ge_u32 s2, 256
  s_cbranch_scc1 L_main_end
  s_load_dwordx8 s[68:75], s[0:1], 0
  s_load_dwordx2 s[76:77], s[0:1], 32
  s_load_dwordx8 s[80:87], s[0:1], 40
  s_load_dwordx2 s[88:89], s[0:1], 72
  s_load_dwordx2 s[58:59], s[0:1], 96
  s_load_dwordx4 s[96:99], s[0:1], 80
  s_and_b32 s50, s2, 7
  s_lshr_b32 s51, s2, 3
  s_lshr_b32 s56, s50, 2
  s_and_b32 s52, s50, 3
  s_lshl_b32 s52, s52, 2
  s_and_b32 s53, s51, 3
  s_add_u32 s54, s52, s53
  s_lshr_b32 s55, s51, 2
  s_lshl_b32 s52, s56, 3
  s_add_u32 s57, s52, s55
  v_lshrrev_b32 v46, 6, v0
  v_and_b32 v1, 63, v0
  s_nop 0
  v_readfirstlane_b32 s28, v46
  s_nop 3
  s_lshr_b32 s29, s28, 1
  s_and_b32 s30, s28, 1
  s_mov_b32 s61, 0
  v_lshrrev_b32 v46, 4, v1
  v_bfe_u32 v47, v1, 2, 2
  v_and_b32 v48, 3, v1
  v_and_b32 v49, 15, v1
  v_lshrrev_b32 v50, 5, v1
  v_bfe_u32 v51, v1, 4, 1
  v_lshlrev_b32 v7, 2, v50
  v_xor_b32 v7, v7, v49
  v_lshlrev_b32 v7, 4, v7
  v_lshl_add_u32 v7, v51, 8, v7
  v_lshl_add_u32 v7, v50, 13, v7
  v_xor_b32 v8, 0x80, v7
  v_add_u32 v8, 15360, v8
  v_add_u32 v9, 30720, v7
  v_add_u32 v10, 30720, v8
  v_lshlrev_b32 v50, 1, v46
  v_mov_b32 v51, 0x78
  v_lshrrev_b32 v50, v50, v51
  v_and_b32 v50, 3, v50
  v_xor_b32 v50, v50, v48
  v_lshlrev_b32 v50, 4, v50
  v_lshrrev_b32 v51, 2, v1
  v_lshl_add_u32 v50, v51, 10, v50
  v_add_u32 v11, 0, v50
  v_add_u32 v12, 15360, v50
  s_lshl_b32 s50, s28, 1
  s_lshr_b32 s50, 0x78, s50
  s_and_b32 s50, s50, 3
  v_xor_b32 v50, s50, v48
  v_lshlrev_b32 v50, 4, v50
  v_lshl_add_u32 v50, v51, 10, v50
  s_lshl_b32 s50, s28, 12
  s_lshl_b32 s51, s28, 15
  s_sub_u32 s50, s50, s51
  s_add_u32 s50, s50, 131072
  v_add_u32 v13, s50, v50
  s_waitcnt lgkmcnt(0)
  s_cmp_eq_u32 s56, 1
  s_cselect_b32 s68, s80, s68
  s_cselect_b32 s69, s81, s69
  s_cselect_b32 s74, s86, s74
  s_cselect_b32 s75, s87, s75
  s_mul_i32 s50, s55, 147456
  s_add_u32 s4, s68, s50
  s_addc_u32 s5, s69, 0
  s_and_b32 s5, s5, 0xffff
  s_mov_b32 s6, 147456
  s_mov_b32 s7, 0x20000
  s_lshl_b32 s50, s54, 9
  s_add_u32 s8, s74, s50
  s_addc_u32 s9, s75, 0
  s_and_b32 s9, s9, 0xffff
  s_sub_u32 s10, 4194304, s50
  s_mov_b32 s11, 0x20000
L_phase_q:
  s_lshr_b32 s50, s2, 3
  s_and_b32 s51, s50, 3
  s_lshr_b32 s50, s50, 2
  s_lshl_b32 s51, s51, 2
  s_lshl_b32 s50, s50, 1
  s_add_u32 s52, s50, s51
  s_and_b32 s52, s52, 15
  s_lshl_b32 s50, s52, 6
  s_lshl_b32 s51, s28, 15
  s_add_u32 s32, s50, s51
  s_lshl_b32 s50, s52, 18
  s_lshl_b32 s51, s28, 16
  s_add_u32 s33, s50, s51
  s_lshl_b32 s50, s28, 12
  s_add_u32 s41, s50, 16384
  s_lshl_b32 s50, s28, 11
  s_add_u32 s42, s50, 114688
  s_lshl_b32 s50, s28, 8
  s_add_u32 s38, s50, 122880
  s_add_u32 m0, s41, 0
  s_nop 0
  buffer_load_dwordx4 v7, s[8:11], s33 offen lds
  buffer_load_dwordx4 v8, s[8:11], s33 offen offset:1024 lds
  buffer_load_dwordx4 v9, s[8:11], s33 offen offset:2048 lds
  buffer_load_dwordx4 v10, s[8:11], s33 offen offset:3072 lds
  s_add_u32 m0, s42, 0
  s_nop 0
  buffer_load_dwordx4 v11, s[4:7], s32 offen lds
  buffer_load_dwordx4 v12, s[4:7], s32 offen offset:1024 lds
  s_add_u32 m0, s38, 0
  s_nop 0
  s_mov_b64 exec, 0xffff
  buffer_load_dwordx4 v13, s[4:7], s32 offen lds
  s_mov_b64 exec, -1
  s_add_u32 s33, s33, 262144
  s_and_b32 s33, s33, 0x3fffff
  s_add_u32 s32, s32, 64
  s_and_b32 s32, s32, 0xfffffbff
  s_cmp_eq_u32 s61, 1
  s_cbranch_scc1 L_setup_b_done
  s_cmp_eq_u32 s56, 1
  s_cselect_b32 s70, s82, s70
  s_cselect_b32 s71, s83, s71
  s_cselect_b32 s72, s84, s72
  s_cselect_b32 s73, s85, s73
  s_cselect_b32 s76, s88, s76
  s_cselect_b32 s77, s89, s77
  s_lshl_b32 s50, s55, 5
  s_lshl_b32 s51, s54, 1
  s_add_u32 s50, s50, s51
  s_add_u32 s50, s50, s29
  s_lshl_b32 s50, s50, 17
  s_add_u32 s12, s70, s50
  s_addc_u32 s13, s71, 0
  s_and_b32 s13, s13, 0xffff
  s_mov_b32 s14, 131072
  s_mov_b32 s15, 0x20000
  s_add_u32 s16, s72, s50
  s_addc_u32 s17, s73, 0
  s_and_b32 s17, s17, 0xffff
  s_mov_b32 s18, 131072
  s_mov_b32 s19, 0x20000
  s_lshl_b32 s50, s54, 18
  s_lshl_b32 s51, s28, 8
  s_add_u32 s50, s50, s51
  s_sub_u32 s52, 262144, s51
  s_add_u32 s20, s76, s50
  s_addc_u32 s21, s77, 0
  s_and_b32 s21, s21, 0xffff
  s_mov_b32 s22, s52
  s_mov_b32 s23, 0x20000
  s_lshl_b32 s50, s54, 18
  s_add_u32 s84, s76, s50
  s_addc_u32 s85, s77, 0
  s_and_b32 s85, s85, 0xffff
  s_mov_b32 s86, 262144
  s_mov_b32 s87, 0x20000
  s_mul_i32 s50, s57, 2359296
  s_add_u32 s50, s50, 0x0
  s_add_u32 s24, s58, s50
  s_addc_u32 s25, s59, 0
  s_and_b32 s25, s25, 0xffff
  s_mov_b32 s26, 2359296
  s_mov_b32 s27, 0x20000
  s_mul_i32 s50, s57, 4608
  s_add_u32 s50, s50, 0x2440000
  s_add_u32 s68, s58, s50
  s_addc_u32 s69, s59, 0
  s_and_b32 s69, s69, 0xffff
  s_mov_b32 s70, 4608
  s_mov_b32 s71, 0x20000
  s_mov_b32 s72, s98
  s_and_b32 s73, s99, 0xffff
  s_mov_b32 s74, 256
  s_mov_b32 s75, 0x20000
  s_mov_b32 s80, s96
  s_and_b32 s81, s97, 0xffff
  s_mov_b32 s82, 2359296
  s_mov_b32 s83, 0x20000
  s_lshl_b32 s50, s28, 7
  s_lshl_b32 s51, s54, 2
  s_add_u32 s50, s50, s51
  v_lshlrev_b32 v46, 9, v1
  v_add_u32 v46, s50, v46
  v_mov_b32 v47, 0
  buffer_store_dword v47, v46, s[68:71], 0 offen sc1
L_setup_b_done:
  s_lshl_b32 s39, s55, 15
  s_lshl_b32 s43, s30, 12
  s_lshl_b32 s50, s29, 13
  s_add_u32 s50, s50, s43
  s_add_u32 s47, s50, 65536
  s_add_u32 s48, s50, 0
  v_lshrrev_b32 v46, 4, v1
  v_bfe_u32 v47, v1, 2, 2
  v_and_b32 v48, 3, v1
  v_and_b32 v49, 15, v1
  v_add_u32 v50, 0, v46
  v_xor_b32 v50, v50, v49
  v_lshlrev_b32 v50, 4, v50
  v_lshl_add_u32 v16, v46, 8, v50
  v_add_u32 v50, 4, v46
  v_xor_b32 v50, v50, v49
  v_lshlrev_b32 v50, 4, v50
  v_lshl_add_u32 v17, v46, 8, v50
  v_add_u32 v50, 8, v46
  v_xor_b32 v50, v50, v49
  v_lshlrev_b32 v50, 4, v50
  v_lshl_add_u32 v18, v46, 8, v50
  v_add_u32 v50, 12, v46
  v_xor_b32 v50, v50, v49
  v_lshlrev_b32 v50, 4, v50
  v_lshl_add_u32 v19, v46, 8, v50
  v_add_u32 v50, 0, v46
  v_lshlrev_b32 v50, 1, v50
  v_xor_b32 v50, v50, v49
  v_lshlrev_b32 v50, 4, v50
  v_lshl_add_u32 v20, v46, 8, v50
  v_add_u32 v50, 4, v46
  v_lshlrev_b32 v50, 1, v50
  v_xor_b32 v50, v50, v49
  v_lshlrev_b32 v50, 4, v50
  v_lshl_add_u32 v21, v46, 8, v50
  v_lshl_add_u32 v50, v46, 3, v47
  v_lshlrev_b32 v50, 9, v50
  v_lshl_add_u32 v50, v48, 4, v50
  s_lshl_b32 s50, s29, 8
  s_add_u32 s50, s50, 16384
  v_add_u32 v50, s50, v50
  s_lshl_b32 s51, s30, 1
  v_xor_b32 v47, s51, v47
  v_xor_b32 v51, 0, v47
  v_lshl_add_u32 v2, v51, 6, v50
  v_xor_b32 v51, 1, v47
  v_lshl_add_u32 v3, v51, 6, v50
  v_xor_b32 v51, 2, v47
  v_lshl_add_u32 v4, v51, 6, v50
  v_xor_b32 v51, 3, v47
  v_lshl_add_u32 v5, v51, 6, v50
  v_lshrrev_b32 v50, 2, v49
  v_lshlrev_b32 v50, 1, v50
  v_mov_b32 v51, 0x78
  v_lshrrev_b32 v50, v50, v51
  v_and_b32 v50, 3, v50
  v_xor_b32 v50, v50, v46
  v_lshlrev_b32 v50, 4, v50
  v_lshl_add_u32 v50, v49, 6, v50
  s_mul_i32 s50, s30, 5120
  s_add_u32 s50, s50, 114688
  v_add_u32 v6, s50, v50
  v_add_u32 v14, 118784, v50
  v_mov_b32 v244, 0
  v_mov_b32 v245, 0
  v_mov_b32 v246, 0
  v_mov_b32 v247, 0
  s_nop 1
  v_mfma_f32_32x32x16_bf16 v[64:79], v[244:247], v[244:247], 0
  v_mfma_f32_32x32x16_bf16 v[80:95], v[244:247], v[244:247], 0
  v_mfma_f32_32x32x16_bf16 v[96:111], v[244:247], v[244:247], 0
  v_mfma_f32_32x32x16_bf16 v[112:127], v[244:247], v[244:247], 0
  v_mfma_f32_32x32x16_bf16 v[128:143], v[244:247], v[244:247], 0
  v_mfma_f32_32x32x16_bf16 v[144:159], v[244:247], v[244:247], 0
  v_mfma_f32_32x32x16_bf16 v[160:175], v[244:247], v[244:247], 0
  v_mfma_f32_32x32x16_bf16 v[176:191], v[244:247], v[244:247], 0
  v_mfma_f32_32x32x16_bf16 v[192:207], v[244:247], v[244:247], 0
  v_mfma_f32_32x32x16_bf16 v[208:223], v[244:247], v[244:247], 0
  v_mfma_f32_32x32x16_bf16 a[0:15], v[244:247], v[244:247], 0
  v_mfma_f32_32x32x16_bf16 a[16:31], v[244:247], v[244:247], 0
  v_mfma_f32_32x32x16_bf16 a[32:47], v[244:247], v[244:247], 0
  v_mfma_f32_32x32x16_bf16 a[48:63], v[244:247], v[244:247], 0
  v_mfma_f32_32x32x16_bf16 a[64:79], v[244:247], v[244:247], 0
  v_mfma_f32_32x32x16_bf16 a[80:95], v[244:247], v[244:247], 0
  v_mfma_f32_32x32x16_bf16 a[96:111], v[244:247], v[244:247], 0
  v_mfma_f32_32x32x16_bf16 a[112:127], v[244:247], v[244:247], 0
  v_mfma_f32_32x32x16_bf16 a[128:143], v[244:247], v[244:247], 0
  v_mfma_f32_32x32x16_bf16 a[144:159], v[244:247], v[244:247], 0
  v_mfma_f32_32x32x16_bf16 a[160:175], v[244:247], v[244:247], 0
  v_mfma_f32_32x32x16_bf16 a[176:191], v[244:247], v[244:247], 0
  v_mfma_f32_32x32x16_bf16 a[192:207], v[244:247], v[244:247], 0
  v_mfma_f32_32x32x16_bf16 a[208:223], v[244:247], v[244:247], 0
  v_mfma_f32_32x32x16_bf16 a[224:239], v[244:247], v[244:247], 0
  v_mfma_f32_32x32x16_bf16 a[240:255], v[244:247], v[244:247], 0
  v_lshrrev_b32 v46, 4, v1
  v_bfe_u32 v47, v1, 2, 2
  v_and_b32 v48, 3, v1
  v_and_b32 v49, 15, v1
  s_lshl_b32 s50, s29, 13
  s_add_u32 s51, s50, 65536
  v_lshlrev_b32 v50, 8, v49
  v_add_u32 v50, s51, v50
  s_lshl_b32 s51, s30, 3
  v_xor_b32 v52, s51, v49
  v_add_u32 v51, 0, v46
  v_xor_b32 v51, v51, v52
  v_lshl_add_u32 v22, v51, 4, v50
  v_add_u32 v51, 4, v46
  v_xor_b32 v51, v51, v52
  v_lshl_add_u32 v23, v51, 4, v50
  v_add_u32 v51, 8, v46
  v_xor_b32 v51, v51, v52
  v_lshl_add_u32 v24, v51, 4, v50
  v_add_u32 v51, 12, v46
  v_xor_b32 v51, v51, v52
  v_lshl_add_u32 v25, v51, 4, v50
  v_lshrrev_b32 v50, 2, v1
  v_and_b32 v51, 7, v50
  v_lshlrev_b32 v51, 1, v51
  v_lshlrev_b32 v50, 8, v50
  v_add_u32 v50, s50, v50
  v_and_b32 v52, 1, v48
  v_lshl_add_u32 v50, v52, 3, v50
  v_lshrrev_b32 v52, 1, v48
  s_lshl_b32 s51, s30, 3
  v_xor_b32 v51, s51, v51
  v_add_u32 v26, 0, v52
  v_xor_b32 v26, v26, v51
  v_lshl_add_u32 v26, v26, 4, v50
  v_add_u32 v27, 2, v52
  v_xor_b32 v27, v27, v51
  v_lshl_add_u32 v27, v27, 4, v50
  v_add_u32 v28, 4, v52
  v_xor_b32 v28, v28, v51
  v_lshl_add_u32 v28, v28, 4, v50
  v_add_u32 v29, 6, v52
  v_xor_b32 v29, v29, v51
  v_lshl_add_u32 v29, v29, 4, v50
  v_add_u32 v30, 8, v52
  v_xor_b32 v30, v30, v51
  v_lshl_add_u32 v30, v30, 4, v50
  v_add_u32 v31, 10, v52
  v_xor_b32 v31, v31, v51
  v_lshl_add_u32 v31, v31, 4, v50
  v_add_u32 v32, 12, v52
  v_xor_b32 v32, v32, v51
  v_lshl_add_u32 v32, v32, 4, v50
  v_add_u32 v33, 14, v52
  v_xor_b32 v33, v33, v51
  v_lshl_add_u32 v33, v33, 4, v50
  v_lshlrev_b32 v50, 2, v46
  v_xor_b32 v50, v50, v49
  v_lshlrev_b32 v50, 4, v50
  v_lshl_add_u32 v50, v46, 10, v50
  v_add_u32 v34, 0, v50
  v_add_u32 v35, 3072, v50
  v_add_u32 v36, 6144, v50
  v_add_u32 v37, 9216, v50
  v_lshrrev_b32 v50, 2, v1
  v_lshlrev_b32 v50, 8, v50
  v_lshl_add_u32 v50, v48, 4, v50
  s_lshl_b32 s50, s28, 13
  s_add_u32 s50, s50, 98304
  v_add_u32 v50, s50, v50
  v_xor_b32 v51, 0, v47
  v_lshl_add_u32 v38, v51, 6, v50
  v_xor_b32 v51, 1, v47
  v_lshl_add_u32 v39, v51, 6, v50
  v_xor_b32 v51, 2, v47
  v_lshl_add_u32 v40, v51, 6, v50
  v_xor_b32 v51, 3, v47
  v_lshl_add_u32 v41, v51, 6, v50
  s_mul_i32 s50, s30, 40960
  s_lshl_b32 s51, s29, 12
  s_add_u32 s50, s50, s51
  v_lshlrev_b32 v43, 4, v1
  v_add_u32 v42, s50, v43
  v_add_u32 v44, 0x10000, v43
  s_lshl_b32 s50, s54, 10
  v_add_u32 v45, s50, v43
  s_mov_b32 s31, 0
  v_mov_b32 v46, 0x3f803f80
  v_accvgpr_write_b32 a180, v46
  v_accvgpr_write_b32 a181, v46
  v_accvgpr_write_b32 a182, v46
  v_accvgpr_write_b32 a183, v46
  v_mov_b32 v48, 0
  v_mov_b32 v49, 0
  v_mov_b32 v50, 0
  v_mov_b32 v51, 0
  v_mov_b32 v52, 0
  v_mov_b32 v53, 0
  v_mov_b32 v54, 0
  v_mov_b32 v55, 0
  v_mov_b32 v56, 0
  v_mov_b32 v57, 0
  v_mov_b32 v58, 0
  v_mov_b32 v59, 0
  v_mov_b32 v60, 0
  v_mov_b32 v61, 0
  v_mov_b32 v62, 0
  v_mov_b32 v63, 0
  v_mov_b32 v248, 0
  v_mov_b32 v249, 0
  v_mov_b32 v250, 0
  v_mov_b32 v251, 0
  s_mov_b32 s96, s12
  s_mov_b32 s97, s13
  s_mov_b32 s98, s14
  s_mov_b32 s99, s15
  v_mov_b32 v244, v16
  v_mov_b32 v245, v17
  v_mov_b32 v246, v18
  v_mov_b32 v247, v19
  s_add_u32 m0, s41, 16384
  s_nop 0
  buffer_load_dwordx4 v7, s[8:11], s33 offen lds
  buffer_load_dwordx4 v8, s[8:11], s33 offen offset:1024 lds
  buffer_load_dwordx4 v9, s[8:11], s33 offen offset:2048 lds
  buffer_load_dwordx4 v10, s[8:11], s33 offen offset:3072 lds
  s_add_u32 m0, s42, 9216
  s_nop 0
  buffer_load_dwordx4 v11, s[4:7], s32 offen lds
  buffer_load_dwordx4 v12, s[4:7], s32 offen offset:1024 lds
  s_add_u32 m0, s38, 9216
  s_nop 0
  s_mov_b64 exec, 0xffff
  buffer_load_dwordx4 v13, s[4:7], s32 offen lds
  s_mov_b64 exec, -1
  s_add_u32 s33, s33, 262144
  s_and_b32 s33, s33, 0x3fffff
  s_add_u32 s32, s32, 64
  s_and_b32 s32, s32, 0xfffffbff
  s_waitcnt vmcnt(7)
  s_barrier
  s_cmp_eq_u32 s61, 1
  s_cbranch_scc1 L_no_arrive
  s_lshl_b32 s50, s57, 2
  s_add_u32 s50, s50, 0
  s_lshl_b32 s51, s28, 14
  s_add_u32 s50, s50, s51
  v_lshlrev_b32 v46, 8, v1
  v_add_u32 v46, s50, v46
  v_mov_b32 v47, 1
  buffer_atomic_add v47, v46, s[72:75], 0 offen sc1
L_no_arrive:
  s_add_u32 m0, s41, 32768
  s_nop 0
  buffer_load_dwordx4 v7, s[8:11], s33 offen lds
  buffer_load_dwordx4 v8, s[8:11], s33 offen offset:1024 lds
  buffer_load_dwordx4 v9, s[8:11], s33 offen offset:2048 lds
  buffer_load_dwordx4 v10, s[8:11], s33 offen offset:3072 lds
  s_add_u32 m0, s42, 18432
  s_nop 0
  buffer_load_dwordx4 v11, s[4:7], s32 offen lds
  buffer_load_dwordx4 v12, s[4:7], s32 offen offset:1024 lds
  s_add_u32 m0, s38, 18432
  s_nop 0
  s_mov_b64 exec, 0xffff
  buffer_load_dwordx4 v13, s[4:7], s32 offen lds
  s_mov_b64 exec, -1
  s_add_u32 s33, s33, 262144
  s_and_b32 s33, s33, 0x3fffff
  s_add_u32 s32, s32, 64
  s_and_b32 s32, s32, 0xfffffbff
  s_add_u32 s35, s47, 16384
  s_mov_b32 s36, s43
  .p2align 6
L_q_loop:
  v_mfma_f32_16x16x32_bf16 v[80:83], a[200:203], v[48:51], v[80:83]
  ds_read_b64_tr_b16 a[184:185], v2
  v_mfma_f32_16x16x32_bf16 v[84:87], a[204:207], v[48:51], v[84:87]
  ds_read_b64_tr_b16 a[186:187], v2 offset:2048
  v_mfma_f32_16x16x32_bf16 v[88:91], a[208:211], v[48:51], v[88:91]
  ds_read_b64_tr_b16 a[188:189], v2 offset:8
  v_mfma_f32_16x16x32_bf16 v[92:95], a[212:215], v[48:51], v[92:95]
  ds_read_b64_tr_b16 a[190:191], v2 offset:2056
  v_mfma_f32_16x16x32_bf16 v[112:115], a[200:203], v[52:55], v[112:115]
  ds_read_b128 v[48:51], v6
  v_mfma_f32_16x16x32_bf16 v[116:119], a[204:207], v[52:55], v[116:119]
  s_add_u32 m0, s41, 49152
  ds_read_b64_tr_b16 a[192:193], v3
  v_mfma_f32_16x16x32_bf16 v[120:123], a[208:211], v[52:55], v[120:123]
  buffer_load_dwordx4 v7, s[8:11], s33 offen lds
  v_mfma_f32_16x16x32_bf16 v[124:127], a[212:215], v[52:55], v[124:127]
  ds_read_b64_tr_b16 a[194:195], v3 offset:2048
  v_mfma_f32_16x16x32_bf16 v[144:147], a[200:203], v[56:59], v[144:147]
  ds_read_b128 v[52:55], v6 offset:1024
  v_mfma_f32_16x16x32_bf16 v[148:151], a[204:207], v[56:59], v[148:151]
  ds_read_b64_tr_b16 a[196:197], v3 offset:8
  v_mfma_f32_16x16x32_bf16 v[152:155], a[208:211], v[56:59], v[152:155]
  buffer_load_dwordx4 v8, s[8:11], s33 offen offset:1024 lds
  v_mfma_f32_16x16x32_bf16 v[156:159], a[212:215], v[56:59], v[156:159]
  ds_read_b64_tr_b16 a[198:199], v3 offset:2056
  v_mfma_f32_16x16x32_bf16 v[176:179], a[200:203], v[60:63], v[176:179]
  ds_read_b128 v[56:59], v6 offset:2048
  v_mfma_f32_16x16x32_bf16 v[180:183], a[204:207], v[60:63], v[180:183]
  ds_read_b128 v[248:251], v14
  v_mfma_f32_16x16x32_bf16 v[184:187], a[208:211], v[60:63], v[184:187]
  buffer_load_dwordx4 v9, s[8:11], s33 offen offset:2048 lds
  v_mfma_f32_16x16x32_bf16 v[188:191], a[212:215], v[60:63], v[188:191]
  s_waitcnt lgkmcnt(7)
  v_mfma_f32_16x16x32_bf16 v[64:67], a[184:187], v[48:51], v[64:67]
  ds_read_b128 v[60:63], v6 offset:3072
  v_mfma_f32_16x16x32_bf16 v[68:71], a[188:191], v[48:51], v[68:71]
  s_waitcnt lgkmcnt(6)
  ds_read_b64_tr_b16 a[200:201], v4
  v_mfma_f32_16x16x32_bf16 v[72:75], a[192:195], v[48:51], v[72:75]
  s_waitcnt lgkmcnt(4)
  buffer_load_dwordx4 v10, s[8:11], s33 offen offset:3072 lds
  v_mfma_f32_16x16x32_bf16 v[76:79], a[196:199], v[48:51], v[76:79]
  s_add_u32 s33, s33, 262144
  ds_read_b64_tr_b16 a[202:203], v4 offset:2048
  v_mfma_f32_16x16x32_bf16 v[96:99], a[184:187], v[52:55], v[96:99]
  s_and_b32 s33, s33, 0x3fffff
  ds_read_b64_tr_b16 a[204:205], v4 offset:8
  v_mfma_f32_16x16x32_bf16 v[100:103], a[188:191], v[52:55], v[100:103]
  s_add_u32 m0, s42, 27648
  ds_read_b64_tr_b16 a[206:207], v4 offset:2056
  v_mfma_f32_16x16x32_bf16 v[104:107], a[192:195], v[52:55], v[104:107]
  buffer_load_dwordx4 v11, s[4:7], s32 offen lds
  v_mfma_f32_16x16x32_bf16 v[108:111], a[196:199], v[52:55], v[108:111]
  s_waitcnt lgkmcnt(6)
  ds_read_b64_tr_b16 a[208:209], v5
  v_mfma_f32_16x16x32_bf16 v[128:131], a[184:187], v[56:59], v[128:131]
  ds_read_b64_tr_b16 a[210:211], v5 offset:2048
  v_mfma_f32_16x16x32_bf16 v[132:135], a[188:191], v[56:59], v[132:135]
  ds_read_b64_tr_b16 a[212:213], v5 offset:8
  v_mfma_f32_16x16x32_bf16 v[136:139], a[192:195], v[56:59], v[136:139]
  buffer_load_dwordx4 v12, s[4:7], s32 offen offset:1024 lds
  v_mfma_f32_16x16x32_bf16 v[140:143], a[196:199], v[56:59], v[140:143]
  s_waitcnt lgkmcnt(7)
  ds_read_b64_tr_b16 a[214:215], v5 offset:2056
  v_mfma_f32_16x16x32_bf16 v[160:163], a[184:187], v[60:63], v[160:163]
  s_add_u32 m0, s38, 27648
  v_mfma_f32_16x16x32_bf16 v[164:167], a[188:191], v[60:63], v[164:167]
  s_mov_b64 exec, 0xffff
  buffer_load_dwordx4 v13, s[4:7], s32 offen lds
  s_mov_b64 exec, -1
  v_mfma_f32_16x16x32_bf16 v[168:171], a[192:195], v[60:63], v[168:171]
  s_add_u32 s32, s32, 64
  v_mfma_f32_16x16x32_bf16 v[172:175], a[196:199], v[60:63], v[172:175]
  s_and_b32 s32, s32, 0xfffffbff
  v_mfma_f32_16x16x32_bf16 v[192:195], a[184:187], v[248:251], v[192:195]
  v_mfma_f32_16x16x32_bf16 v[196:199], a[188:191], v[248:251], v[196:199]
  s_waitcnt vmcnt(14) lgkmcnt(0)
  v_mfma_f32_16x16x32_bf16 v[200:203], a[192:195], v[248:251], v[200:203]
  s_barrier
  v_mfma_f32_16x16x32_bf16 v[204:207], a[196:199], v[248:251], v[204:207]
  v_mfma_f32_16x16x32_bf16 v[80:83], a[200:203], v[48:51], v[80:83]
  ds_read_b64_tr_b16 a[184:185], v2 offset:16384
  v_mfma_f32_16x16x32_bf16 v[84:87], a[204:207], v[48:51], v[84:87]
  ds_read_b64_tr_b16 a[186:187], v2 offset:18432
  v_mfma_f32_16x16x32_bf16 v[88:91], a[208:211], v[48:51], v[88:91]
  ds_read_b64_tr_b16 a[188:189], v2 offset:16392
  v_mfma_f32_16x16x32_bf16 v[92:95], a[212:215], v[48:51], v[92:95]
  ds_read_b64_tr_b16 a[190:191], v2 offset:18440
  v_mfma_f32_16x16x32_bf16 v[112:115], a[200:203], v[52:55], v[112:115]
  ds_read_b128 v[48:51], v6 offset:9216
  v_mfma_f32_16x16x32_bf16 v[116:119], a[204:207], v[52:55], v[116:119]
  s_add_u32 m0, s41, 0
  ds_read_b64_tr_b16 a[192:193], v3 offset:16384
  v_mfma_f32_16x16x32_bf16 v[120:123], a[208:211], v[52:55], v[120:123]
  buffer_load_dwordx4 v7, s[8:11], s33 offen lds
  v_mfma_f32_16x16x32_bf16 v[124:127], a[212:215], v[52:55], v[124:127]
  ds_read_b64_tr_b16 a[194:195], v3 offset:18432
  v_mfma_f32_16x16x32_bf16 v[144:147], a[200:203], v[56:59], v[144:147]
  ds_read_b128 v[52:55], v6 offset:10240
  v_mfma_f32_16x16x32_bf16 v[148:151], a[204:207], v[56:59], v[148:151]
  ds_read_b64_tr_b16 a[196:197], v3 offset:16392
  v_mfma_f32_16x16x32_bf16 v[152:155], a[208:211], v[56:59], v[152:155]
  buffer_load_dwordx4 v8, s[8:11], s33 offen offset:1024 lds
  v_mfma_f32_16x16x32_bf16 v[156:159], a[212:215], v[56:59], v[156:159]
  ds_read_b64_tr_b16 a[198:199], v3 offset:18440
  v_mfma_f32_16x16x32_bf16 v[176:179], a[200:203], v[60:63], v[176:179]
  ds_read_b128 v[56:59], v6 offset:11264
  v_mfma_f32_16x16x32_bf16 v[180:183], a[204:207], v[60:63], v[180:183]
  ds_read_b128 v[248:251], v14 offset:9216
  v_mfma_f32_16x16x32_bf16 v[184:187], a[208:211], v[60:63], v[184:187]
  buffer_load_dwordx4 v9, s[8:11], s33 offen offset:2048 lds
  v_mfma_f32_16x16x32_bf16 v[188:191], a[212:215], v[60:63], v[188:191]
  s_waitcnt lgkmcnt(7)
  v_mfma_f32_16x16x32_bf16 v[64:67], a[184:187], v[48:51], v[64:67]
  ds_read_b128 v[60:63], v6 offset:12288
  v_mfma_f32_16x16x32_bf16 v[68:71], a[188:191], v[48:51], v[68:71]
  s_waitcnt lgkmcnt(6)
  ds_read_b64_tr_b16 a[200:201], v4 offset:16384
  v_mfma_f32_16x16x32_bf16 v[72:75], a[192:195], v[48:51], v[72:75]
  s_waitcnt lgkmcnt(4)
  buffer_load_dwordx4 v10, s[8:11], s33 offen offset:3072 lds
  v_mfma_f32_16x16x32_bf16 v[76:79], a[196:199], v[48:51], v[76:79]
  s_add_u32 s33, s33, 262144
  ds_read_b64_tr_b16 a[202:203], v4 offset:18432
  v_mfma_f32_16x16x32_bf16 v[96:99], a[184:187], v[52:55], v[96:99]
  s_and_b32 s33, s33, 0x3fffff
  ds_read_b64_tr_b16 a[204:205], v4 offset:16392
  v_mfma_f32_16x16x32_bf16 v[100:103], a[188:191], v[52:55], v[100:103]
  s_add_u32 m0, s42, 0
  ds_read_b64_tr_b16 a[206:207], v4 offset:18440
  v_mfma_f32_16x16x32_bf16 v[104:107], a[192:195], v[52:55], v[104:107]
  buffer_load_dwordx4 v11, s[4:7], s32 offen lds
  v_mfma_f32_16x16x32_bf16 v[108:111], a[196:199], v[52:55], v[108:111]
  s_waitcnt lgkmcnt(6)
  ds_read_b64_tr_b16 a[208:209], v5 offset:16384
  v_mfma_f32_16x16x32_bf16 v[128:131], a[184:187], v[56:59], v[128:131]
  ds_read_b64_tr_b16 a[210:211], v5 offset:18432
  v_mfma_f32_16x16x32_bf16 v[132:135], a[188:191], v[56:59], v[132:135]
  ds_read_b64_tr_b16 a[212:213], v5 offset:16392
  v_mfma_f32_16x16x32_bf16 v[136:139], a[192:195], v[56:59], v[136:139]
  buffer_load_dwordx4 v12, s[4:7], s32 offen offset:1024 lds
  v_mfma_f32_16x16x32_bf16 v[140:143], a[196:199], v[56:59], v[140:143]
  s_waitcnt lgkmcnt(7)
  ds_read_b64_tr_b16 a[214:215], v5 offset:18440
  v_mfma_f32_16x16x32_bf16 v[160:163], a[184:187], v[60:63], v[160:163]
  s_add_u32 m0, s38, 0
  v_mfma_f32_16x16x32_bf16 v[164:167], a[188:191], v[60:63], v[164:167]
  s_mov_b64 exec, 0xffff
  buffer_load_dwordx4 v13, s[4:7], s32 offen lds
  s_mov_b64 exec, -1
  v_mfma_f32_16x16x32_bf16 v[168:171], a[192:195], v[60:63], v[168:171]
  s_add_u32 s32, s32, 64
  v_mfma_f32_16x16x32_bf16 v[172:175], a[196:199], v[60:63], v[172:175]
  s_and_b32 s32, s32, 0xfffffbff
  s_mov_b32 m0, s35
  v_mfma_f32_16x16x32_bf16 v[192:195], a[184:187], v[248:251], v[192:195]
  buffer_load_dwordx4 v244, s[96:99], s36 offen nt lds
  v_mfma_f32_16x16x32_bf16 v[196:199], a[188:191], v[248:251], v[196:199]
  buffer_load_dwordx4 v245, s[96:99], s36 offen offset:1024 nt lds
  v_mfma_f32_16x16x32_bf16 v[200:203], a[192:195], v[248:251], v[200:203]
  buffer_load_dwordx4 v246, s[96:99], s36 offen offset:2048 nt lds
  v_mfma_f32_16x16x32_bf16 v[204:207], a[196:199], v[248:251], v[204:207]
  buffer_load_dwordx4 v247, s[96:99], s36 offen offset:3072 nt lds
  s_waitcnt vmcnt(18) lgkmcnt(0)
  s_barrier
  v_mfma_f32_16x16x32_bf16 v[80:83], a[200:203], v[48:51], v[80:83]
  ds_read_b64_tr_b16 a[184:185], v2 offset:32768
  v_mfma_f32_16x16x32_bf16 v[84:87], a[204:207], v[48:51], v[84:87]
  ds_read_b64_tr_b16 a[186:187], v2 offset:34816
  v_mfma_f32_16x16x32_bf16 v[88:91], a[208:211], v[48:51], v[88:91]
  ds_read_b64_tr_b16 a[188:189], v2 offset:32776
  v_mfma_f32_16x16x32_bf16 v[92:95], a[212:215], v[48:51], v[92:95]
  ds_read_b64_tr_b16 a[190:191], v2 offset:34824
  v_mfma_f32_16x16x32_bf16 v[112:115], a[200:203], v[52:55], v[112:115]
  ds_read_b128 v[48:51], v6 offset:18432
  v_mfma_f32_16x16x32_bf16 v[116:119], a[204:207], v[52:55], v[116:119]
  s_add_u32 m0, s41, 16384
  ds_read_b64_tr_b16 a[192:193], v3 offset:32768
  v_mfma_f32_16x16x32_bf16 v[120:123], a[208:211], v[52:55], v[120:123]
  buffer_load_dwordx4 v7, s[8:11], s33 offen lds
  v_mfma_f32_16x16x32_bf16 v[124:127], a[212:215], v[52:55], v[124:127]
  ds_read_b64_tr_b16 a[194:195], v3 offset:34816
  v_mfma_f32_16x16x32_bf16 v[144:147], a[200:203], v[56:59], v[144:147]
  ds_read_b128 v[52:55], v6 offset:19456
  v_mfma_f32_16x16x32_bf16 v[148:151], a[204:207], v[56:59], v[148:151]
  ds_read_b64_tr_b16 a[196:197], v3 offset:32776
  v_mfma_f32_16x16x32_bf16 v[152:155], a[208:211], v[56:59], v[152:155]
  buffer_load_dwordx4 v8, s[8:11], s33 offen offset:1024 lds
  v_mfma_f32_16x16x32_bf16 v[156:159], a[212:215], v[56:59], v[156:159]
  ds_read_b64_tr_b16 a[198:199], v3 offset:34824
  v_mfma_f32_16x16x32_bf16 v[176:179], a[200:203], v[60:63], v[176:179]
  ds_read_b128 v[56:59], v6 offset:20480
  v_mfma_f32_16x16x32_bf16 v[180:183], a[204:207], v[60:63], v[180:183]
  ds_read_b128 v[248:251], v14 offset:18432
  v_mfma_f32_16x16x32_bf16 v[184:187], a[208:211], v[60:63], v[184:187]
  buffer_load_dwordx4 v9, s[8:11], s33 offen offset:2048 lds
  v_mfma_f32_16x16x32_bf16 v[188:191], a[212:215], v[60:63], v[188:191]
  s_waitcnt lgkmcnt(7)
  v_mfma_f32_16x16x32_bf16 v[64:67], a[184:187], v[48:51], v[64:67]
  ds_read_b128 v[60:63], v6 offset:21504
  v_mfma_f32_16x16x32_bf16 v[68:71], a[188:191], v[48:51], v[68:71]
  s_waitcnt lgkmcnt(6)
  ds_read_b64_tr_b16 a[200:201], v4 offset:32768
  v_mfma_f32_16x16x32_bf16 v[72:75], a[192:195], v[48:51], v[72:75]
  s_waitcnt lgkmcnt(4)
  buffer_load_dwordx4 v10, s[8:11], s33 offen offset:3072 lds
  v_mfma_f32_16x16x32_bf16 v[76:79], a[196:199], v[48:51], v[76:79]
  s_add_u32 s33, s33, 262144
  ds_read_b64_tr_b16 a[202:203], v4 offset:34816
  v_mfma_f32_16x16x32_bf16 v[96:99], a[184:187], v[52:55], v[96:99]
  s_and_b32 s33, s33, 0x3fffff
  ds_read_b64_tr_b16 a[204:205], v4 offset:32776
  v_mfma_f32_16x16x32_bf16 v[100:103], a[188:191], v[52:55], v[100:103]
  s_add_u32 m0, s42, 9216
  ds_read_b64_tr_b16 a[206:207], v4 offset:34824
  v_mfma_f32_16x16x32_bf16 v[104:107], a[192:195], v[52:55], v[104:107]
  buffer_load_dwordx4 v11, s[4:7], s32 offen lds
  v_mfma_f32_16x16x32_bf16 v[108:111], a[196:199], v[52:55], v[108:111]
  s_waitcnt lgkmcnt(6)
  ds_read_b64_tr_b16 a[208:209], v5 offset:32768
  v_mfma_f32_16x16x32_bf16 v[128:131], a[184:187], v[56:59], v[128:131]
  ds_read_b64_tr_b16 a[210:211], v5 offset:34816
  v_mfma_f32_16x16x32_bf16 v[132:135], a[188:191], v[56:59], v[132:135]
  ds_read_b64_tr_b16 a[212:213], v5 offset:32776
  v_mfma_f32_16x16x32_bf16 v[136:139], a[192:195], v[56:59], v[136:139]
  buffer_load_dwordx4 v12, s[4:7], s32 offen offset:1024 lds
  v_mfma_f32_16x16x32_bf16 v[140:143], a[196:199], v[56:59], v[140:143]
  s_waitcnt lgkmcnt(7)
  ds_read_b64_tr_b16 a[214:215], v5 offset:34824
  v_mfma_f32_16x16x32_bf16 v[160:163], a[184:187], v[60:63], v[160:163]
  s_add_u32 m0, s38, 9216
  v_mfma_f32_16x16x32_bf16 v[164:167], a[188:191], v[60:63], v[164:167]
  s_mov_b64 exec, 0xffff
  buffer_load_dwordx4 v13, s[4:7], s32 offen lds
  s_mov_b64 exec, -1
  v_mfma_f32_16x16x32_bf16 v[168:171], a[192:195], v[60:63], v[168:171]
  s_add_u32 s32, s32, 64
  v_mfma_f32_16x16x32_bf16 v[172:175], a[196:199], v[60:63], v[172:175]
  s_and_b32 s32, s32, 0xfffffbff
  v_mfma_f32_16x16x32_bf16 v[192:195], a[184:187], v[248:251], v[192:195]
  v_mfma_f32_16x16x32_bf16 v[196:199], a[188:191], v[248:251], v[196:199]
  s_waitcnt vmcnt(18) lgkmcnt(0)
  v_mfma_f32_16x16x32_bf16 v[200:203], a[192:195], v[248:251], v[200:203]
  s_barrier
  v_mfma_f32_16x16x32_bf16 v[204:207], a[196:199], v[248:251], v[204:207]
  v_mfma_f32_16x16x32_bf16 v[80:83], a[200:203], v[48:51], v[80:83]
  ds_read_b64_tr_b16 a[184:185], v2 offset:49152
  v_mfma_f32_16x16x32_bf16 v[84:87], a[204:207], v[48:51], v[84:87]
  ds_read_b64_tr_b16 a[186:187], v2 offset:51200
  v_mfma_f32_16x16x32_bf16 v[88:91], a[208:211], v[48:51], v[88:91]
  ds_read_b64_tr_b16 a[188:189], v2 offset:49160
  v_mfma_f32_16x16x32_bf16 v[92:95], a[212:215], v[48:51], v[92:95]
  ds_read_b64_tr_b16 a[190:191], v2 offset:51208
  v_mfma_f32_16x16x32_bf16 v[112:115], a[200:203], v[52:55], v[112:115]
  ds_read_b128 v[48:51], v6 offset:27648
  v_mfma_f32_16x16x32_bf16 v[116:119], a[204:207], v[52:55], v[116:119]
  s_add_u32 m0, s41, 32768
  ds_read_b64_tr_b16 a[192:193], v3 offset:49152
  v_mfma_f32_16x16x32_bf16 v[120:123], a[208:211], v[52:55], v[120:123]
  buffer_load_dwordx4 v7, s[8:11], s33 offen lds
  v_mfma_f32_16x16x32_bf16 v[124:127], a[212:215], v[52:55], v[124:127]
  ds_read_b64_tr_b16 a[194:195], v3 offset:51200
  v_mfma_f32_16x16x32_bf16 v[144:147], a[200:203], v[56:59], v[144:147]
  ds_read_b128 v[52:55], v6 offset:28672
  v_mfma_f32_16x16x32_bf16 v[148:151], a[204:207], v[56:59], v[148:151]
  ds_read_b64_tr_b16 a[196:197], v3 offset:49160
  v_mfma_f32_16x16x32_bf16 v[152:155], a[208:211], v[56:59], v[152:155]
  buffer_load_dwordx4 v8, s[8:11], s33 offen offset:1024 lds
  v_mfma_f32_16x16x32_bf16 v[156:159], a[212:215], v[56:59], v[156:159]
  ds_read_b64_tr_b16 a[198:199], v3 offset:51208
  v_mfma_f32_16x16x32_bf16 v[176:179], a[200:203], v[60:63], v[176:179]
  ds_read_b128 v[56:59], v6 offset:29696
  v_mfma_f32_16x16x32_bf16 v[180:183], a[204:207], v[60:63], v[180:183]
  ds_read_b128 v[248:251], v14 offset:27648
  v_mfma_f32_16x16x32_bf16 v[184:187], a[208:211], v[60:63], v[184:187]
  buffer_load_dwordx4 v9, s[8:11], s33 offen offset:2048 lds
  v_mfma_f32_16x16x32_bf16 v[188:191], a[212:215], v[60:63], v[188:191]
  s_waitcnt lgkmcnt(7)
  v_mfma_f32_16x16x32_bf16 v[64:67], a[184:187], v[48:51], v[64:67]
  ds_read_b128 v[60:63], v6 offset:30720
  v_mfma_f32_16x16x32_bf16 v[68:71], a[188:191], v[48:51], v[68:71]
  s_waitcnt lgkmcnt(6)
  ds_read_b64_tr_b16 a[200:201], v4 offset:49152
  v_mfma_f32_16x16x32_bf16 v[72:75], a[192:195], v[48:51], v[72:75]
  s_waitcnt lgkmcnt(4)
  buffer_load_dwordx4 v10, s[8:11], s33 offen offset:3072 lds
  v_mfma_f32_16x16x32_bf16 v[76:79], a[196:199], v[48:51], v[76:79]
  s_add_u32 s33, s33, 262144
  ds_read_b64_tr_b16 a[202:203], v4 offset:51200
  v_mfma_f32_16x16x32_bf16 v[96:99], a[184:187], v[52:55], v[96:99]
  s_and_b32 s33, s33, 0x3fffff
  ds_read_b64_tr_b16 a[204:205], v4 offset:49160
  v_mfma_f32_16x16x32_bf16 v[100:103], a[188:191], v[52:55], v[100:103]
  s_add_u32 m0, s42, 18432
  ds_read_b64_tr_b16 a[206:207], v4 offset:51208
  v_mfma_f32_16x16x32_bf16 v[104:107], a[192:195], v[52:55], v[104:107]
  buffer_load_dwordx4 v11, s[4:7], s32 offen lds
  v_mfma_f32_16x16x32_bf16 v[108:111], a[196:199], v[52:55], v[108:111]
  s_waitcnt lgkmcnt(6)
  ds_read_b64_tr_b16 a[208:209], v5 offset:49152
  v_mfma_f32_16x16x32_bf16 v[128:131], a[184:187], v[56:59], v[128:131]
  ds_read_b64_tr_b16 a[210:211], v5 offset:51200
  v_mfma_f32_16x16x32_bf16 v[132:135], a[188:191], v[56:59], v[132:135]
  ds_read_b64_tr_b16 a[212:213], v5 offset:49160
  v_mfma_f32_16x16x32_bf16 v[136:139], a[192:195], v[56:59], v[136:139]
  buffer_load_dwordx4 v12, s[4:7], s32 offen offset:1024 lds
  v_mfma_f32_16x16x32_bf16 v[140:143], a[196:199], v[56:59], v[140:143]
  s_waitcnt lgkmcnt(7)
  ds_read_b64_tr_b16 a[214:215], v5 offset:51208
  v_mfma_f32_16x16x32_bf16 v[160:163], a[184:187], v[60:63], v[160:163]
  s_add_u32 m0, s38, 18432
  v_mfma_f32_16x16x32_bf16 v[164:167], a[188:191], v[60:63], v[164:167]
  s_mov_b64 exec, 0xffff
  buffer_load_dwordx4 v13, s[4:7], s32 offen lds
  s_mov_b64 exec, -1
  v_mfma_f32_16x16x32_bf16 v[168:171], a[192:195], v[60:63], v[168:171]
  s_add_u32 s32, s32, 64
  v_mfma_f32_16x16x32_bf16 v[172:175], a[196:199], v[60:63], v[172:175]
  s_and_b32 s32, s32, 0xfffffbff
  v_mfma_f32_16x16x32_bf16 v[192:195], a[184:187], v[248:251], v[192:195]
  v_mfma_f32_16x16x32_bf16 v[196:199], a[188:191], v[248:251], v[196:199]
  s_waitcnt vmcnt(18) lgkmcnt(0)
  v_mfma_f32_16x16x32_bf16 v[200:203], a[192:195], v[248:251], v[200:203]
  s_barrier
  v_mfma_f32_16x16x32_bf16 v[204:207], a[196:199], v[248:251], v[204:207]
  s_add_u32 s35, s35, 16384
  s_add_u32 s36, s36, 8192
  s_add_u32 s31, s31, 1
  s_cmp_eq_u32 s31, 2
  s_cbranch_scc0 L_q_tov_done
  s_mov_b32 s96, s16
  s_mov_b32 s97, s17
  s_add_u32 s35, s48, 0
  s_mov_b32 s36, s43
  v_mov_b32 v244, v20
  v_mov_b32 v245, v21
  v_mov_b32 v246, v20
  v_mov_b32 v247, v21
L_q_tov_done:
  s_cmp_lt_u32 s31, 3
  s_cbranch_scc1 L_q_loop
  v_mfma_f32_16x16x32_bf16 v[80:83], a[200:203], v[48:51], v[80:83]
  ds_read_b64_tr_b16 a[184:185], v2
  v_mfma_f32_16x16x32_bf16 v[84:87], a[204:207], v[48:51], v[84:87]
  ds_read_b64_tr_b16 a[186:187], v2 offset:2048
  v_mfma_f32_16x16x32_bf16 v[88:91], a[208:211], v[48:51], v[88:91]
  ds_read_b64_tr_b16 a[188:189], v2 offset:8
  v_mfma_f32_16x16x32_bf16 v[92:95], a[212:215], v[48:51], v[92:95]
  ds_read_b64_tr_b16 a[190:191], v2 offset:2056
  v_mfma_f32_16x16x32_bf16 v[112:115], a[200:203], v[52:55], v[112:115]
  ds_read_b128 v[48:51], v6
  v_mfma_f32_16x16x32_bf16 v[116:119], a[204:207], v[52:55], v[116:119]
  s_add_u32 m0, s41, 49152
  ds_read_b64_tr_b16 a[192:193], v3
  v_mfma_f32_16x16x32_bf16 v[120:123], a[208:211], v[52:55], v[120:123]
  buffer_load_dwordx4 v7, s[8:11], s33 offen lds
  v_mfma_f32_16x16x32_bf16 v[124:127], a[212:215], v[52:55], v[124:127]
  ds_read_b64_tr_b16 a[194:195], v3 offset:2048
  v_mfma_f32_16x16x32_bf16 v[144:147], a[200:203], v[56:59], v[144:147]
  ds_read_b128 v[52:55], v6 offset:1024
  v_mfma_f32_16x16x32_bf16 v[148:151], a[204:207], v[56:59], v[148:151]
  ds_read_b64_tr_b16 a[196:197], v3 offset:8
  v_mfma_f32_16x16x32_bf16 v[152:155], a[208:211], v[56:59], v[152:155]
  buffer_load_dwordx4 v8, s[8:11], s33 offen offset:1024 lds
  v_mfma_f32_16x16x32_bf16 v[156:159], a[212:215], v[56:59], v[156:159]
  ds_read_b64_tr_b16 a[198:199], v3 offset:2056
  v_mfma_f32_16x16x32_bf16 v[176:179], a[200:203], v[60:63], v[176:179]
  ds_read_b128 v[56:59], v6 offset:2048
  v_mfma_f32_16x16x32_bf16 v[180:183], a[204:207], v[60:63], v[180:183]
  ds_read_b128 v[248:251], v14
  v_mfma_f32_16x16x32_bf16 v[184:187], a[208:211], v[60:63], v[184:187]
  buffer_load_dwordx4 v9, s[8:11], s33 offen offset:2048 lds
  v_mfma_f32_16x16x32_bf16 v[188:191], a[212:215], v[60:63], v[188:191]
  s_waitcnt lgkmcnt(7)
  v_mfma_f32_16x16x32_bf16 v[64:67], a[184:187], v[48:51], v[64:67]
  ds_read_b128 v[60:63], v6 offset:3072
  v_mfma_f32_16x16x32_bf16 v[68:71], a[188:191], v[48:51], v[68:71]
  s_waitcnt lgkmcnt(6)
  ds_read_b64_tr_b16 a[200:201], v4
  v_mfma_f32_16x16x32_bf16 v[72:75], a[192:195], v[48:51], v[72:75]
  s_waitcnt lgkmcnt(4)
  buffer_load_dwordx4 v10, s[8:11], s33 offen offset:3072 lds
  v_mfma_f32_16x16x32_bf16 v[76:79], a[196:199], v[48:51], v[76:79]
  s_add_u32 s33, s33, 262144
  ds_read_b64_tr_b16 a[202:203], v4 offset:2048
  v_mfma_f32_16x16x32_bf16 v[96:99], a[184:187], v[52:55], v[96:99]
  s_and_b32 s33, s33, 0x3fffff
  ds_read_b64_tr_b16 a[204:205], v4 offset:8
  v_mfma_f32_16x16x32_bf16 v[100:103], a[188:191], v[52:55], v[100:103]
  s_add_u32 m0, s42, 27648
  ds_read_b64_tr_b16 a[206:207], v4 offset:2056
  v_mfma_f32_16x16x32_bf16 v[104:107], a[192:195], v[52:55], v[104:107]
  buffer_load_dwordx4 v11, s[4:7], s32 offen lds
  v_mfma_f32_16x16x32_bf16 v[108:111], a[196:199], v[52:55], v[108:111]
  s_waitcnt lgkmcnt(6)
  ds_read_b64_tr_b16 a[208:209], v5
  v_mfma_f32_16x16x32_bf16 v[128:131], a[184:187], v[56:59], v[128:131]
  ds_read_b64_tr_b16 a[210:211], v5 offset:2048
  v_mfma_f32_16x16x32_bf16 v[132:135], a[188:191], v[56:59], v[132:135]
  ds_read_b64_tr_b16 a[212:213], v5 offset:8
  v_mfma_f32_16x16x32_bf16 v[136:139], a[192:195], v[56:59], v[136:139]
  buffer_load_dwordx4 v12, s[4:7], s32 offen offset:1024 lds
  v_mfma_f32_16x16x32_bf16 v[140:143], a[196:199], v[56:59], v[140:143]
  s_waitcnt lgkmcnt(7)
  ds_read_b64_tr_b16 a[214:215], v5 offset:2056
  v_mfma_f32_16x16x32_bf16 v[160:163], a[184:187], v[60:63], v[160:163]
  s_add_u32 m0, s38, 27648
  v_mfma_f32_16x16x32_bf16 v[164:167], a[188:191], v[60:63], v[164:167]
  s_mov_b64 exec, 0xffff
  buffer_load_dwordx4 v13, s[4:7], s32 offen lds
  s_mov_b64 exec, -1
  v_mfma_f32_16x16x32_bf16 v[168:171], a[192:195], v[60:63], v[168:171]
  s_add_u32 s32, s32, 64
  v_mfma_f32_16x16x32_bf16 v[172:175], a[196:199], v[60:63], v[172:175]
  s_and_b32 s32, s32, 0xfffffbff
  v_mfma_f32_16x16x32_bf16 v[192:195], a[184:187], v[248:251], v[192:195]
  v_mfma_f32_16x16x32_bf16 v[196:199], a[188:191], v[248:251], v[196:199]
  s_waitcnt vmcnt(14) lgkmcnt(0)
  v_mfma_f32_16x16x32_bf16 v[200:203], a[192:195], v[248:251], v[200:203]
  s_barrier
  v_mfma_f32_16x16x32_bf16 v[204:207], a[196:199], v[248:251], v[204:207]
  v_mfma_f32_16x16x32_bf16 v[80:83], a[200:203], v[48:51], v[80:83]
  ds_read_b64_tr_b16 a[184:185], v2 offset:16384
  v_mfma_f32_16x16x32_bf16 v[84:87], a[204:207], v[48:51], v[84:87]
  ds_read_b64_tr_b16 a[186:187], v2 offset:18432
  v_mfma_f32_16x16x32_bf16 v[88:91], a[208:211], v[48:51], v[88:91]
  ds_read_b64_tr_b16 a[188:189], v2 offset:16392
  v_mfma_f32_16x16x32_bf16 v[92:95], a[212:215], v[48:51], v[92:95]
  ds_read_b64_tr_b16 a[190:191], v2 offset:18440
  v_mfma_f32_16x16x32_bf16 v[112:115], a[200:203], v[52:55], v[112:115]
  ds_read_b128 v[48:51], v6 offset:9216
  v_mfma_f32_16x16x32_bf16 v[116:119], a[204:207], v[52:55], v[116:119]
  s_add_u32 m0, s48, 16384
  s_add_u32 s51, s43, 8192
  ds_read_b64_tr_b16 a[192:193], v3 offset:16384
  v_mfma_f32_16x16x32_bf16 v[120:123], a[208:211], v[52:55], v[120:123]
  buffer_load_dwordx4 v20, s[16:19], s51 offen nt lds
  v_mfma_f32_16x16x32_bf16 v[124:127], a[212:215], v[52:55], v[124:127]
  ds_read_b64_tr_b16 a[194:195], v3 offset:18432
  v_mfma_f32_16x16x32_bf16 v[144:147], a[200:203], v[56:59], v[144:147]
  ds_read_b128 v[52:55], v6 offset:10240
  v_mfma_f32_16x16x32_bf16 v[148:151], a[204:207], v[56:59], v[148:151]
  ds_read_b64_tr_b16 a[196:197], v3 offset:16392
  v_mfma_f32_16x16x32_bf16 v[152:155], a[208:211], v[56:59], v[152:155]
  buffer_load_dwordx4 v21, s[16:19], s51 offen offset:1024 nt lds
  v_mfma_f32_16x16x32_bf16 v[156:159], a[212:215], v[56:59], v[156:159]
  ds_read_b64_tr_b16 a[198:199], v3 offset:18440
  v_mfma_f32_16x16x32_bf16 v[176:179], a[200:203], v[60:63], v[176:179]
  ds_read_b128 v[56:59], v6 offset:11264
  v_mfma_f32_16x16x32_bf16 v[180:183], a[204:207], v[60:63], v[180:183]
  ds_read_b128 v[248:251], v14 offset:9216
  v_mfma_f32_16x16x32_bf16 v[184:187], a[208:211], v[60:63], v[184:187]
  buffer_load_dwordx4 v20, s[16:19], s51 offen offset:2048 nt lds
  v_mfma_f32_16x16x32_bf16 v[188:191], a[212:215], v[60:63], v[188:191]
  s_waitcnt lgkmcnt(7)
  v_mfma_f32_16x16x32_bf16 v[64:67], a[184:187], v[48:51], v[64:67]
  ds_read_b128 v[60:63], v6 offset:12288
  v_mfma_f32_16x16x32_bf16 v[68:71], a[188:191], v[48:51], v[68:71]
  s_waitcnt lgkmcnt(6)
  ds_read_b64_tr_b16 a[200:201], v4 offset:16384
  v_mfma_f32_16x16x32_bf16 v[72:75], a[192:195], v[48:51], v[72:75]
  s_waitcnt lgkmcnt(4)
  buffer_load_dwordx4 v21, s[16:19], s51 offen offset:3072 nt lds
  v_mfma_f32_16x16x32_bf16 v[76:79], a[196:199], v[48:51], v[76:79]
  ds_read_b64_tr_b16 a[202:203], v4 offset:18432
  v_mfma_f32_16x16x32_bf16 v[96:99], a[184:187], v[52:55], v[96:99]
  ds_read_b64_tr_b16 a[204:205], v4 offset:16392
  v_mfma_f32_16x16x32_bf16 v[100:103], a[188:191], v[52:55], v[100:103]
  ds_read_b64_tr_b16 a[206:207], v4 offset:18440
  v_mfma_f32_16x16x32_bf16 v[104:107], a[192:195], v[52:55], v[104:107]
  v_mfma_f32_16x16x32_bf16 v[108:111], a[196:199], v[52:55], v[108:111]
  s_waitcnt lgkmcnt(6)
  ds_read_b64_tr_b16 a[208:209], v5 offset:16384
  v_mfma_f32_16x16x32_bf16 v[128:131], a[184:187], v[56:59], v[128:131]
  ds_read_b64_tr_b16 a[210:211], v5 offset:18432
  v_mfma_f32_16x16x32_bf16 v[132:135], a[188:191], v[56:59], v[132:135]
  ds_read_b64_tr_b16 a[212:213], v5 offset:16392
  v_mfma_f32_16x16x32_bf16 v[136:139], a[192:195], v[56:59], v[136:139]
  v_mfma_f32_16x16x32_bf16 v[140:143], a[196:199], v[56:59], v[140:143]
  s_waitcnt lgkmcnt(7)
  ds_read_b64_tr_b16 a[214:215], v5 offset:18440
  v_mfma_f32_16x16x32_bf16 v[160:163], a[184:187], v[60:63], v[160:163]
  v_mfma_f32_16x16x32_bf16 v[164:167], a[188:191], v[60:63], v[164:167]
  v_mfma_f32_16x16x32_bf16 v[168:171], a[192:195], v[60:63], v[168:171]
  v_mfma_f32_16x16x32_bf16 v[172:175], a[196:199], v[60:63], v[172:175]
  v_mfma_f32_16x16x32_bf16 v[192:195], a[184:187], v[248:251], v[192:195]
  v_mfma_f32_16x16x32_bf16 v[196:199], a[188:191], v[248:251], v[196:199]
  s_waitcnt vmcnt(11) lgkmcnt(0)
  v_mfma_f32_16x16x32_bf16 v[200:203], a[192:195], v[248:251], v[200:203]
  s_barrier
  v_mfma_f32_16x16x32_bf16 v[204:207], a[196:199], v[248:251], v[204:207]
  v_mfma_f32_16x16x32_bf16 v[80:83], a[200:203], v[48:51], v[80:83]
  ds_read_b64_tr_b16 a[184:185], v2 offset:32768
  v_mfma_f32_16x16x32_bf16 v[84:87], a[204:207], v[48:51], v[84:87]
  ds_read_b64_tr_b16 a[186:187], v2 offset:34816
  v_mfma_f32_16x16x32_bf16 v[88:91], a[208:211], v[48:51], v[88:91]
  ds_read_b64_tr_b16 a[188:189], v2 offset:32776
  v_mfma_f32_16x16x32_bf16 v[92:95], a[212:215], v[48:51], v[92:95]
  ds_read_b64_tr_b16 a[190:191], v2 offset:34824
  v_mfma_f32_16x16x32_bf16 v[112:115], a[200:203], v[52:55], v[112:115]
  ds_read_b128 v[48:51], v6 offset:18432
  v_mfma_f32_16x16x32_bf16 v[116:119], a[204:207], v[52:55], v[116:119]
  s_add_u32 m0, s47, 49152
  s_add_u32 s51, s43, 16384
  ds_read_b64_tr_b16 a[192:193], v3 offset:32768
  v_mfma_f32_16x16x32_bf16 v[120:123], a[208:211], v[52:55], v[120:123]
  buffer_load_dwordx4 v16, s[12:15], s51 offen nt lds
  v_mfma_f32_16x16x32_bf16 v[124:127], a[212:215], v[52:55], v[124:127]
  ds_read_b64_tr_b16 a[194:195], v3 offset:34816
  v_mfma_f32_16x16x32_bf16 v[144:147], a[200:203], v[56:59], v[144:147]
  ds_read_b128 v[52:55], v6 offset:19456
  v_mfma_f32_16x16x32_bf16 v[148:151], a[204:207], v[56:59], v[148:151]
  ds_read_b64_tr_b16 a[196:197], v3 offset:32776
  v_mfma_f32_16x16x32_bf16 v[152:155], a[208:211], v[56:59], v[152:155]
  buffer_load_dwordx4 v17, s[12:15], s51 offen offset:1024 nt lds
  v_mfma_f32_16x16x32_bf16 v[156:159], a[212:215], v[56:59], v[156:159]
  ds_read_b64_tr_b16 a[198:199], v3 offset:34824
  v_mfma_f32_16x16x32_bf16 v[176:179], a[200:203], v[60:63], v[176:179]
  ds_read_b128 v[56:59], v6 offset:20480
  v_mfma_f32_16x16x32_bf16 v[180:183], a[204:207], v[60:63], v[180:183]
  ds_read_b128 v[248:251], v14 offset:18432
  v_mfma_f32_16x16x32_bf16 v[184:187], a[208:211], v[60:63], v[184:187]
  buffer_load_dwordx4 v18, s[12:15], s51 offen offset:2048 nt lds
  v_mfma_f32_16x16x32_bf16 v[188:191], a[212:215], v[60:63], v[188:191]
  s_waitcnt lgkmcnt(7)
  v_mfma_f32_16x16x32_bf16 v[64:67], a[184:187], v[48:51], v[64:67]
  ds_read_b128 v[60:63], v6 offset:21504
  v_mfma_f32_16x16x32_bf16 v[68:71], a[188:191], v[48:51], v[68:71]
  s_waitcnt lgkmcnt(6)
  ds_read_b64_tr_b16 a[200:201], v4 offset:32768
  v_mfma_f32_16x16x32_bf16 v[72:75], a[192:195], v[48:51], v[72:75]
  s_waitcnt lgkmcnt(4)
  buffer_load_dwordx4 v19, s[12:15], s51 offen offset:3072 nt lds
  v_mfma_f32_16x16x32_bf16 v[76:79], a[196:199], v[48:51], v[76:79]
  ds_read_b64_tr_b16 a[202:203], v4 offset:34816
  v_mfma_f32_16x16x32_bf16 v[96:99], a[184:187], v[52:55], v[96:99]
  ds_read_b64_tr_b16 a[204:205], v4 offset:32776
  v_mfma_f32_16x16x32_bf16 v[100:103], a[188:191], v[52:55], v[100:103]
  s_add_u32 m0, s48, 32768
  s_add_u32 s51, s43, 16384
  ds_read_b64_tr_b16 a[206:207], v4 offset:34824
  v_mfma_f32_16x16x32_bf16 v[104:107], a[192:195], v[52:55], v[104:107]
  buffer_load_dwordx4 v20, s[16:19], s51 offen nt lds
  v_mfma_f32_16x16x32_bf16 v[108:111], a[196:199], v[52:55], v[108:111]
  s_waitcnt lgkmcnt(6)
  ds_read_b64_tr_b16 a[208:209], v5 offset:32768
  v_mfma_f32_16x16x32_bf16 v[128:131], a[184:187], v[56:59], v[128:131]
  ds_read_b64_tr_b16 a[210:211], v5 offset:34816
  v_mfma_f32_16x16x32_bf16 v[132:135], a[188:191], v[56:59], v[132:135]
  ds_read_b64_tr_b16 a[212:213], v5 offset:32776
  v_mfma_f32_16x16x32_bf16 v[136:139], a[192:195], v[56:59], v[136:139]
  buffer_load_dwordx4 v21, s[16:19], s51 offen offset:1024 nt lds
  v_mfma_f32_16x16x32_bf16 v[140:143], a[196:199], v[56:59], v[140:143]
  s_waitcnt lgkmcnt(7)
  ds_read_b64_tr_b16 a[214:215], v5 offset:34824
  v_mfma_f32_16x16x32_bf16 v[160:163], a[184:187], v[60:63], v[160:163]
  v_mfma_f32_16x16x32_bf16 v[164:167], a[188:191], v[60:63], v[164:167]
  v_mfma_f32_16x16x32_bf16 v[168:171], a[192:195], v[60:63], v[168:171]
  buffer_load_dwordx4 v20, s[16:19], s51 offen offset:2048 nt lds
  v_mfma_f32_16x16x32_bf16 v[172:175], a[196:199], v[60:63], v[172:175]
  v_mfma_f32_16x16x32_bf16 v[192:195], a[184:187], v[248:251], v[192:195]
  buffer_load_dwordx4 v21, s[16:19], s51 offen offset:3072 nt lds
  v_mfma_f32_16x16x32_bf16 v[196:199], a[188:191], v[248:251], v[196:199]
  s_waitcnt vmcnt(12) lgkmcnt(0)
  v_mfma_f32_16x16x32_bf16 v[200:203], a[192:195], v[248:251], v[200:203]
  s_barrier
  v_mfma_f32_16x16x32_bf16 v[204:207], a[196:199], v[248:251], v[204:207]
  v_mfma_f32_16x16x32_bf16 v[80:83], a[200:203], v[48:51], v[80:83]
  ds_read_b64_tr_b16 a[184:185], v2 offset:49152
  v_mfma_f32_16x16x32_bf16 v[84:87], a[204:207], v[48:51], v[84:87]
  ds_read_b64_tr_b16 a[186:187], v2 offset:51200
  v_mfma_f32_16x16x32_bf16 v[88:91], a[208:211], v[48:51], v[88:91]
  ds_read_b64_tr_b16 a[188:189], v2 offset:49160
  v_mfma_f32_16x16x32_bf16 v[92:95], a[212:215], v[48:51], v[92:95]
  ds_read_b64_tr_b16 a[190:191], v2 offset:51208
  v_mfma_f32_16x16x32_bf16 v[112:115], a[200:203], v[52:55], v[112:115]
  ds_read_b128 v[48:51], v6 offset:27648
  v_mfma_f32_16x16x32_bf16 v[116:119], a[204:207], v[52:55], v[116:119]
  ds_read_b64_tr_b16 a[192:193], v3 offset:49152
  v_mfma_f32_16x16x32_bf16 v[120:123], a[208:211], v[52:55], v[120:123]
  v_mfma_f32_16x16x32_bf16 v[124:127], a[212:215], v[52:55], v[124:127]
  ds_read_b64_tr_b16 a[194:195], v3 offset:51200
  v_mfma_f32_16x16x32_bf16 v[144:147], a[200:203], v[56:59], v[144:147]
  ds_read_b128 v[52:55], v6 offset:28672
  v_mfma_f32_16x16x32_bf16 v[148:151], a[204:207], v[56:59], v[148:151]
  ds_read_b64_tr_b16 a[196:197], v3 offset:49160
  v_mfma_f32_16x16x32_bf16 v[152:155], a[208:211], v[56:59], v[152:155]
  v_mfma_f32_16x16x32_bf16 v[156:159], a[212:215], v[56:59], v[156:159]
  ds_read_b64_tr_b16 a[198:199], v3 offset:51208
  v_mfma_f32_16x16x32_bf16 v[176:179], a[200:203], v[60:63], v[176:179]
  ds_read_b128 v[56:59], v6 offset:29696
  v_mfma_f32_16x16x32_bf16 v[180:183], a[204:207], v[60:63], v[180:183]
  ds_read_b128 v[248:251], v14 offset:27648
  v_mfma_f32_16x16x32_bf16 v[184:187], a[208:211], v[60:63], v[184:187]
  v_mfma_f32_16x16x32_bf16 v[188:191], a[212:215], v[60:63], v[188:191]
  s_waitcnt lgkmcnt(7)
  v_mfma_f32_16x16x32_bf16 v[64:67], a[184:187], v[48:51], v[64:67]
  ds_read_b128 v[60:63], v6 offset:30720
  v_mfma_f32_16x16x32_bf16 v[68:71], a[188:191], v[48:51], v[68:71]
  s_waitcnt lgkmcnt(6)
  ds_read_b64_tr_b16 a[200:201], v4 offset:49152
  v_mfma_f32_16x16x32_bf16 v[72:75], a[192:195], v[48:51], v[72:75]
  s_waitcnt lgkmcnt(4)
  v_mfma_f32_16x16x32_bf16 v[76:79], a[196:199], v[48:51], v[76:79]
  ds_read_b64_tr_b16 a[202:203], v4 offset:51200
  v_mfma_f32_16x16x32_bf16 v[96:99], a[184:187], v[52:55], v[96:99]
  ds_read_b64_tr_b16 a[204:205], v4 offset:49160
  v_mfma_f32_16x16x32_bf16 v[100:103], a[188:191], v[52:55], v[100:103]
  ds_read_b64_tr_b16 a[206:207], v4 offset:51208
  v_mfma_f32_16x16x32_bf16 v[104:107], a[192:195], v[52:55], v[104:107]
  v_mfma_f32_16x16x32_bf16 v[108:111], a[196:199], v[52:55], v[108:111]
  s_waitcnt lgkmcnt(6)
  ds_read_b64_tr_b16 a[208:209], v5 offset:49152
  v_mfma_f32_16x16x32_bf16 v[128:131], a[184:187], v[56:59], v[128:131]
  ds_read_b64_tr_b16 a[210:211], v5 offset:51200
  v_mfma_f32_16x16x32_bf16 v[132:135], a[188:191], v[56:59], v[132:135]
  ds_read_b64_tr_b16 a[212:213], v5 offset:49160
  v_mfma_f32_16x16x32_bf16 v[136:139], a[192:195], v[56:59], v[136:139]
  v_mfma_f32_16x16x32_bf16 v[140:143], a[196:199], v[56:59], v[140:143]
  s_waitcnt lgkmcnt(7)
  ds_read_b64_tr_b16 a[214:215], v5 offset:51208
  v_mfma_f32_16x16x32_bf16 v[160:163], a[184:187], v[60:63], v[160:163]
  v_mfma_f32_16x16x32_bf16 v[164:167], a[188:191], v[60:63], v[164:167]
  v_mfma_f32_16x16x32_bf16 v[168:171], a[192:195], v[60:63], v[168:171]
  v_mfma_f32_16x16x32_bf16 v[172:175], a[196:199], v[60:63], v[172:175]
  v_mfma_f32_16x16x32_bf16 v[192:195], a[184:187], v[248:251], v[192:195]
  v_mfma_f32_16x16x32_bf16 v[196:199], a[188:191], v[248:251], v[196:199]
  s_waitcnt vmcnt(12) lgkmcnt(0)
  v_mfma_f32_16x16x32_bf16 v[200:203], a[192:195], v[248:251], v[200:203]
  s_barrier
  v_mfma_f32_16x16x32_bf16 v[204:207], a[196:199], v[248:251], v[204:207]
  s_add_u32 s45, s43, 40960
  s_add_u32 s46, s43, 32768
  v_mov_b32 v244, 0x3e0293ee
  v_mov_b32 v245, 0x3e0293ee
  s_lshl_b32 s50, s28, 11
  s_add_u32 s50, s50, 155648
  v_lshlrev_b32 v7, 4, v1
  v_add_u32 v8, s50, v7
  s_xor_b32 s50, s50, 2048
  v_add_u32 v9, s50, v7
  ds_read_b128 a[216:219], v22 offset:16384
  ds_read_b128 a[220:223], v23 offset:16384
  ds_read_b128 a[224:227], v24 offset:16384
  ds_read_b128 a[228:231], v25 offset:16384
  ds_read_b128 a[232:235], v22 offset:20480
  ds_read_b128 a[236:239], v23 offset:20480
  ds_read_b128 a[240:243], v24 offset:20480
  ds_read_b128 a[244:247], v25 offset:20480
  s_nop 3
  v_pk_mul_f32 v[64:65], v[64:65], v[244:245]
  v_pk_mul_f32 v[66:67], v[66:67], v[244:245]
  v_pk_mul_f32 v[68:69], v[68:69], v[244:245]
  v_pk_mul_f32 v[70:71], v[70:71], v[244:245]
  v_pk_mul_f32 v[96:97], v[96:97], v[244:245]
  v_pk_mul_f32 v[98:99], v[98:99], v[244:245]
  v_pk_mul_f32 v[100:101], v[100:101], v[244:245]
  v_pk_mul_f32 v[102:103], v[102:103], v[244:245]
  v_pk_mul_f32 v[128:129], v[128:129], v[244:245]
  v_pk_mul_f32 v[130:131], v[130:131], v[244:245]
  v_pk_mul_f32 v[132:133], v[132:133], v[244:245]
  v_pk_mul_f32 v[134:135], v[134:135], v[244:245]
  v_pk_mul_f32 v[160:161], v[160:161], v[244:245]
  v_pk_mul_f32 v[162:163], v[162:163], v[244:245]
  v_pk_mul_f32 v[164:165], v[164:165], v[244:245]
  v_pk_mul_f32 v[166:167], v[166:167], v[244:245]
  v_pk_mul_f32 v[192:193], v[192:193], v[244:245]
  v_pk_mul_f32 v[194:195], v[194:195], v[244:245]
  v_pk_mul_f32 v[196:197], v[196:197], v[244:245]
  v_pk_mul_f32 v[198:199], v[198:199], v[244:245]
  v_pk_mul_f32 v[72:73], v[72:73], v[244:245]
  v_pk_mul_f32 v[74:75], v[74:75], v[244:245]
  v_pk_mul_f32 v[76:77], v[76:77], v[244:245]
  v_pk_mul_f32 v[78:79], v[78:79], v[244:245]
  v_pk_mul_f32 v[104:105], v[104:105], v[244:245]
  v_pk_mul_f32 v[106:107], v[106:107], v[244:245]
  v_pk_mul_f32 v[108:109], v[108:109], v[244:245]
  v_pk_mul_f32 v[110:111], v[110:111], v[244:245]
  v_pk_mul_f32 v[136:137], v[136:137], v[244:245]
  v_pk_mul_f32 v[138:139], v[138:139], v[244:245]
  v_pk_mul_f32 v[140:141], v[140:141], v[244:245]
  v_pk_mul_f32 v[142:143], v[142:143], v[244:245]
  v_pk_mul_f32 v[168:169], v[168:169], v[244:245]
  v_pk_mul_f32 v[170:171], v[170:171], v[244:245]
  v_pk_mul_f32 v[172:173], v[172:173], v[244:245]
  v_pk_mul_f32 v[174:175], v[174:175], v[244:245]
  v_pk_mul_f32 v[200:201], v[200:201], v[244:245]
  v_pk_mul_f32 v[202:203], v[202:203], v[244:245]
  v_pk_mul_f32 v[204:205], v[204:205], v[244:245]
  v_pk_mul_f32 v[206:207], v[206:207], v[244:245]
  v_mfma_f32_16x16x32_bf16 v[80:83], a[200:203], v[48:51], v[80:83]
  v_cvt_pk_bf16_f32 v192, v192, v193
  v_cvt_pk_bf16_f32 v193, v194, v195
  v_cvt_pk_bf16_f32 v194, v196, v197
  v_mfma_f32_16x16x32_bf16 v[84:87], a[204:207], v[48:51], v[84:87]
  v_cvt_pk_bf16_f32 v195, v198, v199
  v_cvt_pk_bf16_f32 v200, v200, v201
  v_mfma_f32_16x16x32_bf16 v[88:91], a[208:211], v[48:51], v[88:91]
  v_cvt_pk_bf16_f32 v201, v202, v203
  v_cvt_pk_bf16_f32 v202, v204, v205
  v_cvt_pk_bf16_f32 v203, v206, v207
  v_mfma_f32_16x16x32_bf16 v[92:95], a[212:215], v[48:51], v[92:95]
  v_cvt_pk_bf16_f32 v64, v64, v65
  v_cvt_pk_bf16_f32 v65, v66, v67
  v_mfma_f32_16x16x32_bf16 v[112:115], a[200:203], v[52:55], v[112:115]
  v_cvt_pk_bf16_f32 v66, v68, v69
  v_cvt_pk_bf16_f32 v67, v70, v71
  v_cvt_pk_bf16_f32 v96, v96, v97
  v_mfma_f32_16x16x32_bf16 v[116:119], a[204:207], v[52:55], v[116:119]
  ds_write_b128 v8, v[192:195]
  v_cvt_pk_bf16_f32 v97, v98, v99
  v_cvt_pk_bf16_f32 v98, v100, v101
  v_mfma_f32_16x16x32_bf16 v[120:123], a[208:211], v[52:55], v[120:123]
  v_cvt_pk_bf16_f32 v99, v102, v103
  v_cvt_pk_bf16_f32 v128, v128, v129
  v_cvt_pk_bf16_f32 v129, v130, v131
  v_mfma_f32_16x16x32_bf16 v[124:127], a[212:215], v[52:55], v[124:127]
  ds_write_b128 v8, v[200:203] offset:1024
  v_cvt_pk_bf16_f32 v130, v132, v133
  v_cvt_pk_bf16_f32 v131, v134, v135
  v_mfma_f32_16x16x32_bf16 v[144:147], a[200:203], v[56:59], v[144:147]
  v_cvt_pk_bf16_f32 v160, v160, v161
  v_cvt_pk_bf16_f32 v161, v162, v163
  v_cvt_pk_bf16_f32 v162, v164, v165
  v_mfma_f32_16x16x32_bf16 v[148:151], a[204:207], v[56:59], v[148:151]
  v_cvt_pk_bf16_f32 v163, v166, v167
  v_cvt_pk_bf16_f32 v72, v72, v73
  v_mfma_f32_16x16x32_bf16 v[152:155], a[208:211], v[56:59], v[152:155]
  v_cvt_pk_bf16_f32 v73, v74, v75
  v_cvt_pk_bf16_f32 v74, v76, v77
  v_cvt_pk_bf16_f32 v75, v78, v79
  v_mfma_f32_16x16x32_bf16 v[156:159], a[212:215], v[56:59], v[156:159]
  v_cvt_pk_bf16_f32 v104, v104, v105
  v_cvt_pk_bf16_f32 v105, v106, v107
  v_mfma_f32_16x16x32_bf16 v[176:179], a[200:203], v[60:63], v[176:179]
  v_cvt_pk_bf16_f32 v106, v108, v109
  v_cvt_pk_bf16_f32 v107, v110, v111
  v_cvt_pk_bf16_f32 v136, v136, v137
  v_mfma_f32_16x16x32_bf16 v[180:183], a[204:207], v[60:63], v[180:183]
  v_cvt_pk_bf16_f32 v137, v138, v139
  v_cvt_pk_bf16_f32 v138, v140, v141
  v_mfma_f32_16x16x32_bf16 v[184:187], a[208:211], v[60:63], v[184:187]
  v_cvt_pk_bf16_f32 v139, v142, v143
  v_cvt_pk_bf16_f32 v168, v168, v169
  v_cvt_pk_bf16_f32 v169, v170, v171
  v_mfma_f32_16x16x32_bf16 v[188:191], a[212:215], v[60:63], v[188:191]
  v_cvt_pk_bf16_f32 v170, v172, v173
  v_cvt_pk_bf16_f32 v171, v174, v175
  s_waitcnt lgkmcnt(0)
  s_barrier
  ds_read_b128 v[208:211], v9
  ds_read_b128 v[216:219], v9 offset:1024
  s_nop 3
  s_add_u32 m0, s47, 0
  s_add_u32 s51, s43, 24576
  v_pk_mul_f32 v[80:81], v[80:81], v[244:245]
  v_pk_mul_f32 v[82:83], v[82:83], v[244:245]
  v_pk_mul_f32 v[84:85], v[84:85], v[244:245]
  v_pk_mul_f32 v[86:87], v[86:87], v[244:245]
  v_pk_mul_f32 v[112:113], v[112:113], v[244:245]
  v_pk_mul_f32 v[114:115], v[114:115], v[244:245]
  v_pk_mul_f32 v[116:117], v[116:117], v[244:245]
  v_pk_mul_f32 v[118:119], v[118:119], v[244:245]
  buffer_load_dwordx4 v16, s[12:15], s51 offen nt lds
  v_pk_mul_f32 v[144:145], v[144:145], v[244:245]
  v_pk_mul_f32 v[146:147], v[146:147], v[244:245]
  v_pk_mul_f32 v[148:149], v[148:149], v[244:245]
  v_pk_mul_f32 v[150:151], v[150:151], v[244:245]
  v_pk_mul_f32 v[176:177], v[176:177], v[244:245]
  v_pk_mul_f32 v[178:179], v[178:179], v[244:245]
  v_pk_mul_f32 v[180:181], v[180:181], v[244:245]
  v_pk_mul_f32 v[182:183], v[182:183], v[244:245]
  buffer_load_dwordx4 v17, s[12:15], s51 offen offset:1024 nt lds
  v_pk_mul_f32 v[88:89], v[88:89], v[244:245]
  v_pk_mul_f32 v[90:91], v[90:91], v[244:245]
  v_pk_mul_f32 v[92:93], v[92:93], v[244:245]
  v_pk_mul_f32 v[94:95], v[94:95], v[244:245]
  v_pk_mul_f32 v[120:121], v[120:121], v[244:245]
  v_pk_mul_f32 v[122:123], v[122:123], v[244:245]
  v_pk_mul_f32 v[124:125], v[124:125], v[244:245]
  v_pk_mul_f32 v[126:127], v[126:127], v[244:245]
  buffer_load_dwordx4 v18, s[12:15], s51 offen offset:2048 nt lds
  v_pk_mul_f32 v[152:153], v[152:153], v[244:245]
  v_pk_mul_f32 v[154:155], v[154:155], v[244:245]
  v_pk_mul_f32 v[156:157], v[156:157], v[244:245]
  v_pk_mul_f32 v[158:159], v[158:159], v[244:245]
  v_pk_mul_f32 v[184:185], v[184:185], v[244:245]
  v_pk_mul_f32 v[186:187], v[186:187], v[244:245]
  v_pk_mul_f32 v[188:189], v[188:189], v[244:245]
  v_pk_mul_f32 v[190:191], v[190:191], v[244:245]
  buffer_load_dwordx4 v19, s[12:15], s51 offen offset:3072 nt lds
  v_mfma_f32_16x16x32_bf16 v[68:71], a[216:219], v[64:67], 0
  v_cvt_pk_bf16_f32 v80, v80, v81
  v_cvt_pk_bf16_f32 v81, v82, v83
  v_cvt_pk_bf16_f32 v82, v84, v85
  v_cvt_pk_bf16_f32 v83, v86, v87
  v_mfma_f32_16x16x32_bf16 v[100:103], a[216:219], v[96:99], 0
  v_cvt_pk_bf16_f32 v112, v112, v113
  v_cvt_pk_bf16_f32 v113, v114, v115
  v_cvt_pk_bf16_f32 v114, v116, v117
  v_mfma_f32_16x16x32_bf16 v[132:135], a[216:219], v[128:131], 0
  v_cvt_pk_bf16_f32 v115, v118, v119
  v_cvt_pk_bf16_f32 v144, v144, v145
  v_cvt_pk_bf16_f32 v145, v146, v147
  v_mfma_f32_16x16x32_bf16 v[164:167], a[216:219], v[160:163], 0
  v_cvt_pk_bf16_f32 v146, v148, v149
  v_cvt_pk_bf16_f32 v147, v150, v151
  v_cvt_pk_bf16_f32 v176, v176, v177
  v_mfma_f32_16x16x32_bf16 v[196:199], a[216:219], v[192:195], 0
  v_cvt_pk_bf16_f32 v177, v178, v179
  v_cvt_pk_bf16_f32 v178, v180, v181
  v_cvt_pk_bf16_f32 v179, v182, v183
  v_mfma_f32_16x16x32_bf16 v[68:71], a[220:223], v[72:75], v[68:71]
  v_cvt_pk_bf16_f32 v88, v88, v89
  v_cvt_pk_bf16_f32 v89, v90, v91
  v_cvt_pk_bf16_f32 v90, v92, v93
  v_cvt_pk_bf16_f32 v91, v94, v95
  v_mfma_f32_16x16x32_bf16 v[100:103], a[220:223], v[104:107], v[100:103]
  v_cvt_pk_bf16_f32 v120, v120, v121
  v_cvt_pk_bf16_f32 v121, v122, v123
  v_cvt_pk_bf16_f32 v122, v124, v125
  v_mfma_f32_16x16x32_bf16 v[132:135], a[220:223], v[136:139], v[132:135]
  v_cvt_pk_bf16_f32 v123, v126, v127
  v_cvt_pk_bf16_f32 v152, v152, v153
  v_cvt_pk_bf16_f32 v153, v154, v155
  v_mfma_f32_16x16x32_bf16 v[164:167], a[220:223], v[168:171], v[164:167]
  v_cvt_pk_bf16_f32 v154, v156, v157
  v_cvt_pk_bf16_f32 v155, v158, v159
  v_cvt_pk_bf16_f32 v184, v184, v185
  v_mfma_f32_16x16x32_bf16 v[196:199], a[220:223], v[200:203], v[196:199]
  v_cvt_pk_bf16_f32 v185, v186, v187
  v_cvt_pk_bf16_f32 v186, v188, v189
  v_cvt_pk_bf16_f32 v187, v190, v191
  v_mfma_f32_16x16x32_bf16 v[68:71], a[224:227], v[80:83], v[68:71]
  v_mov_b32 v92, 0
  v_mov_b32 v93, 0
  v_mfma_f32_16x16x32_bf16 v[100:103], a[224:227], v[112:115], v[100:103]
  v_mov_b32 v94, 0
  v_mov_b32 v95, 0
  v_mfma_f32_16x16x32_bf16 v[132:135], a[224:227], v[144:147], v[132:135]
  v_mov_b32 v124, 0
  v_mov_b32 v125, 0
  v_mfma_f32_16x16x32_bf16 v[164:167], a[224:227], v[176:179], v[164:167]
  s_waitcnt lgkmcnt(1)
  v_mov_b32 v126, 0
  v_mov_b32 v127, 0
  v_mfma_f32_16x16x32_bf16 v[196:199], a[224:227], v[208:211], v[196:199]
  v_mov_b32 v156, 0
  v_mov_b32 v157, 0
  v_mfma_f32_16x16x32_bf16 v[68:71], a[228:231], v[88:91], v[68:71]
  v_mov_b32 v158, 0
  v_mov_b32 v159, 0
  v_mfma_f32_16x16x32_bf16 v[100:103], a[228:231], v[120:123], v[100:103]
  v_mov_b32 v188, 0
  v_mov_b32 v189, 0
  v_mfma_f32_16x16x32_bf16 v[132:135], a[228:231], v[152:155], v[132:135]
  v_mov_b32 v190, 0
  v_mov_b32 v191, 0
  v_mfma_f32_16x16x32_bf16 v[164:167], a[228:231], v[184:187], v[164:167]
  s_waitcnt lgkmcnt(0)
  v_mov_b32 v220, 0
  v_mov_b32 v221, 0
  v_mfma_f32_16x16x32_bf16 v[196:199], a[228:231], v[216:219], v[196:199]
  v_mov_b32 v222, 0
  v_mov_b32 v223, 0
  s_add_u32 m0, s48, 49152
  s_add_u32 s51, s43, 24576
  s_nop 0
  buffer_load_dwordx4 v20, s[16:19], s51 offen nt lds
  buffer_load_dwordx4 v21, s[16:19], s51 offen offset:1024 nt lds
  buffer_load_dwordx4 v20, s[16:19], s51 offen offset:2048 nt lds
  buffer_load_dwordx4 v21, s[16:19], s51 offen offset:3072 nt lds
  s_cmp_eq_u32 s61, 1
  s_cbranch_scc1 L_safe_max
  s_nop 5
  v_max3_f32 v2, v68, v69, v70
  v_max3_f32 v3, v100, v101, v102
  v_max3_f32 v4, v132, v133, v134
  v_max3_f32 v5, v164, v165, v166
  v_max3_f32 v6, v196, v197, v198
  v_max_f32 v2, v2, v71
  v_max_f32 v3, v3, v103
  v_max_f32 v4, v4, v135
  v_max_f32 v5, v5, v167
  v_max_f32 v6, v6, v199
  v_mov_b32 v7, v2
  v_mov_b32 v8, v3
  v_mov_b32 v9, v4
  v_mov_b32 v10, v5
  v_mov_b32 v11, v6
  v_permlane32_swap_b32 v2, v7
  v_permlane32_swap_b32 v3, v8
  v_permlane32_swap_b32 v4, v9
  v_permlane32_swap_b32 v5, v10
  v_permlane32_swap_b32 v6, v11
  v_max_f32 v2, v2, v7
  v_max_f32 v3, v3, v8
  v_max_f32 v4, v4, v9
  v_max_f32 v5, v5, v10
  v_max_f32 v6, v6, v11
  v_mov_b32 v7, v2
  v_mov_b32 v8, v3
  v_mov_b32 v9, v4
  v_mov_b32 v10, v5
  v_mov_b32 v11, v6
  v_permlane16_swap_b32 v2, v7
  v_permlane16_swap_b32 v3, v8
  v_permlane16_swap_b32 v4, v9
  v_permlane16_swap_b32 v5, v10
  v_permlane16_swap_b32 v6, v11
  v_max_f32 v2, v2, v7
  v_max_f32 v3, v3, v8
  v_max_f32 v4, v4, v9
  v_max_f32 v5, v5, v10
  v_max_f32 v6, v6, v11
  v_sub_f32 v224, 0, v2
  v_sub_f32 v225, 0, v2
  v_sub_f32 v226, 0, v2
  v_sub_f32 v227, 0, v2
  v_sub_f32 v228, 0, v3
  v_sub_f32 v229, 0, v3
  v_sub_f32 v230, 0, v3
  v_sub_f32 v231, 0, v3
  v_sub_f32 v232, 0, v4
  v_sub_f32 v233, 0, v4
  v_sub_f32 v234, 0, v4
  v_sub_f32 v235, 0, v4
  v_sub_f32 v236, 0, v5
  v_sub_f32 v237, 0, v5
  v_sub_f32 v238, 0, v5
  v_sub_f32 v239, 0, v5
  v_sub_f32 v240, 0, v6
  v_sub_f32 v241, 0, v6
  v_sub_f32 v242, 0, v6
  v_sub_f32 v243, 0, v6
  v_mfma_f32_16x16x32_bf16 v[76:79], a[232:235], v[64:67], v[224:227]
  v_add_f32 v68, v68, v224
  v_add_f32 v69, v69, v224
  v_mfma_f32_16x16x32_bf16 v[108:111], a[232:235], v[96:99], v[228:231]
  v_add_f32 v70, v70, v224
  v_add_f32 v71, v71, v224
  v_mfma_f32_16x16x32_bf16 v[140:143], a[232:235], v[128:131], v[232:235]
  v_add_f32 v100, v100, v228
  v_add_f32 v101, v101, v228
  v_exp_f32 v68, v68
  v_mfma_f32_16x16x32_bf16 v[172:175], a[232:235], v[160:163], v[236:239]
  v_add_f32 v102, v102, v228
  v_add_f32 v103, v103, v228
  v_exp_f32 v69, v69
  v_mfma_f32_16x16x32_bf16 v[204:207], a[232:235], v[192:195], v[240:243]
  v_add_f32 v132, v132, v232
  v_add_f32 v133, v133, v232
  v_exp_f32 v70, v70
  v_mfma_f32_16x16x32_bf16 v[76:79], a[236:239], v[72:75], v[76:79]
  v_add_f32 v134, v134, v232
  v_add_f32 v135, v135, v232
  v_exp_f32 v71, v71
  v_mfma_f32_16x16x32_bf16 v[108:111], a[236:239], v[104:107], v[108:111]
  v_add_f32 v164, v164, v236
  v_add_f32 v165, v165, v236
  v_exp_f32 v100, v100
  v_mfma_f32_16x16x32_bf16 v[140:143], a[236:239], v[136:139], v[140:143]
  v_add_f32 v166, v166, v236
  v_add_f32 v167, v167, v236
  v_exp_f32 v101, v101
  v_mfma_f32_16x16x32_bf16 v[172:175], a[236:239], v[168:171], v[172:175]
  v_add_f32 v196, v196, v240
  v_add_f32 v197, v197, v240
  v_exp_f32 v102, v102
  v_mfma_f32_16x16x32_bf16 v[204:207], a[236:239], v[200:203], v[204:207]
  v_add_f32 v198, v198, v240
  v_add_f32 v199, v199, v240
  v_exp_f32 v103, v103
  v_mfma_f32_16x16x32_bf16 v[76:79], a[240:243], v[80:83], v[76:79]
  v_exp_f32 v132, v132
  v_mfma_f32_16x16x32_bf16 v[108:111], a[240:243], v[112:115], v[108:111]
  v_exp_f32 v133, v133
  v_mfma_f32_16x16x32_bf16 v[140:143], a[240:243], v[144:147], v[140:143]
  v_exp_f32 v134, v134
  v_mfma_f32_16x16x32_bf16 v[172:175], a[240:243], v[176:179], v[172:175]
  v_exp_f32 v135, v135
  v_mfma_f32_16x16x32_bf16 v[204:207], a[240:243], v[208:211], v[204:207]
  v_exp_f32 v164, v164
  v_mfma_f32_16x16x32_bf16 v[76:79], a[244:247], v[88:91], v[76:79]
  v_exp_f32 v165, v165
  v_mfma_f32_16x16x32_bf16 v[108:111], a[244:247], v[120:123], v[108:111]
  v_exp_f32 v166, v166
  v_mfma_f32_16x16x32_bf16 v[140:143], a[244:247], v[152:155], v[140:143]
  v_exp_f32 v167, v167
  v_mfma_f32_16x16x32_bf16 v[172:175], a[244:247], v[184:187], v[172:175]
  v_exp_f32 v196, v196
  v_mfma_f32_16x16x32_bf16 v[204:207], a[244:247], v[216:219], v[204:207]
  v_exp_f32 v197, v197
  v_exp_f32 v198, v198
  v_exp_f32 v199, v199
  s_barrier
  s_nop 3
  v_exp_f32 v76, v76
  v_exp_f32 v77, v77
  v_exp_f32 v78, v78
  v_exp_f32 v79, v79
  v_exp_f32 v108, v108
  v_exp_f32 v109, v109
  v_exp_f32 v110, v110
  v_exp_f32 v111, v111
  v_exp_f32 v140, v140
  v_exp_f32 v141, v141
  v_exp_f32 v142, v142
  v_exp_f32 v143, v143
  v_exp_f32 v172, v172
  v_exp_f32 v173, v173
  v_exp_f32 v174, v174
  v_exp_f32 v175, v175
  v_exp_f32 v204, v204
  v_exp_f32 v205, v205
  v_exp_f32 v206, v206
  v_exp_f32 v207, v207
L_max_done:
  s_add_u32 m0, s47, 16384
  s_add_u32 s51, s43, 32768
  s_nop 0
  buffer_load_dwordx4 v16, s[12:15], s51 offen nt lds
  buffer_load_dwordx4 v17, s[12:15], s51 offen offset:1024 nt lds
  buffer_load_dwordx4 v18, s[12:15], s51 offen offset:2048 nt lds
  buffer_load_dwordx4 v19, s[12:15], s51 offen offset:3072 nt lds
  s_mov_b32 s31, 0
  v_mfma_f32_16x16x32_bf16 a[20:23], a[204:207], v[92:95], a[20:23]
  ds_read_b128 a[216:219], v22 offset:32768
  v_mfma_f32_16x16x32_bf16 a[52:55], a[204:207], v[124:127], a[52:55]
  v_cvt_pk_bf16_f32 v84, v68, v69
  v_cvt_pk_bf16_f32 v85, v70, v71
  v_mfma_f32_16x16x32_bf16 a[84:87], a[204:207], v[156:159], a[84:87]
  ds_read_b128 a[220:223], v23 offset:32768
  v_mfma_f32_16x16x32_bf16 a[116:119], a[204:207], v[188:191], a[116:119]
  v_cvt_pk_bf16_f32 v116, v100, v101
  v_cvt_pk_bf16_f32 v117, v102, v103
  v_mfma_f32_16x16x32_bf16 a[148:151], a[204:207], v[220:223], a[148:151]
  v_mfma_f32_16x16x32_bf16 a[24:27], a[208:211], v[92:95], a[24:27]
  ds_read_b128 a[224:227], v24 offset:32768
  v_mfma_f32_16x16x32_bf16 a[56:59], a[208:211], v[124:127], a[56:59]
  v_cvt_pk_bf16_f32 v148, v132, v133
  v_cvt_pk_bf16_f32 v149, v134, v135
  v_mfma_f32_16x16x32_bf16 a[88:91], a[208:211], v[156:159], a[88:91]
  ds_read_b128 a[228:231], v25 offset:32768
  v_mfma_f32_16x16x32_bf16 a[120:123], a[208:211], v[188:191], a[120:123]
  v_cvt_pk_bf16_f32 v180, v164, v165
  v_cvt_pk_bf16_f32 v181, v166, v167
  v_mfma_f32_16x16x32_bf16 a[152:155], a[208:211], v[220:223], a[152:155]
  v_mfma_f32_16x16x32_bf16 a[28:31], a[212:215], v[92:95], a[28:31]
  ds_read_b128 a[232:235], v22 offset:36864
  v_mfma_f32_16x16x32_bf16 a[60:63], a[212:215], v[124:127], a[60:63]
  v_cvt_pk_bf16_f32 v212, v196, v197
  v_cvt_pk_bf16_f32 v213, v198, v199
  v_mfma_f32_16x16x32_bf16 a[92:95], a[212:215], v[156:159], a[92:95]
  ds_read_b128 a[236:239], v23 offset:36864
  v_mfma_f32_16x16x32_bf16 a[124:127], a[212:215], v[188:191], a[124:127]
  v_cvt_pk_bf16_f32 v86, v76, v77
  v_cvt_pk_bf16_f32 v87, v78, v79
  v_mfma_f32_16x16x32_bf16 a[156:159], a[212:215], v[220:223], a[156:159]
  v_mfma_f32_16x16x32_bf16 a[160:163], a[180:183], v[92:95], a[160:163]
  ds_read_b128 a[240:243], v24 offset:36864
  v_mfma_f32_16x16x32_bf16 a[164:167], a[180:183], v[124:127], a[164:167]
  v_cvt_pk_bf16_f32 v118, v108, v109
  v_cvt_pk_bf16_f32 v119, v110, v111
  v_mfma_f32_16x16x32_bf16 a[168:171], a[180:183], v[156:159], a[168:171]
  ds_read_b128 a[244:247], v25 offset:36864
  v_mfma_f32_16x16x32_bf16 a[172:175], a[180:183], v[188:191], a[172:175]
  v_cvt_pk_bf16_f32 v150, v140, v141
  v_cvt_pk_bf16_f32 v151, v142, v143
  v_mfma_f32_16x16x32_bf16 a[176:179], a[180:183], v[220:223], a[176:179]
  s_waitcnt lgkmcnt(7)
  v_mfma_f32_16x16x32_bf16 v[68:71], a[216:219], v[64:67], v[224:227]
  ds_read_b64_tr_b16 a[184:185], v26
  v_mfma_f32_16x16x32_bf16 v[100:103], a[216:219], v[96:99], v[228:231]
  v_cvt_pk_bf16_f32 v182, v172, v173
  v_cvt_pk_bf16_f32 v183, v174, v175
  v_mfma_f32_16x16x32_bf16 v[132:135], a[216:219], v[128:131], v[232:235]
  ds_read_b64_tr_b16 a[186:187], v26 offset:4096
  v_mfma_f32_16x16x32_bf16 v[164:167], a[216:219], v[160:163], v[236:239]
  v_cvt_pk_bf16_f32 v214, v204, v205
  v_cvt_pk_bf16_f32 v215, v206, v207
  v_mfma_f32_16x16x32_bf16 v[196:199], a[216:219], v[192:195], v[240:243]
  s_waitcnt lgkmcnt(8)
  v_mfma_f32_16x16x32_bf16 v[68:71], a[220:223], v[72:75], v[68:71]
  ds_read_b64_tr_b16 a[188:189], v27
  v_mfma_f32_16x16x32_bf16 v[100:103], a[220:223], v[104:107], v[100:103]
  ds_read_b64_tr_b16 a[190:191], v27 offset:4096
  v_mfma_f32_16x16x32_bf16 v[132:135], a[220:223], v[136:139], v[132:135]
  ds_read_b64_tr_b16 a[192:193], v28
  v_mfma_f32_16x16x32_bf16 v[164:167], a[220:223], v[168:171], v[164:167]
  ds_read_b64_tr_b16 a[194:195], v28 offset:4096
  v_mfma_f32_16x16x32_bf16 v[196:199], a[220:223], v[200:203], v[196:199]
  s_waitcnt lgkmcnt(11)
  v_mfma_f32_16x16x32_bf16 v[68:71], a[224:227], v[80:83], v[68:71]
  ds_read_b64_tr_b16 a[196:197], v29
  v_mfma_f32_16x16x32_bf16 v[100:103], a[224:227], v[112:115], v[100:103]
  ds_read_b64_tr_b16 a[198:199], v29 offset:4096
  v_mfma_f32_16x16x32_bf16 v[132:135], a[224:227], v[144:147], v[132:135]
  ds_read_b64_tr_b16 a[200:201], v30
  v_mfma_f32_16x16x32_bf16 v[164:167], a[224:227], v[176:179], v[164:167]
  ds_read_b64_tr_b16 a[202:203], v30 offset:4096
  v_mfma_f32_16x16x32_bf16 v[196:199], a[224:227], v[208:211], v[196:199]
  s_waitcnt lgkmcnt(14)
  v_mfma_f32_16x16x32_bf16 v[68:71], a[228:231], v[88:91], v[68:71]
  ds_read_b64_tr_b16 a[204:205], v31
  v_mfma_f32_16x16x32_bf16 v[100:103], a[228:231], v[120:123], v[100:103]
  ds_read_b64_tr_b16 a[206:207], v31 offset:4096
  v_mfma_f32_16x16x32_bf16 v[132:135], a[228:231], v[152:155], v[132:135]
  ds_read_b64_tr_b16 a[208:209], v32
  v_mfma_f32_16x16x32_bf16 v[164:167], a[228:231], v[184:187], v[164:167]
  ds_read_b64_tr_b16 a[210:211], v32 offset:4096
  v_mfma_f32_16x16x32_bf16 v[196:199], a[228:231], v[216:219], v[196:199]
  s_waitcnt lgkmcnt(15)
  v_mfma_f32_16x16x32_bf16 v[76:79], a[232:235], v[64:67], v[224:227]
  ds_read_b64_tr_b16 a[212:213], v33
  v_mfma_f32_16x16x32_bf16 v[108:111], a[232:235], v[96:99], v[228:231]
  v_exp_f32 v68, v68
  v_mfma_f32_16x16x32_bf16 v[140:143], a[232:235], v[128:131], v[232:235]
  v_exp_f32 v69, v69
  v_mfma_f32_16x16x32_bf16 v[172:175], a[232:235], v[160:163], v[236:239]
  v_exp_f32 v70, v70
  v_mfma_f32_16x16x32_bf16 v[204:207], a[232:235], v[192:195], v[240:243]
  v_exp_f32 v71, v71
  v_mfma_f32_16x16x32_bf16 v[76:79], a[236:239], v[72:75], v[76:79]
  v_exp_f32 v100, v100
  v_mfma_f32_16x16x32_bf16 v[108:111], a[236:239], v[104:107], v[108:111]
  v_exp_f32 v101, v101
  v_mfma_f32_16x16x32_bf16 v[140:143], a[236:239], v[136:139], v[140:143]
  v_exp_f32 v102, v102
  v_mfma_f32_16x16x32_bf16 v[172:175], a[236:239], v[168:171], v[172:175]
  v_exp_f32 v103, v103
  v_mfma_f32_16x16x32_bf16 v[204:207], a[236:239], v[200:203], v[204:207]
  v_exp_f32 v132, v132
  v_mfma_f32_16x16x32_bf16 v[76:79], a[240:243], v[80:83], v[76:79]
  v_exp_f32 v133, v133
  v_mfma_f32_16x16x32_bf16 v[108:111], a[240:243], v[112:115], v[108:111]
  v_exp_f32 v134, v134
  v_mfma_f32_16x16x32_bf16 v[140:143], a[240:243], v[144:147], v[140:143]
  v_exp_f32 v135, v135
  v_mfma_f32_16x16x32_bf16 v[172:175], a[240:243], v[176:179], v[172:175]
  v_exp_f32 v164, v164
  v_mfma_f32_16x16x32_bf16 v[204:207], a[240:243], v[208:211], v[204:207]
  s_waitcnt lgkmcnt(15)
  v_exp_f32 v165, v165
  v_mfma_f32_16x16x32_bf16 v[76:79], a[244:247], v[88:91], v[76:79]
  v_exp_f32 v166, v166
  v_mfma_f32_16x16x32_bf16 v[108:111], a[244:247], v[120:123], v[108:111]
  v_exp_f32 v167, v167
  v_mfma_f32_16x16x32_bf16 v[140:143], a[244:247], v[152:155], v[140:143]
  v_exp_f32 v196, v196
  v_mfma_f32_16x16x32_bf16 v[172:175], a[244:247], v[184:187], v[172:175]
  v_exp_f32 v197, v197
  v_mfma_f32_16x16x32_bf16 v[204:207], a[244:247], v[216:219], v[204:207]
  s_waitcnt lgkmcnt(13)
  v_exp_f32 v198, v198
  v_mfma_f32_16x16x32_bf16 a[0:3], a[184:187], v[84:87], a[0:3]
  v_exp_f32 v199, v199
  v_mfma_f32_16x16x32_bf16 a[32:35], a[184:187], v[116:119], a[32:35]
  ds_read_b64_tr_b16 a[214:215], v33 offset:4096
  v_mfma_f32_16x16x32_bf16 a[64:67], a[184:187], v[148:151], a[64:67]
  v_exp_f32 v76, v76
  v_mfma_f32_16x16x32_bf16 a[96:99], a[184:187], v[180:183], a[96:99]
  v_exp_f32 v77, v77
  v_mfma_f32_16x16x32_bf16 a[128:131], a[184:187], v[212:215], a[128:131]
  s_waitcnt lgkmcnt(12)
  v_exp_f32 v78, v78
  v_mfma_f32_16x16x32_bf16 a[4:7], a[188:191], v[84:87], a[4:7]
  v_exp_f32 v79, v79
  v_mfma_f32_16x16x32_bf16 a[36:39], a[188:191], v[116:119], a[36:39]
  v_exp_f32 v108, v108
  v_mfma_f32_16x16x32_bf16 a[68:71], a[188:191], v[148:151], a[68:71]
  v_exp_f32 v109, v109
  v_mfma_f32_16x16x32_bf16 a[100:103], a[188:191], v[180:183], a[100:103]
  v_exp_f32 v110, v110
  v_mfma_f32_16x16x32_bf16 a[132:135], a[188:191], v[212:215], a[132:135]
  s_waitcnt lgkmcnt(10)
  v_exp_f32 v111, v111
  v_mfma_f32_16x16x32_bf16 a[8:11], a[192:195], v[84:87], a[8:11]
  v_exp_f32 v140, v140
  v_mfma_f32_16x16x32_bf16 a[40:43], a[192:195], v[116:119], a[40:43]
  v_exp_f32 v141, v141
  v_mfma_f32_16x16x32_bf16 a[72:75], a[192:195], v[148:151], a[72:75]
  v_exp_f32 v142, v142
  v_mfma_f32_16x16x32_bf16 a[104:107], a[192:195], v[180:183], a[104:107]
  v_exp_f32 v143, v143
  v_mfma_f32_16x16x32_bf16 a[136:139], a[192:195], v[212:215], a[136:139]
  s_waitcnt lgkmcnt(8)
  v_exp_f32 v172, v172
  v_mfma_f32_16x16x32_bf16 a[12:15], a[196:199], v[84:87], a[12:15]
  v_exp_f32 v173, v173
  v_mfma_f32_16x16x32_bf16 a[44:47], a[196:199], v[116:119], a[44:47]
  v_exp_f32 v174, v174
  v_mfma_f32_16x16x32_bf16 a[76:79], a[196:199], v[148:151], a[76:79]
  v_exp_f32 v175, v175
  v_mfma_f32_16x16x32_bf16 a[108:111], a[196:199], v[180:183], a[108:111]
  v_exp_f32 v204, v204
  v_mfma_f32_16x16x32_bf16 a[140:143], a[196:199], v[212:215], a[140:143]
  s_waitcnt lgkmcnt(6)
  v_exp_f32 v205, v205
  v_mfma_f32_16x16x32_bf16 a[16:19], a[200:203], v[84:87], a[16:19]
  v_exp_f32 v206, v206
  v_mfma_f32_16x16x32_bf16 a[48:51], a[200:203], v[116:119], a[48:51]
  v_exp_f32 v207, v207
  v_mfma_f32_16x16x32_bf16 a[80:83], a[200:203], v[148:151], a[80:83]
  v_mfma_f32_16x16x32_bf16 a[112:115], a[200:203], v[180:183], a[112:115]
  v_mfma_f32_16x16x32_bf16 a[144:147], a[200:203], v[212:215], a[144:147]
  s_waitcnt vmcnt(16) lgkmcnt(0)
  s_barrier
  .p2align 6
L_att_loop:
  v_mfma_f32_16x16x32_bf16 a[20:23], a[204:207], v[84:87], a[20:23]
  ds_read_b128 a[216:219], v22 offset:49152
  v_mfma_f32_16x16x32_bf16 a[52:55], a[204:207], v[116:119], a[52:55]
  v_cvt_pk_bf16_f32 v92, v68, v69
  v_cvt_pk_bf16_f32 v93, v70, v71
  v_mfma_f32_16x16x32_bf16 a[84:87], a[204:207], v[148:151], a[84:87]
  ds_read_b128 a[220:223], v23 offset:49152
  v_mfma_f32_16x16x32_bf16 a[116:119], a[204:207], v[180:183], a[116:119]
  s_add_u32 m0, s47, 32768
  v_cvt_pk_bf16_f32 v124, v100, v101
  v_cvt_pk_bf16_f32 v125, v102, v103
  v_mfma_f32_16x16x32_bf16 a[148:151], a[204:207], v[212:215], a[148:151]
  buffer_load_dwordx4 v16, s[12:15], s45 offen nt lds
  v_mfma_f32_16x16x32_bf16 a[24:27], a[208:211], v[84:87], a[24:27]
  ds_read_b128 a[224:227], v24 offset:49152
  v_mfma_f32_16x16x32_bf16 a[56:59], a[208:211], v[116:119], a[56:59]
  v_cvt_pk_bf16_f32 v156, v132, v133
  v_cvt_pk_bf16_f32 v157, v134, v135
  v_mfma_f32_16x16x32_bf16 a[88:91], a[208:211], v[148:151], a[88:91]
  ds_read_b128 a[228:231], v25 offset:49152
  v_mfma_f32_16x16x32_bf16 a[120:123], a[208:211], v[180:183], a[120:123]
  v_cvt_pk_bf16_f32 v188, v164, v165
  v_cvt_pk_bf16_f32 v189, v166, v167
  v_mfma_f32_16x16x32_bf16 a[152:155], a[208:211], v[212:215], a[152:155]
  buffer_load_dwordx4 v17, s[12:15], s45 offen offset:1024 nt lds
  v_mfma_f32_16x16x32_bf16 a[28:31], a[212:215], v[84:87], a[28:31]
  ds_read_b128 a[232:235], v22 offset:53248
  v_mfma_f32_16x16x32_bf16 a[60:63], a[212:215], v[116:119], a[60:63]
  v_cvt_pk_bf16_f32 v220, v196, v197
  v_cvt_pk_bf16_f32 v221, v198, v199
  v_mfma_f32_16x16x32_bf16 a[92:95], a[212:215], v[148:151], a[92:95]
  ds_read_b128 a[236:239], v23 offset:53248
  v_mfma_f32_16x16x32_bf16 a[124:127], a[212:215], v[180:183], a[124:127]
  v_cvt_pk_bf16_f32 v94, v76, v77
  v_cvt_pk_bf16_f32 v95, v78, v79
  v_mfma_f32_16x16x32_bf16 a[156:159], a[212:215], v[212:215], a[156:159]
  buffer_load_dwordx4 v18, s[12:15], s45 offen offset:2048 nt lds
  v_mfma_f32_16x16x32_bf16 a[160:163], a[180:183], v[84:87], a[160:163]
  ds_read_b128 a[240:243], v24 offset:53248
  v_mfma_f32_16x16x32_bf16 a[164:167], a[180:183], v[116:119], a[164:167]
  v_cvt_pk_bf16_f32 v126, v108, v109
  v_cvt_pk_bf16_f32 v127, v110, v111
  v_mfma_f32_16x16x32_bf16 a[168:171], a[180:183], v[148:151], a[168:171]
  ds_read_b128 a[244:247], v25 offset:53248
  v_mfma_f32_16x16x32_bf16 a[172:175], a[180:183], v[180:183], a[172:175]
  v_cvt_pk_bf16_f32 v158, v140, v141
  v_cvt_pk_bf16_f32 v159, v142, v143
  v_mfma_f32_16x16x32_bf16 a[176:179], a[180:183], v[212:215], a[176:179]
  s_waitcnt lgkmcnt(7)
  buffer_load_dwordx4 v19, s[12:15], s45 offen offset:3072 nt lds
  v_mfma_f32_16x16x32_bf16 v[68:71], a[216:219], v[64:67], v[224:227]
  s_add_u32 s45, s45, 8192
  ds_read_b64_tr_b16 a[184:185], v26 offset:16384
  v_mfma_f32_16x16x32_bf16 v[100:103], a[216:219], v[96:99], v[228:231]
  v_cvt_pk_bf16_f32 v190, v172, v173
  v_cvt_pk_bf16_f32 v191, v174, v175
  v_mfma_f32_16x16x32_bf16 v[132:135], a[216:219], v[128:131], v[232:235]
  ds_read_b64_tr_b16 a[186:187], v26 offset:20480
  v_mfma_f32_16x16x32_bf16 v[164:167], a[216:219], v[160:163], v[236:239]
  s_add_u32 m0, s48, 0
  v_cvt_pk_bf16_f32 v222, v204, v205
  v_cvt_pk_bf16_f32 v223, v206, v207
  v_mfma_f32_16x16x32_bf16 v[196:199], a[216:219], v[192:195], v[240:243]
  s_waitcnt lgkmcnt(8)
  buffer_load_dwordx4 v20, s[16:19], s46 offen nt lds
  v_mfma_f32_16x16x32_bf16 v[68:71], a[220:223], v[72:75], v[68:71]
  ds_read_b64_tr_b16 a[188:189], v27 offset:16384
  v_mfma_f32_16x16x32_bf16 v[100:103], a[220:223], v[104:107], v[100:103]
  ds_read_b64_tr_b16 a[190:191], v27 offset:20480
  v_mfma_f32_16x16x32_bf16 v[132:135], a[220:223], v[136:139], v[132:135]
  ds_read_b64_tr_b16 a[192:193], v28 offset:16384
  v_mfma_f32_16x16x32_bf16 v[164:167], a[220:223], v[168:171], v[164:167]
  ds_read_b64_tr_b16 a[194:195], v28 offset:20480
  v_mfma_f32_16x16x32_bf16 v[196:199], a[220:223], v[200:203], v[196:199]
  s_waitcnt lgkmcnt(11)
  buffer_load_dwordx4 v21, s[16:19], s46 offen offset:1024 nt lds
  v_mfma_f32_16x16x32_bf16 v[68:71], a[224:227], v[80:83], v[68:71]
  ds_read_b64_tr_b16 a[196:197], v29 offset:16384
  v_mfma_f32_16x16x32_bf16 v[100:103], a[224:227], v[112:115], v[100:103]
  ds_read_b64_tr_b16 a[198:199], v29 offset:20480
  v_mfma_f32_16x16x32_bf16 v[132:135], a[224:227], v[144:147], v[132:135]
  ds_read_b64_tr_b16 a[200:201], v30 offset:16384
  v_mfma_f32_16x16x32_bf16 v[164:167], a[224:227], v[176:179], v[164:167]
  ds_read_b64_tr_b16 a[202:203], v30 offset:20480
  v_mfma_f32_16x16x32_bf16 v[196:199], a[224:227], v[208:211], v[196:199]
  s_waitcnt lgkmcnt(14)
  buffer_load_dwordx4 v20, s[16:19], s46 offen offset:2048 nt lds
  v_mfma_f32_16x16x32_bf16 v[68:71], a[228:231], v[88:91], v[68:71]
  ds_read_b64_tr_b16 a[204:205], v31 offset:16384
  v_mfma_f32_16x16x32_bf16 v[100:103], a[228:231], v[120:123], v[100:103]
  ds_read_b64_tr_b16 a[206:207], v31 offset:20480
  v_mfma_f32_16x16x32_bf16 v[132:135], a[228:231], v[152:155], v[132:135]
  ds_read_b64_tr_b16 a[208:209], v32 offset:16384
  v_mfma_f32_16x16x32_bf16 v[164:167], a[228:231], v[184:187], v[164:167]
  ds_read_b64_tr_b16 a[210:211], v32 offset:20480
  v_mfma_f32_16x16x32_bf16 v[196:199], a[228:231], v[216:219], v[196:199]
  s_waitcnt lgkmcnt(15)
  buffer_load_dwordx4 v21, s[16:19], s46 offen offset:3072 nt lds
  v_mfma_f32_16x16x32_bf16 v[76:79], a[232:235], v[64:67], v[224:227]
  s_add_u32 s46, s46, 8192
  ds_read_b64_tr_b16 a[212:213], v33 offset:16384
  v_mfma_f32_16x16x32_bf16 v[108:111], a[232:235], v[96:99], v[228:231]
  v_exp_f32 v68, v68
  v_mfma_f32_16x16x32_bf16 v[140:143], a[232:235], v[128:131], v[232:235]
  v_exp_f32 v69, v69
  v_mfma_f32_16x16x32_bf16 v[172:175], a[232:235], v[160:163], v[236:239]
  v_exp_f32 v70, v70
  v_mfma_f32_16x16x32_bf16 v[204:207], a[232:235], v[192:195], v[240:243]
  v_exp_f32 v71, v71
  v_mfma_f32_16x16x32_bf16 v[76:79], a[236:239], v[72:75], v[76:79]
  v_exp_f32 v100, v100
  v_mfma_f32_16x16x32_bf16 v[108:111], a[236:239], v[104:107], v[108:111]
  v_exp_f32 v101, v101
  v_mfma_f32_16x16x32_bf16 v[140:143], a[236:239], v[136:139], v[140:143]
  v_exp_f32 v102, v102
  v_mfma_f32_16x16x32_bf16 v[172:175], a[236:239], v[168:171], v[172:175]
  v_exp_f32 v103, v103
  v_mfma_f32_16x16x32_bf16 v[204:207], a[236:239], v[200:203], v[204:207]
  v_exp_f32 v132, v132
  v_mfma_f32_16x16x32_bf16 v[76:79], a[240:243], v[80:83], v[76:79]
  v_exp_f32 v133, v133
  v_mfma_f32_16x16x32_bf16 v[108:111], a[240:243], v[112:115], v[108:111]
  v_exp_f32 v134, v134
  v_mfma_f32_16x16x32_bf16 v[140:143], a[240:243], v[144:147], v[140:143]
  v_exp_f32 v135, v135
  v_mfma_f32_16x16x32_bf16 v[172:175], a[240:243], v[176:179], v[172:175]
  v_exp_f32 v164, v164
  v_mfma_f32_16x16x32_bf16 v[204:207], a[240:243], v[208:211], v[204:207]
  s_waitcnt lgkmcnt(15)
  v_exp_f32 v165, v165
  v_mfma_f32_16x16x32_bf16 v[76:79], a[244:247], v[88:91], v[76:79]
  v_exp_f32 v166, v166
  v_mfma_f32_16x16x32_bf16 v[108:111], a[244:247], v[120:123], v[108:111]
  v_exp_f32 v167, v167
  v_mfma_f32_16x16x32_bf16 v[140:143], a[244:247], v[152:155], v[140:143]
  v_exp_f32 v196, v196
  v_mfma_f32_16x16x32_bf16 v[172:175], a[244:247], v[184:187], v[172:175]
  v_exp_f32 v197, v197
  v_mfma_f32_16x16x32_bf16 v[204:207], a[244:247], v[216:219], v[204:207]
  s_waitcnt lgkmcnt(13)
  v_exp_f32 v198, v198
  v_mfma_f32_16x16x32_bf16 a[0:3], a[184:187], v[92:95], a[0:3]
  v_exp_f32 v199, v199
  v_mfma_f32_16x16x32_bf16 a[32:35], a[184:187], v[124:127], a[32:35]
  ds_read_b64_tr_b16 a[214:215], v33 offset:20480
  v_mfma_f32_16x16x32_bf16 a[64:67], a[184:187], v[156:159], a[64:67]
  v_exp_f32 v76, v76
  v_mfma_f32_16x16x32_bf16 a[96:99], a[184:187], v[188:191], a[96:99]
  v_exp_f32 v77, v77
  v_mfma_f32_16x16x32_bf16 a[128:131], a[184:187], v[220:223], a[128:131]
  s_waitcnt lgkmcnt(12)
  v_exp_f32 v78, v78
  v_mfma_f32_16x16x32_bf16 a[4:7], a[188:191], v[92:95], a[4:7]
  v_exp_f32 v79, v79
  v_mfma_f32_16x16x32_bf16 a[36:39], a[188:191], v[124:127], a[36:39]
  v_exp_f32 v108, v108
  v_mfma_f32_16x16x32_bf16 a[68:71], a[188:191], v[156:159], a[68:71]
  v_exp_f32 v109, v109
  v_mfma_f32_16x16x32_bf16 a[100:103], a[188:191], v[188:191], a[100:103]
  v_exp_f32 v110, v110
  v_mfma_f32_16x16x32_bf16 a[132:135], a[188:191], v[220:223], a[132:135]
  s_waitcnt lgkmcnt(10)
  v_exp_f32 v111, v111
  v_mfma_f32_16x16x32_bf16 a[8:11], a[192:195], v[92:95], a[8:11]
  v_exp_f32 v140, v140
  v_mfma_f32_16x16x32_bf16 a[40:43], a[192:195], v[124:127], a[40:43]
  v_exp_f32 v141, v141
  v_mfma_f32_16x16x32_bf16 a[72:75], a[192:195], v[156:159], a[72:75]
  v_exp_f32 v142, v142
  v_mfma_f32_16x16x32_bf16 a[104:107], a[192:195], v[188:191], a[104:107]
  v_exp_f32 v143, v143
  v_mfma_f32_16x16x32_bf16 a[136:139], a[192:195], v[220:223], a[136:139]
  s_waitcnt lgkmcnt(8)
  v_exp_f32 v172, v172
  v_mfma_f32_16x16x32_bf16 a[12:15], a[196:199], v[92:95], a[12:15]
  v_exp_f32 v173, v173
  v_mfma_f32_16x16x32_bf16 a[44:47], a[196:199], v[124:127], a[44:47]
  v_exp_f32 v174, v174
  v_mfma_f32_16x16x32_bf16 a[76:79], a[196:199], v[156:159], a[76:79]
  v_exp_f32 v175, v175
  v_mfma_f32_16x16x32_bf16 a[108:111], a[196:199], v[188:191], a[108:111]
  v_exp_f32 v204, v204
  v_mfma_f32_16x16x32_bf16 a[140:143], a[196:199], v[220:223], a[140:143]
  s_waitcnt lgkmcnt(6)
  v_exp_f32 v205, v205
  v_mfma_f32_16x16x32_bf16 a[16:19], a[200:203], v[92:95], a[16:19]
  v_exp_f32 v206, v206
  v_mfma_f32_16x16x32_bf16 a[48:51], a[200:203], v[124:127], a[48:51]
  v_exp_f32 v207, v207
  v_mfma_f32_16x16x32_bf16 a[80:83], a[200:203], v[156:159], a[80:83]
  v_mfma_f32_16x16x32_bf16 a[112:115], a[200:203], v[188:191], a[112:115]
  v_mfma_f32_16x16x32_bf16 a[144:147], a[200:203], v[220:223], a[144:147]
  s_waitcnt vmcnt(16) lgkmcnt(0)
  s_barrier
  v_mfma_f32_16x16x32_bf16 a[20:23], a[204:207], v[92:95], a[20:23]
  ds_read_b128 a[216:219], v22
  v_mfma_f32_16x16x32_bf16 a[52:55], a[204:207], v[124:127], a[52:55]
  v_cvt_pk_bf16_f32 v84, v68, v69
  v_cvt_pk_bf16_f32 v85, v70, v71
  v_mfma_f32_16x16x32_bf16 a[84:87], a[204:207], v[156:159], a[84:87]
  ds_read_b128 a[220:223], v23
  v_mfma_f32_16x16x32_bf16 a[116:119], a[204:207], v[188:191], a[116:119]
  s_add_u32 m0, s47, 49152
  v_cvt_pk_bf16_f32 v116, v100, v101
  v_cvt_pk_bf16_f32 v117, v102, v103
  v_mfma_f32_16x16x32_bf16 a[148:151], a[204:207], v[220:223], a[148:151]
  buffer_load_dwordx4 v16, s[12:15], s45 offen nt lds
  v_mfma_f32_16x16x32_bf16 a[24:27], a[208:211], v[92:95], a[24:27]
  ds_read_b128 a[224:227], v24
  v_mfma_f32_16x16x32_bf16 a[56:59], a[208:211], v[124:127], a[56:59]
  v_cvt_pk_bf16_f32 v148, v132, v133
  v_cvt_pk_bf16_f32 v149, v134, v135
  v_mfma_f32_16x16x32_bf16 a[88:91], a[208:211], v[156:159], a[88:91]
  ds_read_b128 a[228:231], v25
  v_mfma_f32_16x16x32_bf16 a[120:123], a[208:211], v[188:191], a[120:123]
  v_cvt_pk_bf16_f32 v180, v164, v165
  v_cvt_pk_bf16_f32 v181, v166, v167
  v_mfma_f32_16x16x32_bf16 a[152:155], a[208:211], v[220:223], a[152:155]
  buffer_load_dwordx4 v17, s[12:15], s45 offen offset:1024 nt lds
  v_mfma_f32_16x16x32_bf16 a[28:31], a[212:215], v[92:95], a[28:31]
  ds_read_b128 a[232:235], v22 offset:4096
  v_mfma_f32_16x16x32_bf16 a[60:63], a[212:215], v[124:127], a[60:63]
  v_cvt_pk_bf16_f32 v212, v196, v197
  v_cvt_pk_bf16_f32 v213, v198, v199
  v_mfma_f32_16x16x32_bf16 a[92:95], a[212:215], v[156:159], a[92:95]
  ds_read_b128 a[236:239], v23 offset:4096
  v_mfma_f32_16x16x32_bf16 a[124:127], a[212:215], v[188:191], a[124:127]
  v_cvt_pk_bf16_f32 v86, v76, v77
  v_cvt_pk_bf16_f32 v87, v78, v79
  v_mfma_f32_16x16x32_bf16 a[156:159], a[212:215], v[220:223], a[156:159]
  buffer_load_dwordx4 v18, s[12:15], s45 offen offset:2048 nt lds
  v_mfma_f32_16x16x32_bf16 a[160:163], a[180:183], v[92:95], a[160:163]
  ds_read_b128 a[240:243], v24 offset:4096
  v_mfma_f32_16x16x32_bf16 a[164:167], a[180:183], v[124:127], a[164:167]
  v_cvt_pk_bf16_f32 v118, v108, v109
  v_cvt_pk_bf16_f32 v119, v110, v111
  v_mfma_f32_16x16x32_bf16 a[168:171], a[180:183], v[156:159], a[168:171]
  ds_read_b128 a[244:247], v25 offset:4096
  v_mfma_f32_16x16x32_bf16 a[172:175], a[180:183], v[188:191], a[172:175]
  v_cvt_pk_bf16_f32 v150, v140, v141
  v_cvt_pk_bf16_f32 v151, v142, v143
  v_mfma_f32_16x16x32_bf16 a[176:179], a[180:183], v[220:223], a[176:179]
  s_waitcnt lgkmcnt(7)
  buffer_load_dwordx4 v19, s[12:15], s45 offen offset:3072 nt lds
  v_mfma_f32_16x16x32_bf16 v[68:71], a[216:219], v[64:67], v[224:227]
  s_add_u32 s45, s45, 8192
  ds_read_b64_tr_b16 a[184:185], v26 offset:32768
  v_mfma_f32_16x16x32_bf16 v[100:103], a[216:219], v[96:99], v[228:231]
  v_cvt_pk_bf16_f32 v182, v172, v173
  v_cvt_pk_bf16_f32 v183, v174, v175
  v_mfma_f32_16x16x32_bf16 v[132:135], a[216:219], v[128:131], v[232:235]
  ds_read_b64_tr_b16 a[186:187], v26 offset:36864
  v_mfma_f32_16x16x32_bf16 v[164:167], a[216:219], v[160:163], v[236:239]
  s_add_u32 m0, s48, 16384
  v_cvt_pk_bf16_f32 v214, v204, v205
  v_cvt_pk_bf16_f32 v215, v206, v207
  v_mfma_f32_16x16x32_bf16 v[196:199], a[216:219], v[192:195], v[240:243]
  s_waitcnt lgkmcnt(8)
  buffer_load_dwordx4 v20, s[16:19], s46 offen nt lds
  v_mfma_f32_16x16x32_bf16 v[68:71], a[220:223], v[72:75], v[68:71]
  ds_read_b64_tr_b16 a[188:189], v27 offset:32768
  v_mfma_f32_16x16x32_bf16 v[100:103], a[220:223], v[104:107], v[100:103]
  ds_read_b64_tr_b16 a[190:191], v27 offset:36864
  v_mfma_f32_16x16x32_bf16 v[132:135], a[220:223], v[136:139], v[132:135]
  ds_read_b64_tr_b16 a[192:193], v28 offset:32768
  v_mfma_f32_16x16x32_bf16 v[164:167], a[220:223], v[168:171], v[164:167]
  ds_read_b64_tr_b16 a[194:195], v28 offset:36864
  v_mfma_f32_16x16x32_bf16 v[196:199], a[220:223], v[200:203], v[196:199]
  s_waitcnt lgkmcnt(11)
  buffer_load_dwordx4 v21, s[16:19], s46 offen offset:1024 nt lds
  v_mfma_f32_16x16x32_bf16 v[68:71], a[224:227], v[80:83], v[68:71]
  ds_read_b64_tr_b16 a[196:197], v29 offset:32768
  v_mfma_f32_16x16x32_bf16 v[100:103], a[224:227], v[112:115], v[100:103]
  ds_read_b64_tr_b16 a[198:199], v29 offset:36864
  v_mfma_f32_16x16x32_bf16 v[132:135], a[224:227], v[144:147], v[132:135]
  ds_read_b64_tr_b16 a[200:201], v30 offset:32768
  v_mfma_f32_16x16x32_bf16 v[164:167], a[224:227], v[176:179], v[164:167]
  ds_read_b64_tr_b16 a[202:203], v30 offset:36864
  v_mfma_f32_16x16x32_bf16 v[196:199], a[224:227], v[208:211], v[196:199]
  s_waitcnt lgkmcnt(14)
  buffer_load_dwordx4 v20, s[16:19], s46 offen offset:2048 nt lds
  v_mfma_f32_16x16x32_bf16 v[68:71], a[228:231], v[88:91], v[68:71]
  ds_read_b64_tr_b16 a[204:205], v31 offset:32768
  v_mfma_f32_16x16x32_bf16 v[100:103], a[228:231], v[120:123], v[100:103]
  ds_read_b64_tr_b16 a[206:207], v31 offset:36864
  v_mfma_f32_16x16x32_bf16 v[132:135], a[228:231], v[152:155], v[132:135]
  ds_read_b64_tr_b16 a[208:209], v32 offset:32768
  v_mfma_f32_16x16x32_bf16 v[164:167], a[228:231], v[184:187], v[164:167]
  ds_read_b64_tr_b16 a[210:211], v32 offset:36864
  v_mfma_f32_16x16x32_bf16 v[196:199], a[228:231], v[216:219], v[196:199]
  s_waitcnt lgkmcnt(15)
  buffer_load_dwordx4 v21, s[16:19], s46 offen offset:3072 nt lds
  v_mfma_f32_16x16x32_bf16 v[76:79], a[232:235], v[64:67], v[224:227]
  s_add_u32 s46, s46, 8192
  ds_read_b64_tr_b16 a[212:213], v33 offset:32768
  v_mfma_f32_16x16x32_bf16 v[108:111], a[232:235], v[96:99], v[228:231]
  v_exp_f32 v68, v68
  v_mfma_f32_16x16x32_bf16 v[140:143], a[232:235], v[128:131], v[232:235]
  v_exp_f32 v69, v69
  v_mfma_f32_16x16x32_bf16 v[172:175], a[232:235], v[160:163], v[236:239]
  v_exp_f32 v70, v70
  v_mfma_f32_16x16x32_bf16 v[204:207], a[232:235], v[192:195], v[240:243]
  v_exp_f32 v71, v71
  v_mfma_f32_16x16x32_bf16 v[76:79], a[236:239], v[72:75], v[76:79]
  v_exp_f32 v100, v100
  v_mfma_f32_16x16x32_bf16 v[108:111], a[236:239], v[104:107], v[108:111]
  v_exp_f32 v101, v101
  v_mfma_f32_16x16x32_bf16 v[140:143], a[236:239], v[136:139], v[140:143]
  v_exp_f32 v102, v102
  v_mfma_f32_16x16x32_bf16 v[172:175], a[236:239], v[168:171], v[172:175]
  v_exp_f32 v103, v103
  v_mfma_f32_16x16x32_bf16 v[204:207], a[236:239], v[200:203], v[204:207]
  v_exp_f32 v132, v132
  v_mfma_f32_16x16x32_bf16 v[76:79], a[240:243], v[80:83], v[76:79]
  v_exp_f32 v133, v133
  v_mfma_f32_16x16x32_bf16 v[108:111], a[240:243], v[112:115], v[108:111]
  v_exp_f32 v134, v134
  v_mfma_f32_16x16x32_bf16 v[140:143], a[240:243], v[144:147], v[140:143]
  v_exp_f32 v135, v135
  v_mfma_f32_16x16x32_bf16 v[172:175], a[240:243], v[176:179], v[172:175]
  v_exp_f32 v164, v164
  v_mfma_f32_16x16x32_bf16 v[204:207], a[240:243], v[208:211], v[204:207]
  s_waitcnt lgkmcnt(15)
  v_exp_f32 v165, v165
  v_mfma_f32_16x16x32_bf16 v[76:79], a[244:247], v[88:91], v[76:79]
  v_exp_f32 v166, v166
  v_mfma_f32_16x16x32_bf16 v[108:111], a[244:247], v[120:123], v[108:111]
  v_exp_f32 v167, v167
  v_mfma_f32_16x16x32_bf16 v[140:143], a[244:247], v[152:155], v[140:143]
  v_exp_f32 v196, v196
  v_mfma_f32_16x16x32_bf16 v[172:175], a[244:247], v[184:187], v[172:175]
  v_exp_f32 v197, v197
  v_mfma_f32_16x16x32_bf16 v[204:207], a[244:247], v[216:219], v[204:207]
  s_waitcnt lgkmcnt(13)
  v_exp_f32 v198, v198
  v_mfma_f32_16x16x32_bf16 a[0:3], a[184:187], v[84:87], a[0:3]
  v_exp_f32 v199, v199
  v_mfma_f32_16x16x32_bf16 a[32:35], a[184:187], v[116:119], a[32:35]
  ds_read_b64_tr_b16 a[214:215], v33 offset:36864
  v_mfma_f32_16x16x32_bf16 a[64:67], a[184:187], v[148:151], a[64:67]
  v_exp_f32 v76, v76
  v_mfma_f32_16x16x32_bf16 a[96:99], a[184:187], v[180:183], a[96:99]
  v_exp_f32 v77, v77
  v_mfma_f32_16x16x32_bf16 a[128:131], a[184:187], v[212:215], a[128:131]
  s_waitcnt lgkmcnt(12)
  v_exp_f32 v78, v78
  v_mfma_f32_16x16x32_bf16 a[4:7], a[188:191], v[84:87], a[4:7]
  v_exp_f32 v79, v79
  v_mfma_f32_16x16x32_bf16 a[36:39], a[188:191], v[116:119], a[36:39]
  v_exp_f32 v108, v108
  v_mfma_f32_16x16x32_bf16 a[68:71], a[188:191], v[148:151], a[68:71]
  v_exp_f32 v109, v109
  v_mfma_f32_16x16x32_bf16 a[100:103], a[188:191], v[180:183], a[100:103]
  v_exp_f32 v110, v110
  v_mfma_f32_16x16x32_bf16 a[132:135], a[188:191], v[212:215], a[132:135]
  s_waitcnt lgkmcnt(10)
  v_exp_f32 v111, v111
  v_mfma_f32_16x16x32_bf16 a[8:11], a[192:195], v[84:87], a[8:11]
  v_exp_f32 v140, v140
  v_mfma_f32_16x16x32_bf16 a[40:43], a[192:195], v[116:119], a[40:43]
  v_exp_f32 v141, v141
  v_mfma_f32_16x16x32_bf16 a[72:75], a[192:195], v[148:151], a[72:75]
  v_exp_f32 v142, v142
  v_mfma_f32_16x16x32_bf16 a[104:107], a[192:195], v[180:183], a[104:107]
  v_exp_f32 v143, v143
  v_mfma_f32_16x16x32_bf16 a[136:139], a[192:195], v[212:215], a[136:139]
  s_waitcnt lgkmcnt(8)
  v_exp_f32 v172, v172
  v_mfma_f32_16x16x32_bf16 a[12:15], a[196:199], v[84:87], a[12:15]
  v_exp_f32 v173, v173
  v_mfma_f32_16x16x32_bf16 a[44:47], a[196:199], v[116:119], a[44:47]
  v_exp_f32 v174, v174
  v_mfma_f32_16x16x32_bf16 a[76:79], a[196:199], v[148:151], a[76:79]
  v_exp_f32 v175, v175
  v_mfma_f32_16x16x32_bf16 a[108:111], a[196:199], v[180:183], a[108:111]
  v_exp_f32 v204, v204
  v_mfma_f32_16x16x32_bf16 a[140:143], a[196:199], v[212:215], a[140:143]
  s_waitcnt lgkmcnt(6)
  v_exp_f32 v205, v205
  v_mfma_f32_16x16x32_bf16 a[16:19], a[200:203], v[84:87], a[16:19]
  v_exp_f32 v206, v206
  v_mfma_f32_16x16x32_bf16 a[48:51], a[200:203], v[116:119], a[48:51]
  v_exp_f32 v207, v207
  v_mfma_f32_16x16x32_bf16 a[80:83], a[200:203], v[148:151], a[80:83]
  v_mfma_f32_16x16x32_bf16 a[112:115], a[200:203], v[180:183], a[112:115]
  v_mfma_f32_16x16x32_bf16 a[144:147], a[200:203], v[212:215], a[144:147]
  s_waitcnt vmcnt(16) lgkmcnt(0)
  s_barrier
  v_mfma_f32_16x16x32_bf16 a[20:23], a[204:207], v[84:87], a[20:23]
  ds_read_b128 a[216:219], v22 offset:16384
  v_mfma_f32_16x16x32_bf16 a[52:55], a[204:207], v[116:119], a[52:55]
  v_cvt_pk_bf16_f32 v92, v68, v69
  v_cvt_pk_bf16_f32 v93, v70, v71
  v_mfma_f32_16x16x32_bf16 a[84:87], a[204:207], v[148:151], a[84:87]
  ds_read_b128 a[220:223], v23 offset:16384
  v_mfma_f32_16x16x32_bf16 a[116:119], a[204:207], v[180:183], a[116:119]
  s_add_u32 m0, s47, 0
  v_cvt_pk_bf16_f32 v124, v100, v101
  v_cvt_pk_bf16_f32 v125, v102, v103
  v_mfma_f32_16x16x32_bf16 a[148:151], a[204:207], v[212:215], a[148:151]
  buffer_load_dwordx4 v16, s[12:15], s45 offen nt lds
  v_mfma_f32_16x16x32_bf16 a[24:27], a[208:211], v[84:87], a[24:27]
  ds_read_b128 a[224:227], v24 offset:16384
  v_mfma_f32_16x16x32_bf16 a[56:59], a[208:211], v[116:119], a[56:59]
  v_cvt_pk_bf16_f32 v156, v132, v133
  v_cvt_pk_bf16_f32 v157, v134, v135
  v_mfma_f32_16x16x32_bf16 a[88:91], a[208:211], v[148:151], a[88:91]
  ds_read_b128 a[228:231], v25 offset:16384
  v_mfma_f32_16x16x32_bf16 a[120:123], a[208:211], v[180:183], a[120:123]
  v_cvt_pk_bf16_f32 v188, v164, v165
  v_cvt_pk_bf16_f32 v189, v166, v167
  v_mfma_f32_16x16x32_bf16 a[152:155], a[208:211], v[212:215], a[152:155]
  buffer_load_dwordx4 v17, s[12:15], s45 offen offset:1024 nt lds
  v_mfma_f32_16x16x32_bf16 a[28:31], a[212:215], v[84:87], a[28:31]
  ds_read_b128 a[232:235], v22 offset:20480
  v_mfma_f32_16x16x32_bf16 a[60:63], a[212:215], v[116:119], a[60:63]
  v_cvt_pk_bf16_f32 v220, v196, v197
  v_cvt_pk_bf16_f32 v221, v198, v199
  v_mfma_f32_16x16x32_bf16 a[92:95], a[212:215], v[148:151], a[92:95]
  ds_read_b128 a[236:239], v23 offset:20480
  v_mfma_f32_16x16x32_bf16 a[124:127], a[212:215], v[180:183], a[124:127]
  v_cvt_pk_bf16_f32 v94, v76, v77
  v_cvt_pk_bf16_f32 v95, v78, v79
  v_mfma_f32_16x16x32_bf16 a[156:159], a[212:215], v[212:215], a[156:159]
  buffer_load_dwordx4 v18, s[12:15], s45 offen offset:2048 nt lds
  v_mfma_f32_16x16x32_bf16 a[160:163], a[180:183], v[84:87], a[160:163]
  ds_read_b128 a[240:243], v24 offset:20480
  v_mfma_f32_16x16x32_bf16 a[164:167], a[180:183], v[116:119], a[164:167]
  v_cvt_pk_bf16_f32 v126, v108, v109
  v_cvt_pk_bf16_f32 v127, v110, v111
  v_mfma_f32_16x16x32_bf16 a[168:171], a[180:183], v[148:151], a[168:171]
  ds_read_b128 a[244:247], v25 offset:20480
  v_mfma_f32_16x16x32_bf16 a[172:175], a[180:183], v[180:183], a[172:175]
  v_cvt_pk_bf16_f32 v158, v140, v141
  v_cvt_pk_bf16_f32 v159, v142, v143
  v_mfma_f32_16x16x32_bf16 a[176:179], a[180:183], v[212:215], a[176:179]
  s_waitcnt lgkmcnt(7)
  buffer_load_dwordx4 v19, s[12:15], s45 offen offset:3072 nt lds
  v_mfma_f32_16x16x32_bf16 v[68:71], a[216:219], v[64:67], v[224:227]
  s_add_u32 s45, s45, 8192
  ds_read_b64_tr_b16 a[184:185], v26 offset:49152
  v_mfma_f32_16x16x32_bf16 v[100:103], a[216:219], v[96:99], v[228:231]
  v_cvt_pk_bf16_f32 v190, v172, v173
  v_cvt_pk_bf16_f32 v191, v174, v175
  v_mfma_f32_16x16x32_bf16 v[132:135], a[216:219], v[128:131], v[232:235]
  ds_read_b64_tr_b16 a[186:187], v26 offset:53248
  v_mfma_f32_16x16x32_bf16 v[164:167], a[216:219], v[160:163], v[236:239]
  s_add_u32 m0, s48, 32768
  v_cvt_pk_bf16_f32 v222, v204, v205
  v_cvt_pk_bf16_f32 v223, v206, v207
  v_mfma_f32_16x16x32_bf16 v[196:199], a[216:219], v[192:195], v[240:243]
  s_waitcnt lgkmcnt(8)
  buffer_load_dwordx4 v20, s[16:19], s46 offen nt lds
  v_mfma_f32_16x16x32_bf16 v[68:71], a[220:223], v[72:75], v[68:71]
  ds_read_b64_tr_b16 a[188:189], v27 offset:49152
  v_mfma_f32_16x16x32_bf16 v[100:103], a[220:223], v[104:107], v[100:103]
  ds_read_b64_tr_b16 a[190:191], v27 offset:53248
  v_mfma_f32_16x16x32_bf16 v[132:135], a[220:223], v[136:139], v[132:135]
  ds_read_b64_tr_b16 a[192:193], v28 offset:49152
  v_mfma_f32_16x16x32_bf16 v[164:167], a[220:223], v[168:171], v[164:167]
  ds_read_b64_tr_b16 a[194:195], v28 offset:53248
  v_mfma_f32_16x16x32_bf16 v[196:199], a[220:223], v[200:203], v[196:199]
  s_waitcnt lgkmcnt(11)
  buffer_load_dwordx4 v21, s[16:19], s46 offen offset:1024 nt lds
  v_mfma_f32_16x16x32_bf16 v[68:71], a[224:227], v[80:83], v[68:71]
  ds_read_b64_tr_b16 a[196:197], v29 offset:49152
  v_mfma_f32_16x16x32_bf16 v[100:103], a[224:227], v[112:115], v[100:103]
  ds_read_b64_tr_b16 a[198:199], v29 offset:53248
  v_mfma_f32_16x16x32_bf16 v[132:135], a[224:227], v[144:147], v[132:135]
  ds_read_b64_tr_b16 a[200:201], v30 offset:49152
  v_mfma_f32_16x16x32_bf16 v[164:167], a[224:227], v[176:179], v[164:167]
  ds_read_b64_tr_b16 a[202:203], v30 offset:53248
  v_mfma_f32_16x16x32_bf16 v[196:199], a[224:227], v[208:211], v[196:199]
  s_waitcnt lgkmcnt(14)
  buffer_load_dwordx4 v20, s[16:19], s46 offen offset:2048 nt lds
  v_mfma_f32_16x16x32_bf16 v[68:71], a[228:231], v[88:91], v[68:71]
  ds_read_b64_tr_b16 a[204:205], v31 offset:49152
  v_mfma_f32_16x16x32_bf16 v[100:103], a[228:231], v[120:123], v[100:103]
  ds_read_b64_tr_b16 a[206:207], v31 offset:53248
  v_mfma_f32_16x16x32_bf16 v[132:135], a[228:231], v[152:155], v[132:135]
  ds_read_b64_tr_b16 a[208:209], v32 offset:49152
  v_mfma_f32_16x16x32_bf16 v[164:167], a[228:231], v[184:187], v[164:167]
  ds_read_b64_tr_b16 a[210:211], v32 offset:53248
  v_mfma_f32_16x16x32_bf16 v[196:199], a[228:231], v[216:219], v[196:199]
  s_waitcnt lgkmcnt(15)
  buffer_load_dwordx4 v21, s[16:19], s46 offen offset:3072 nt lds
  v_mfma_f32_16x16x32_bf16 v[76:79], a[232:235], v[64:67], v[224:227]
  s_add_u32 s46, s46, 8192
  ds_read_b64_tr_b16 a[212:213], v33 offset:49152
  v_mfma_f32_16x16x32_bf16 v[108:111], a[232:235], v[96:99], v[228:231]
  v_exp_f32 v68, v68
  v_mfma_f32_16x16x32_bf16 v[140:143], a[232:235], v[128:131], v[232:235]
  v_exp_f32 v69, v69
  v_mfma_f32_16x16x32_bf16 v[172:175], a[232:235], v[160:163], v[236:239]
  v_exp_f32 v70, v70
  v_mfma_f32_16x16x32_bf16 v[204:207], a[232:235], v[192:195], v[240:243]
  v_exp_f32 v71, v71
  v_mfma_f32_16x16x32_bf16 v[76:79], a[236:239], v[72:75], v[76:79]
  v_exp_f32 v100, v100
  v_mfma_f32_16x16x32_bf16 v[108:111], a[236:239], v[104:107], v[108:111]
  v_exp_f32 v101, v101
  v_mfma_f32_16x16x32_bf16 v[140:143], a[236:239], v[136:139], v[140:143]
  v_exp_f32 v102, v102
  v_mfma_f32_16x16x32_bf16 v[172:175], a[236:239], v[168:171], v[172:175]
  v_exp_f32 v103, v103
  v_mfma_f32_16x16x32_bf16 v[204:207], a[236:239], v[200:203], v[204:207]
  v_exp_f32 v132, v132
  v_mfma_f32_16x16x32_bf16 v[76:79], a[240:243], v[80:83], v[76:79]
  v_exp_f32 v133, v133
  v_mfma_f32_16x16x32_bf16 v[108:111], a[240:243], v[112:115], v[108:111]
  v_exp_f32 v134, v134
  v_mfma_f32_16x16x32_bf16 v[140:143], a[240:243], v[144:147], v[140:143]
  v_exp_f32 v135, v135
  v_mfma_f32_16x16x32_bf16 v[172:175], a[240:243], v[176:179], v[172:175]
  v_exp_f32 v164, v164
  v_mfma_f32_16x16x32_bf16 v[204:207], a[240:243], v[208:211], v[204:207]
  s_waitcnt lgkmcnt(15)
  v_exp_f32 v165, v165
  v_mfma_f32_16x16x32_bf16 v[76:79], a[244:247], v[88:91], v[76:79]
  v_exp_f32 v166, v166
  v_mfma_f32_16x16x32_bf16 v[108:111], a[244:247], v[120:123], v[108:111]
  v_exp_f32 v167, v167
  v_mfma_f32_16x16x32_bf16 v[140:143], a[244:247], v[152:155], v[140:143]
  v_exp_f32 v196, v196
  v_mfma_f32_16x16x32_bf16 v[172:175], a[244:247], v[184:187], v[172:175]
  v_exp_f32 v197, v197
  v_mfma_f32_16x16x32_bf16 v[204:207], a[244:247], v[216:219], v[204:207]
  s_waitcnt lgkmcnt(13)
  v_exp_f32 v198, v198
  v_mfma_f32_16x16x32_bf16 a[0:3], a[184:187], v[92:95], a[0:3]
  v_exp_f32 v199, v199
  v_mfma_f32_16x16x32_bf16 a[32:35], a[184:187], v[124:127], a[32:35]
  ds_read_b64_tr_b16 a[214:215], v33 offset:53248
  v_mfma_f32_16x16x32_bf16 a[64:67], a[184:187], v[156:159], a[64:67]
  v_exp_f32 v76, v76
  v_mfma_f32_16x16x32_bf16 a[96:99], a[184:187], v[188:191], a[96:99]
  v_exp_f32 v77, v77
  v_mfma_f32_16x16x32_bf16 a[128:131], a[184:187], v[220:223], a[128:131]
  s_waitcnt lgkmcnt(12)
  v_exp_f32 v78, v78
  v_mfma_f32_16x16x32_bf16 a[4:7], a[188:191], v[92:95], a[4:7]
  v_exp_f32 v79, v79
  v_mfma_f32_16x16x32_bf16 a[36:39], a[188:191], v[124:127], a[36:39]
  v_exp_f32 v108, v108
  v_mfma_f32_16x16x32_bf16 a[68:71], a[188:191], v[156:159], a[68:71]
  v_exp_f32 v109, v109
  v_mfma_f32_16x16x32_bf16 a[100:103], a[188:191], v[188:191], a[100:103]
  v_exp_f32 v110, v110
  v_mfma_f32_16x16x32_bf16 a[132:135], a[188:191], v[220:223], a[132:135]
  s_waitcnt lgkmcnt(10)
  v_exp_f32 v111, v111
  v_mfma_f32_16x16x32_bf16 a[8:11], a[192:195], v[92:95], a[8:11]
  v_exp_f32 v140, v140
  v_mfma_f32_16x16x32_bf16 a[40:43], a[192:195], v[124:127], a[40:43]
  v_exp_f32 v141, v141
  v_mfma_f32_16x16x32_bf16 a[72:75], a[192:195], v[156:159], a[72:75]
  v_exp_f32 v142, v142
  v_mfma_f32_16x16x32_bf16 a[104:107], a[192:195], v[188:191], a[104:107]
  v_exp_f32 v143, v143
  v_mfma_f32_16x16x32_bf16 a[136:139], a[192:195], v[220:223], a[136:139]
  s_waitcnt lgkmcnt(8)
  v_exp_f32 v172, v172
  v_mfma_f32_16x16x32_bf16 a[12:15], a[196:199], v[92:95], a[12:15]
  v_exp_f32 v173, v173
  v_mfma_f32_16x16x32_bf16 a[44:47], a[196:199], v[124:127], a[44:47]
  v_exp_f32 v174, v174
  v_mfma_f32_16x16x32_bf16 a[76:79], a[196:199], v[156:159], a[76:79]
  v_exp_f32 v175, v175
  v_mfma_f32_16x16x32_bf16 a[108:111], a[196:199], v[188:191], a[108:111]
  v_exp_f32 v204, v204
  v_mfma_f32_16x16x32_bf16 a[140:143], a[196:199], v[220:223], a[140:143]
  s_waitcnt lgkmcnt(6)
  v_exp_f32 v205, v205
  v_mfma_f32_16x16x32_bf16 a[16:19], a[200:203], v[92:95], a[16:19]
  v_exp_f32 v206, v206
  v_mfma_f32_16x16x32_bf16 a[48:51], a[200:203], v[124:127], a[48:51]
  v_exp_f32 v207, v207
  v_mfma_f32_16x16x32_bf16 a[80:83], a[200:203], v[156:159], a[80:83]
  v_mfma_f32_16x16x32_bf16 a[112:115], a[200:203], v[188:191], a[112:115]
  v_mfma_f32_16x16x32_bf16 a[144:147], a[200:203], v[220:223], a[144:147]
  s_waitcnt vmcnt(16) lgkmcnt(0)
  s_barrier
  s_cmp_eq_u32 s31, 2
  s_cbranch_scc0 L_att_nok_done
  v_add_u32 v16, 0x40000000, v16
  v_add_u32 v17, 0x40000000, v17
  v_add_u32 v18, 0x40000000, v18
  v_add_u32 v19, 0x40000000, v19
L_att_nok_done:
  v_mfma_f32_16x16x32_bf16 a[20:23], a[204:207], v[92:95], a[20:23]
  ds_read_b128 a[216:219], v22 offset:32768
  v_mfma_f32_16x16x32_bf16 a[52:55], a[204:207], v[124:127], a[52:55]
  v_cvt_pk_bf16_f32 v84, v68, v69
  v_cvt_pk_bf16_f32 v85, v70, v71
  v_mfma_f32_16x16x32_bf16 a[84:87], a[204:207], v[156:159], a[84:87]
  ds_read_b128 a[220:223], v23 offset:32768
  v_mfma_f32_16x16x32_bf16 a[116:119], a[204:207], v[188:191], a[116:119]
  s_add_u32 m0, s47, 16384
  v_cvt_pk_bf16_f32 v116, v100, v101
  v_cvt_pk_bf16_f32 v117, v102, v103
  v_mfma_f32_16x16x32_bf16 a[148:151], a[204:207], v[220:223], a[148:151]
  buffer_load_dwordx4 v16, s[12:15], s45 offen nt lds
  v_mfma_f32_16x16x32_bf16 a[24:27], a[208:211], v[92:95], a[24:27]
  ds_read_b128 a[224:227], v24 offset:32768
  v_mfma_f32_16x16x32_bf16 a[56:59], a[208:211], v[124:127], a[56:59]
  v_cvt_pk_bf16_f32 v148, v132, v133
  v_cvt_pk_bf16_f32 v149, v134, v135
  v_mfma_f32_16x16x32_bf16 a[88:91], a[208:211], v[156:159], a[88:91]
  ds_read_b128 a[228:231], v25 offset:32768
  v_mfma_f32_16x16x32_bf16 a[120:123], a[208:211], v[188:191], a[120:123]
  v_cvt_pk_bf16_f32 v180, v164, v165
  v_cvt_pk_bf16_f32 v181, v166, v167
  v_mfma_f32_16x16x32_bf16 a[152:155], a[208:211], v[220:223], a[152:155]
  buffer_load_dwordx4 v17, s[12:15], s45 offen offset:1024 nt lds
  v_mfma_f32_16x16x32_bf16 a[28:31], a[212:215], v[92:95], a[28:31]
  ds_read_b128 a[232:235], v22 offset:36864
  v_mfma_f32_16x16x32_bf16 a[60:63], a[212:215], v[124:127], a[60:63]
  v_cvt_pk_bf16_f32 v212, v196, v197
  v_cvt_pk_bf16_f32 v213, v198, v199
  v_mfma_f32_16x16x32_bf16 a[92:95], a[212:215], v[156:159], a[92:95]
  ds_read_b128 a[236:239], v23 offset:36864
  v_mfma_f32_16x16x32_bf16 a[124:127], a[212:215], v[188:191], a[124:127]
  v_cvt_pk_bf16_f32 v86, v76, v77
  v_cvt_pk_bf16_f32 v87, v78, v79
  v_mfma_f32_16x16x32_bf16 a[156:159], a[212:215], v[220:223], a[156:159]
  buffer_load_dwordx4 v18, s[12:15], s45 offen offset:2048 nt lds
  v_mfma_f32_16x16x32_bf16 a[160:163], a[180:183], v[92:95], a[160:163]
  ds_read_b128 a[240:243], v24 offset:36864
  v_mfma_f32_16x16x32_bf16 a[164:167], a[180:183], v[124:127], a[164:167]
  v_cvt_pk_bf16_f32 v118, v108, v109
  v_cvt_pk_bf16_f32 v119, v110, v111
  v_mfma_f32_16x16x32_bf16 a[168:171], a[180:183], v[156:159], a[168:171]
  ds_read_b128 a[244:247], v25 offset:36864
  v_mfma_f32_16x16x32_bf16 a[172:175], a[180:183], v[188:191], a[172:175]
  v_cvt_pk_bf16_f32 v150, v140, v141
  v_cvt_pk_bf16_f32 v151, v142, v143
  v_mfma_f32_16x16x32_bf16 a[176:179], a[180:183], v[220:223], a[176:179]
  s_waitcnt lgkmcnt(7)
  buffer_load_dwordx4 v19, s[12:15], s45 offen offset:3072 nt lds
  v_mfma_f32_16x16x32_bf16 v[68:71], a[216:219], v[64:67], v[224:227]
  s_add_u32 s45, s45, 8192
  ds_read_b64_tr_b16 a[184:185], v26
  v_mfma_f32_16x16x32_bf16 v[100:103], a[216:219], v[96:99], v[228:231]
  v_cvt_pk_bf16_f32 v182, v172, v173
  v_cvt_pk_bf16_f32 v183, v174, v175
  v_mfma_f32_16x16x32_bf16 v[132:135], a[216:219], v[128:131], v[232:235]
  ds_read_b64_tr_b16 a[186:187], v26 offset:4096
  v_mfma_f32_16x16x32_bf16 v[164:167], a[216:219], v[160:163], v[236:239]
  s_add_u32 m0, s48, 49152
  v_cvt_pk_bf16_f32 v214, v204, v205
  v_cvt_pk_bf16_f32 v215, v206, v207
  v_mfma_f32_16x16x32_bf16 v[196:199], a[216:219], v[192:195], v[240:243]
  s_waitcnt lgkmcnt(8)
  buffer_load_dwordx4 v20, s[16:19], s46 offen nt lds
  v_mfma_f32_16x16x32_bf16 v[68:71], a[220:223], v[72:75], v[68:71]
  ds_read_b64_tr_b16 a[188:189], v27
  v_mfma_f32_16x16x32_bf16 v[100:103], a[220:223], v[104:107], v[100:103]
  ds_read_b64_tr_b16 a[190:191], v27 offset:4096
  v_mfma_f32_16x16x32_bf16 v[132:135], a[220:223], v[136:139], v[132:135]
  ds_read_b64_tr_b16 a[192:193], v28
  v_mfma_f32_16x16x32_bf16 v[164:167], a[220:223], v[168:171], v[164:167]
  ds_read_b64_tr_b16 a[194:195], v28 offset:4096
  v_mfma_f32_16x16x32_bf16 v[196:199], a[220:223], v[200:203], v[196:199]
  s_waitcnt lgkmcnt(11)
  buffer_load_dwordx4 v21, s[16:19], s46 offen offset:1024 nt lds
  v_mfma_f32_16x16x32_bf16 v[68:71], a[224:227], v[80:83], v[68:71]
  ds_read_b64_tr_b16 a[196:197], v29
  v_mfma_f32_16x16x32_bf16 v[100:103], a[224:227], v[112:115], v[100:103]
  ds_read_b64_tr_b16 a[198:199], v29 offset:4096
  v_mfma_f32_16x16x32_bf16 v[132:135], a[224:227], v[144:147], v[132:135]
  ds_read_b64_tr_b16 a[200:201], v30
  v_mfma_f32_16x16x32_bf16 v[164:167], a[224:227], v[176:179], v[164:167]
  ds_read_b64_tr_b16 a[202:203], v30 offset:4096
  v_mfma_f32_16x16x32_bf16 v[196:199], a[224:227], v[208:211], v[196:199]
  s_waitcnt lgkmcnt(14)
  buffer_load_dwordx4 v20, s[16:19], s46 offen offset:2048 nt lds
  v_mfma_f32_16x16x32_bf16 v[68:71], a[228:231], v[88:91], v[68:71]
  ds_read_b64_tr_b16 a[204:205], v31
  v_mfma_f32_16x16x32_bf16 v[100:103], a[228:231], v[120:123], v[100:103]
  ds_read_b64_tr_b16 a[206:207], v31 offset:4096
  v_mfma_f32_16x16x32_bf16 v[132:135], a[228:231], v[152:155], v[132:135]
  ds_read_b64_tr_b16 a[208:209], v32
  v_mfma_f32_16x16x32_bf16 v[164:167], a[228:231], v[184:187], v[164:167]
  ds_read_b64_tr_b16 a[210:211], v32 offset:4096
  v_mfma_f32_16x16x32_bf16 v[196:199], a[228:231], v[216:219], v[196:199]
  s_waitcnt lgkmcnt(15)
  buffer_load_dwordx4 v21, s[16:19], s46 offen offset:3072 nt lds
  v_mfma_f32_16x16x32_bf16 v[76:79], a[232:235], v[64:67], v[224:227]
  s_add_u32 s46, s46, 8192
  ds_read_b64_tr_b16 a[212:213], v33
  v_mfma_f32_16x16x32_bf16 v[108:111], a[232:235], v[96:99], v[228:231]
  v_exp_f32 v68, v68
  v_mfma_f32_16x16x32_bf16 v[140:143], a[232:235], v[128:131], v[232:235]
  v_exp_f32 v69, v69
  v_mfma_f32_16x16x32_bf16 v[172:175], a[232:235], v[160:163], v[236:239]
  v_exp_f32 v70, v70
  v_mfma_f32_16x16x32_bf16 v[204:207], a[232:235], v[192:195], v[240:243]
  v_exp_f32 v71, v71
  v_mfma_f32_16x16x32_bf16 v[76:79], a[236:239], v[72:75], v[76:79]
  v_exp_f32 v100, v100
  v_mfma_f32_16x16x32_bf16 v[108:111], a[236:239], v[104:107], v[108:111]
  v_exp_f32 v101, v101
  v_mfma_f32_16x16x32_bf16 v[140:143], a[236:239], v[136:139], v[140:143]
  v_exp_f32 v102, v102
  v_mfma_f32_16x16x32_bf16 v[172:175], a[236:239], v[168:171], v[172:175]
  v_exp_f32 v103, v103
  v_mfma_f32_16x16x32_bf16 v[204:207], a[236:239], v[200:203], v[204:207]
  v_exp_f32 v132, v132
  v_mfma_f32_16x16x32_bf16 v[76:79], a[240:243], v[80:83], v[76:79]
  v_exp_f32 v133, v133
  v_mfma_f32_16x16x32_bf16 v[108:111], a[240:243], v[112:115], v[108:111]
  v_exp_f32 v134, v134
  v_mfma_f32_16x16x32_bf16 v[140:143], a[240:243], v[144:147], v[140:143]
  v_exp_f32 v135, v135
  v_mfma_f32_16x16x32_bf16 v[172:175], a[240:243], v[176:179], v[172:175]
  v_exp_f32 v164, v164
  v_mfma_f32_16x16x32_bf16 v[204:207], a[240:243], v[208:211], v[204:207]
  s_waitcnt lgkmcnt(15)
  v_exp_f32 v165, v165
  v_mfma_f32_16x16x32_bf16 v[76:79], a[244:247], v[88:91], v[76:79]
  v_exp_f32 v166, v166
  v_mfma_f32_16x16x32_bf16 v[108:111], a[244:247], v[120:123], v[108:111]
  v_exp_f32 v167, v167
  v_mfma_f32_16x16x32_bf16 v[140:143], a[244:247], v[152:155], v[140:143]
  v_exp_f32 v196, v196
  v_mfma_f32_16x16x32_bf16 v[172:175], a[244:247], v[184:187], v[172:175]
  v_exp_f32 v197, v197
  v_mfma_f32_16x16x32_bf16 v[204:207], a[244:247], v[216:219], v[204:207]
  s_waitcnt lgkmcnt(13)
  v_exp_f32 v198, v198
  v_mfma_f32_16x16x32_bf16 a[0:3], a[184:187], v[84:87], a[0:3]
  v_exp_f32 v199, v199
  v_mfma_f32_16x16x32_bf16 a[32:35], a[184:187], v[116:119], a[32:35]
  ds_read_b64_tr_b16 a[214:215], v33 offset:4096
  v_mfma_f32_16x16x32_bf16 a[64:67], a[184:187], v[148:151], a[64:67]
  v_exp_f32 v76, v76
  v_mfma_f32_16x16x32_bf16 a[96:99], a[184:187], v[180:183], a[96:99]
  v_exp_f32 v77, v77
  v_mfma_f32_16x16x32_bf16 a[128:131], a[184:187], v[212:215], a[128:131]
  s_waitcnt lgkmcnt(12)
  v_exp_f32 v78, v78
  v_mfma_f32_16x16x32_bf16 a[4:7], a[188:191], v[84:87], a[4:7]
  v_exp_f32 v79, v79
  v_mfma_f32_16x16x32_bf16 a[36:39], a[188:191], v[116:119], a[36:39]
  v_exp_f32 v108, v108
  v_mfma_f32_16x16x32_bf16 a[68:71], a[188:191], v[148:151], a[68:71]
  v_exp_f32 v109, v109
  v_mfma_f32_16x16x32_bf16 a[100:103], a[188:191], v[180:183], a[100:103]
  v_exp_f32 v110, v110
  v_mfma_f32_16x16x32_bf16 a[132:135], a[188:191], v[212:215], a[132:135]
  s_waitcnt lgkmcnt(10)
  v_exp_f32 v111, v111
  v_mfma_f32_16x16x32_bf16 a[8:11], a[192:195], v[84:87], a[8:11]
  v_exp_f32 v140, v140
  v_mfma_f32_16x16x32_bf16 a[40:43], a[192:195], v[116:119], a[40:43]
  v_exp_f32 v141, v141
  v_mfma_f32_16x16x32_bf16 a[72:75], a[192:195], v[148:151], a[72:75]
  v_exp_f32 v142, v142
  v_mfma_f32_16x16x32_bf16 a[104:107], a[192:195], v[180:183], a[104:107]
  v_exp_f32 v143, v143
  v_mfma_f32_16x16x32_bf16 a[136:139], a[192:195], v[212:215], a[136:139]
  s_waitcnt lgkmcnt(8)
  v_exp_f32 v172, v172
  v_mfma_f32_16x16x32_bf16 a[12:15], a[196:199], v[84:87], a[12:15]
  v_exp_f32 v173, v173
  v_mfma_f32_16x16x32_bf16 a[44:47], a[196:199], v[116:119], a[44:47]
  v_exp_f32 v174, v174
  v_mfma_f32_16x16x32_bf16 a[76:79], a[196:199], v[148:151], a[76:79]
  v_exp_f32 v175, v175
  v_mfma_f32_16x16x32_bf16 a[108:111], a[196:199], v[180:183], a[108:111]
  v_exp_f32 v204, v204
  v_mfma_f32_16x16x32_bf16 a[140:143], a[196:199], v[212:215], a[140:143]
  s_waitcnt lgkmcnt(6)
  v_exp_f32 v205, v205
  v_mfma_f32_16x16x32_bf16 a[16:19], a[200:203], v[84:87], a[16:19]
  v_exp_f32 v206, v206
  v_mfma_f32_16x16x32_bf16 a[48:51], a[200:203], v[116:119], a[48:51]
  v_exp_f32 v207, v207
  v_mfma_f32_16x16x32_bf16 a[80:83], a[200:203], v[148:151], a[80:83]
  v_mfma_f32_16x16x32_bf16 a[112:115], a[200:203], v[180:183], a[112:115]
  v_mfma_f32_16x16x32_bf16 a[144:147], a[200:203], v[212:215], a[144:147]
  s_waitcnt vmcnt(16) lgkmcnt(0)
  s_barrier
  s_cmp_eq_u32 s31, 2
  s_cbranch_scc0 L_att_nopf
  s_add_u32 s50, s55, 0
  s_and_b32 s50, s50, 7
  s_lshl_b32 s50, s50, 15
  s_lshl_b32 s51, s28, 13
  s_add_u32 s50, s50, s51
  v_lshlrev_b32 v46, 7, v1
  s_add_u32 s51, s50, 0
  buffer_load_dword v47, v46, s[84:87], s51 offen
L_att_nopf:
  s_add_u32 s31, s31, 1
  s_cmp_lt_u32 s31, 3
  s_cbranch_scc1 L_att_loop
  v_mfma_f32_16x16x32_bf16 a[20:23], a[204:207], v[84:87], a[20:23]
  ds_read_b128 a[216:219], v22 offset:49152
  v_mfma_f32_16x16x32_bf16 a[52:55], a[204:207], v[116:119], a[52:55]
  v_cvt_pk_bf16_f32 v92, v68, v69
  v_cvt_pk_bf16_f32 v93, v70, v71
  v_mfma_f32_16x16x32_bf16 a[84:87], a[204:207], v[148:151], a[84:87]
  ds_read_b128 a[220:223], v23 offset:49152
  v_mfma_f32_16x16x32_bf16 a[116:119], a[204:207], v[180:183], a[116:119]
  s_lshl_b32 s50, s28, 13
  s_add_u32 m0, s50, 131072
  s_xor_b32 s51, s39, 0
  v_cvt_pk_bf16_f32 v124, v100, v101
  v_cvt_pk_bf16_f32 v125, v102, v103
  v_mfma_f32_16x16x32_bf16 a[148:151], a[204:207], v[212:215], a[148:151]
  buffer_load_dwordx4 v34, s[20:23], s51 offen lds
  v_mfma_f32_16x16x32_bf16 a[24:27], a[208:211], v[84:87], a[24:27]
  ds_read_b128 a[224:227], v24 offset:49152
  v_mfma_f32_16x16x32_bf16 a[56:59], a[208:211], v[116:119], a[56:59]
  v_cvt_pk_bf16_f32 v156, v132, v133
  v_cvt_pk_bf16_f32 v157, v134, v135
  v_mfma_f32_16x16x32_bf16 a[88:91], a[208:211], v[148:151], a[88:91]
  ds_read_b128 a[228:231], v25 offset:49152
  v_mfma_f32_16x16x32_bf16 a[120:123], a[208:211], v[180:183], a[120:123]
  v_cvt_pk_bf16_f32 v188, v164, v165
  v_cvt_pk_bf16_f32 v189, v166, v167
  v_mfma_f32_16x16x32_bf16 a[152:155], a[208:211], v[212:215], a[152:155]
  buffer_load_dwordx4 v35, s[20:23], s51 offen offset:1024 lds
  v_mfma_f32_16x16x32_bf16 a[28:31], a[212:215], v[84:87], a[28:31]
  ds_read_b128 a[232:235], v22 offset:53248
  v_mfma_f32_16x16x32_bf16 a[60:63], a[212:215], v[116:119], a[60:63]
  v_cvt_pk_bf16_f32 v220, v196, v197
  v_cvt_pk_bf16_f32 v221, v198, v199
  v_mfma_f32_16x16x32_bf16 a[92:95], a[212:215], v[148:151], a[92:95]
  ds_read_b128 a[236:239], v23 offset:53248
  v_mfma_f32_16x16x32_bf16 a[124:127], a[212:215], v[180:183], a[124:127]
  v_cvt_pk_bf16_f32 v94, v76, v77
  v_cvt_pk_bf16_f32 v95, v78, v79
  v_mfma_f32_16x16x32_bf16 a[156:159], a[212:215], v[212:215], a[156:159]
  buffer_load_dwordx4 v36, s[20:23], s51 offen offset:2048 lds
  v_mfma_f32_16x16x32_bf16 a[160:163], a[180:183], v[84:87], a[160:163]
  ds_read_b128 a[240:243], v24 offset:53248
  v_mfma_f32_16x16x32_bf16 a[164:167], a[180:183], v[116:119], a[164:167]
  v_cvt_pk_bf16_f32 v126, v108, v109
  v_cvt_pk_bf16_f32 v127, v110, v111
  v_mfma_f32_16x16x32_bf16 a[168:171], a[180:183], v[148:151], a[168:171]
  ds_read_b128 a[244:247], v25 offset:53248
  v_mfma_f32_16x16x32_bf16 a[172:175], a[180:183], v[180:183], a[172:175]
  v_cvt_pk_bf16_f32 v158, v140, v141
  v_cvt_pk_bf16_f32 v159, v142, v143
  v_mfma_f32_16x16x32_bf16 a[176:179], a[180:183], v[212:215], a[176:179]
  s_waitcnt lgkmcnt(7)
  buffer_load_dwordx4 v37, s[20:23], s51 offen offset:3072 lds
  v_mfma_f32_16x16x32_bf16 v[68:71], a[216:219], v[64:67], v[224:227]
  ds_read_b64_tr_b16 a[184:185], v26 offset:16384
  v_mfma_f32_16x16x32_bf16 v[100:103], a[216:219], v[96:99], v[228:231]
  v_cvt_pk_bf16_f32 v190, v172, v173
  v_cvt_pk_bf16_f32 v191, v174, v175
  v_mfma_f32_16x16x32_bf16 v[132:135], a[216:219], v[128:131], v[232:235]
  ds_read_b64_tr_b16 a[186:187], v26 offset:20480
  v_mfma_f32_16x16x32_bf16 v[164:167], a[216:219], v[160:163], v[236:239]
  s_lshl_b32 s50, s28, 13
  s_add_u32 m0, s50, 135168
  s_xor_b32 s51, s39, 16384
  v_cvt_pk_bf16_f32 v222, v204, v205
  v_cvt_pk_bf16_f32 v223, v206, v207
  v_mfma_f32_16x16x32_bf16 v[196:199], a[216:219], v[192:195], v[240:243]
  s_waitcnt lgkmcnt(8)
  buffer_load_dwordx4 v34, s[20:23], s51 offen lds
  v_mfma_f32_16x16x32_bf16 v[68:71], a[220:223], v[72:75], v[68:71]
  ds_read_b64_tr_b16 a[188:189], v27 offset:16384
  v_mfma_f32_16x16x32_bf16 v[100:103], a[220:223], v[104:107], v[100:103]
  ds_read_b64_tr_b16 a[190:191], v27 offset:20480
  v_mfma_f32_16x16x32_bf16 v[132:135], a[220:223], v[136:139], v[132:135]
  ds_read_b64_tr_b16 a[192:193], v28 offset:16384
  v_mfma_f32_16x16x32_bf16 v[164:167], a[220:223], v[168:171], v[164:167]
  ds_read_b64_tr_b16 a[194:195], v28 offset:20480
  v_mfma_f32_16x16x32_bf16 v[196:199], a[220:223], v[200:203], v[196:199]
  s_waitcnt lgkmcnt(11)
  buffer_load_dwordx4 v35, s[20:23], s51 offen offset:1024 lds
  v_mfma_f32_16x16x32_bf16 v[68:71], a[224:227], v[80:83], v[68:71]
  ds_read_b64_tr_b16 a[196:197], v29 offset:16384
  v_mfma_f32_16x16x32_bf16 v[100:103], a[224:227], v[112:115], v[100:103]
  ds_read_b64_tr_b16 a[198:199], v29 offset:20480
  v_mfma_f32_16x16x32_bf16 v[132:135], a[224:227], v[144:147], v[132:135]
  ds_read_b64_tr_b16 a[200:201], v30 offset:16384
  v_mfma_f32_16x16x32_bf16 v[164:167], a[224:227], v[176:179], v[164:167]
  ds_read_b64_tr_b16 a[202:203], v30 offset:20480
  v_mfma_f32_16x16x32_bf16 v[196:199], a[224:227], v[208:211], v[196:199]
  s_waitcnt lgkmcnt(14)
  buffer_load_dwordx4 v36, s[20:23], s51 offen offset:2048 lds
  v_mfma_f32_16x16x32_bf16 v[68:71], a[228:231], v[88:91], v[68:71]
  ds_read_b64_tr_b16 a[204:205], v31 offset:16384
  v_mfma_f32_16x16x32_bf16 v[100:103], a[228:231], v[120:123], v[100:103]
  ds_read_b64_tr_b16 a[206:207], v31 offset:20480
  v_mfma_f32_16x16x32_bf16 v[132:135], a[228:231], v[152:155], v[132:135]
  ds_read_b64_tr_b16 a[208:209], v32 offset:16384
  v_mfma_f32_16x16x32_bf16 v[164:167], a[228:231], v[184:187], v[164:167]
  ds_read_b64_tr_b16 a[210:211], v32 offset:20480
  v_mfma_f32_16x16x32_bf16 v[196:199], a[228:231], v[216:219], v[196:199]
  s_waitcnt lgkmcnt(15)
  buffer_load_dwordx4 v37, s[20:23], s51 offen offset:3072 lds
  v_mfma_f32_16x16x32_bf16 v[76:79], a[232:235], v[64:67], v[224:227]
  ds_read_b64_tr_b16 a[212:213], v33 offset:16384
  v_mfma_f32_16x16x32_bf16 v[108:111], a[232:235], v[96:99], v[228:231]
  v_exp_f32 v68, v68
  v_mfma_f32_16x16x32_bf16 v[140:143], a[232:235], v[128:131], v[232:235]
  v_exp_f32 v69, v69
  v_mfma_f32_16x16x32_bf16 v[172:175], a[232:235], v[160:163], v[236:239]
  v_exp_f32 v70, v70
  v_mfma_f32_16x16x32_bf16 v[204:207], a[232:235], v[192:195], v[240:243]
  v_exp_f32 v71, v71
  v_mfma_f32_16x16x32_bf16 v[76:79], a[236:239], v[72:75], v[76:79]
  v_exp_f32 v100, v100
  v_mfma_f32_16x16x32_bf16 v[108:111], a[236:239], v[104:107], v[108:111]
  v_exp_f32 v101, v101
  v_mfma_f32_16x16x32_bf16 v[140:143], a[236:239], v[136:139], v[140:143]
  v_exp_f32 v102, v102
  v_mfma_f32_16x16x32_bf16 v[172:175], a[236:239], v[168:171], v[172:175]
  v_exp_f32 v103, v103
  v_mfma_f32_16x16x32_bf16 v[204:207], a[236:239], v[200:203], v[204:207]
  v_exp_f32 v132, v132
  v_mfma_f32_16x16x32_bf16 v[76:79], a[240:243], v[80:83], v[76:79]
  v_exp_f32 v133, v133
  v_mfma_f32_16x16x32_bf16 v[108:111], a[240:243], v[112:115], v[108:111]
  v_exp_f32 v134, v134
  v_mfma_f32_16x16x32_bf16 v[140:143], a[240:243], v[144:147], v[140:143]
  v_exp_f32 v135, v135
  v_mfma_f32_16x16x32_bf16 v[172:175], a[240:243], v[176:179], v[172:175]
  v_exp_f32 v164, v164
  v_mfma_f32_16x16x32_bf16 v[204:207], a[240:243], v[208:211], v[204:207]
  s_waitcnt lgkmcnt(15)
  v_exp_f32 v165, v165
  v_mfma_f32_16x16x32_bf16 v[76:79], a[244:247], v[88:91], v[76:79]
  v_exp_f32 v166, v166
  v_mfma_f32_16x16x32_bf16 v[108:111], a[244:247], v[120:123], v[108:111]
  v_exp_f32 v167, v167
  v_mfma_f32_16x16x32_bf16 v[140:143], a[244:247], v[152:155], v[140:143]
  v_exp_f32 v196, v196
  v_mfma_f32_16x16x32_bf16 v[172:175], a[244:247], v[184:187], v[172:175]
  v_exp_f32 v197, v197
  v_mfma_f32_16x16x32_bf16 v[204:207], a[244:247], v[216:219], v[204:207]
  s_waitcnt lgkmcnt(13)
  v_exp_f32 v198, v198
  v_mfma_f32_16x16x32_bf16 a[0:3], a[184:187], v[92:95], a[0:3]
  v_exp_f32 v199, v199
  v_mfma_f32_16x16x32_bf16 a[32:35], a[184:187], v[124:127], a[32:35]
  ds_read_b64_tr_b16 a[214:215], v33 offset:20480
  v_mfma_f32_16x16x32_bf16 a[64:67], a[184:187], v[156:159], a[64:67]
  v_exp_f32 v76, v76
  v_mfma_f32_16x16x32_bf16 a[96:99], a[184:187], v[188:191], a[96:99]
  v_exp_f32 v77, v77
  v_mfma_f32_16x16x32_bf16 a[128:131], a[184:187], v[220:223], a[128:131]
  s_waitcnt lgkmcnt(12)
  v_exp_f32 v78, v78
  v_mfma_f32_16x16x32_bf16 a[4:7], a[188:191], v[92:95], a[4:7]
  v_exp_f32 v79, v79
  v_mfma_f32_16x16x32_bf16 a[36:39], a[188:191], v[124:127], a[36:39]
  v_exp_f32 v108, v108
  v_mfma_f32_16x16x32_bf16 a[68:71], a[188:191], v[156:159], a[68:71]
  v_exp_f32 v109, v109
  v_mfma_f32_16x16x32_bf16 a[100:103], a[188:191], v[188:191], a[100:103]
  v_exp_f32 v110, v110
  v_mfma_f32_16x16x32_bf16 a[132:135], a[188:191], v[220:223], a[132:135]
  s_waitcnt lgkmcnt(10)
  v_exp_f32 v111, v111
  v_mfma_f32_16x16x32_bf16 a[8:11], a[192:195], v[92:95], a[8:11]
  v_exp_f32 v140, v140
  v_mfma_f32_16x16x32_bf16 a[40:43], a[192:195], v[124:127], a[40:43]
  v_exp_f32 v141, v141
  v_mfma_f32_16x16x32_bf16 a[72:75], a[192:195], v[156:159], a[72:75]
  v_exp_f32 v142, v142
  v_mfma_f32_16x16x32_bf16 a[104:107], a[192:195], v[188:191], a[104:107]
  v_exp_f32 v143, v143
  v_mfma_f32_16x16x32_bf16 a[136:139], a[192:195], v[220:223], a[136:139]
  s_waitcnt lgkmcnt(8)
  v_exp_f32 v172, v172
  v_mfma_f32_16x16x32_bf16 a[12:15], a[196:199], v[92:95], a[12:15]
  v_exp_f32 v173, v173
  v_mfma_f32_16x16x32_bf16 a[44:47], a[196:199], v[124:127], a[44:47]
  v_exp_f32 v174, v174
  v_mfma_f32_16x16x32_bf16 a[76:79], a[196:199], v[156:159], a[76:79]
  v_exp_f32 v175, v175
  v_mfma_f32_16x16x32_bf16 a[108:111], a[196:199], v[188:191], a[108:111]
  v_exp_f32 v204, v204
  v_mfma_f32_16x16x32_bf16 a[140:143], a[196:199], v[220:223], a[140:143]
  s_waitcnt lgkmcnt(6)
  v_exp_f32 v205, v205
  v_mfma_f32_16x16x32_bf16 a[16:19], a[200:203], v[92:95], a[16:19]
  v_exp_f32 v206, v206
  v_mfma_f32_16x16x32_bf16 a[48:51], a[200:203], v[124:127], a[48:51]
  v_exp_f32 v207, v207
  v_mfma_f32_16x16x32_bf16 a[80:83], a[200:203], v[156:159], a[80:83]
  v_mfma_f32_16x16x32_bf16 a[112:115], a[200:203], v[188:191], a[112:115]
  v_mfma_f32_16x16x32_bf16 a[144:147], a[200:203], v[220:223], a[144:147]
  s_waitcnt vmcnt(17) lgkmcnt(0)
  s_barrier
  v_mfma_f32_16x16x32_bf16 a[20:23], a[204:207], v[92:95], a[20:23]
  ds_read_b128 a[216:219], v22
  v_mfma_f32_16x16x32_bf16 a[52:55], a[204:207], v[124:127], a[52:55]
  v_cvt_pk_bf16_f32 v84, v68, v69
  v_cvt_pk_bf16_f32 v85, v70, v71
  v_mfma_f32_16x16x32_bf16 a[84:87], a[204:207], v[156:159], a[84:87]
  ds_read_b128 a[220:223], v23
  v_mfma_f32_16x16x32_bf16 a[116:119], a[204:207], v[188:191], a[116:119]
  s_lshl_b32 s50, s28, 13
  s_add_u32 m0, s50, 98304
  s_xor_b32 s51, s39, 32768
  v_cvt_pk_bf16_f32 v116, v100, v101
  v_cvt_pk_bf16_f32 v117, v102, v103
  v_mfma_f32_16x16x32_bf16 a[148:151], a[204:207], v[220:223], a[148:151]
  buffer_load_dwordx4 v34, s[20:23], s51 offen lds
  v_mfma_f32_16x16x32_bf16 a[24:27], a[208:211], v[92:95], a[24:27]
  ds_read_b128 a[224:227], v24
  v_mfma_f32_16x16x32_bf16 a[56:59], a[208:211], v[124:127], a[56:59]
  v_cvt_pk_bf16_f32 v148, v132, v133
  v_cvt_pk_bf16_f32 v149, v134, v135
  v_mfma_f32_16x16x32_bf16 a[88:91], a[208:211], v[156:159], a[88:91]
  ds_read_b128 a[228:231], v25
  v_mfma_f32_16x16x32_bf16 a[120:123], a[208:211], v[188:191], a[120:123]
  v_cvt_pk_bf16_f32 v180, v164, v165
  v_cvt_pk_bf16_f32 v181, v166, v167
  v_mfma_f32_16x16x32_bf16 a[152:155], a[208:211], v[220:223], a[152:155]
  buffer_load_dwordx4 v35, s[20:23], s51 offen offset:1024 lds
  v_mfma_f32_16x16x32_bf16 a[28:31], a[212:215], v[92:95], a[28:31]
  ds_read_b128 a[232:235], v22 offset:4096
  v_mfma_f32_16x16x32_bf16 a[60:63], a[212:215], v[124:127], a[60:63]
  v_cvt_pk_bf16_f32 v212, v196, v197
  v_cvt_pk_bf16_f32 v213, v198, v199
  v_mfma_f32_16x16x32_bf16 a[92:95], a[212:215], v[156:159], a[92:95]
  ds_read_b128 a[236:239], v23 offset:4096
  v_mfma_f32_16x16x32_bf16 a[124:127], a[212:215], v[188:191], a[124:127]
  v_cvt_pk_bf16_f32 v86, v76, v77
  v_cvt_pk_bf16_f32 v87, v78, v79
  v_mfma_f32_16x16x32_bf16 a[156:159], a[212:215], v[220:223], a[156:159]
  buffer_load_dwordx4 v36, s[20:23], s51 offen offset:2048 lds
  v_mfma_f32_16x16x32_bf16 a[160:163], a[180:183], v[92:95], a[160:163]
  ds_read_b128 a[240:243], v24 offset:4096
  v_mfma_f32_16x16x32_bf16 a[164:167], a[180:183], v[124:127], a[164:167]
  v_cvt_pk_bf16_f32 v118, v108, v109
  v_cvt_pk_bf16_f32 v119, v110, v111
  v_mfma_f32_16x16x32_bf16 a[168:171], a[180:183], v[156:159], a[168:171]
  ds_read_b128 a[244:247], v25 offset:4096
  v_mfma_f32_16x16x32_bf16 a[172:175], a[180:183], v[188:191], a[172:175]
  v_cvt_pk_bf16_f32 v150, v140, v141
  v_cvt_pk_bf16_f32 v151, v142, v143
  v_mfma_f32_16x16x32_bf16 a[176:179], a[180:183], v[220:223], a[176:179]
  s_waitcnt lgkmcnt(7)
  buffer_load_dwordx4 v37, s[20:23], s51 offen offset:3072 lds
  v_mfma_f32_16x16x32_bf16 v[68:71], a[216:219], v[64:67], v[224:227]
  ds_read_b64_tr_b16 a[184:185], v26 offset:32768
  v_mfma_f32_16x16x32_bf16 v[100:103], a[216:219], v[96:99], v[228:231]
  v_cvt_pk_bf16_f32 v182, v172, v173
  v_cvt_pk_bf16_f32 v183, v174, v175
  v_mfma_f32_16x16x32_bf16 v[132:135], a[216:219], v[128:131], v[232:235]
  ds_read_b64_tr_b16 a[186:187], v26 offset:36864
  v_mfma_f32_16x16x32_bf16 v[164:167], a[216:219], v[160:163], v[236:239]
  s_lshl_b32 s50, s28, 13
  s_add_u32 m0, s50, 102400
  s_xor_b32 s51, s39, 49152
  v_cvt_pk_bf16_f32 v214, v204, v205
  v_cvt_pk_bf16_f32 v215, v206, v207
  v_mfma_f32_16x16x32_bf16 v[196:199], a[216:219], v[192:195], v[240:243]
  s_waitcnt lgkmcnt(8)
  buffer_load_dwordx4 v34, s[20:23], s51 offen lds
  v_mfma_f32_16x16x32_bf16 v[68:71], a[220:223], v[72:75], v[68:71]
  ds_read_b64_tr_b16 a[188:189], v27 offset:32768
  v_mfma_f32_16x16x32_bf16 v[100:103], a[220:223], v[104:107], v[100:103]
  ds_read_b64_tr_b16 a[190:191], v27 offset:36864
  v_mfma_f32_16x16x32_bf16 v[132:135], a[220:223], v[136:139], v[132:135]
  ds_read_b64_tr_b16 a[192:193], v28 offset:32768
  v_mfma_f32_16x16x32_bf16 v[164:167], a[220:223], v[168:171], v[164:167]
  ds_read_b64_tr_b16 a[194:195], v28 offset:36864
  v_mfma_f32_16x16x32_bf16 v[196:199], a[220:223], v[200:203], v[196:199]
  s_waitcnt lgkmcnt(11)
  buffer_load_dwordx4 v35, s[20:23], s51 offen offset:1024 lds
  v_mfma_f32_16x16x32_bf16 v[68:71], a[224:227], v[80:83], v[68:71]
  ds_read_b64_tr_b16 a[196:197], v29 offset:32768
  v_mfma_f32_16x16x32_bf16 v[100:103], a[224:227], v[112:115], v[100:103]
  ds_read_b64_tr_b16 a[198:199], v29 offset:36864
  v_mfma_f32_16x16x32_bf16 v[132:135], a[224:227], v[144:147], v[132:135]
  ds_read_b64_tr_b16 a[200:201], v30 offset:32768
  v_mfma_f32_16x16x32_bf16 v[164:167], a[224:227], v[176:179], v[164:167]
  ds_read_b64_tr_b16 a[202:203], v30 offset:36864
  v_mfma_f32_16x16x32_bf16 v[196:199], a[224:227], v[208:211], v[196:199]
  s_waitcnt lgkmcnt(14)
  buffer_load_dwordx4 v36, s[20:23], s51 offen offset:2048 lds
  v_mfma_f32_16x16x32_bf16 v[68:71], a[228:231], v[88:91], v[68:71]
  ds_read_b64_tr_b16 a[204:205], v31 offset:32768
  v_mfma_f32_16x16x32_bf16 v[100:103], a[228:231], v[120:123], v[100:103]
  ds_read_b64_tr_b16 a[206:207], v31 offset:36864
  v_mfma_f32_16x16x32_bf16 v[132:135], a[228:231], v[152:155], v[132:135]
  ds_read_b64_tr_b16 a[208:209], v32 offset:32768
  v_mfma_f32_16x16x32_bf16 v[164:167], a[228:231], v[184:187], v[164:167]
  ds_read_b64_tr_b16 a[210:211], v32 offset:36864
  v_mfma_f32_16x16x32_bf16 v[196:199], a[228:231], v[216:219], v[196:199]
  s_waitcnt lgkmcnt(15)
  buffer_load_dwordx4 v37, s[20:23], s51 offen offset:3072 lds
  v_mfma_f32_16x16x32_bf16 v[76:79], a[232:235], v[64:67], v[224:227]
  ds_read_b64_tr_b16 a[212:213], v33 offset:32768
  v_mfma_f32_16x16x32_bf16 v[108:111], a[232:235], v[96:99], v[228:231]
  v_exp_f32 v68, v68
  v_mfma_f32_16x16x32_bf16 v[140:143], a[232:235], v[128:131], v[232:235]
  v_exp_f32 v69, v69
  v_mfma_f32_16x16x32_bf16 v[172:175], a[232:235], v[160:163], v[236:239]
  v_exp_f32 v70, v70
  v_mfma_f32_16x16x32_bf16 v[204:207], a[232:235], v[192:195], v[240:243]
  v_exp_f32 v71, v71
  v_mfma_f32_16x16x32_bf16 v[76:79], a[236:239], v[72:75], v[76:79]
  v_exp_f32 v100, v100
  v_mfma_f32_16x16x32_bf16 v[108:111], a[236:239], v[104:107], v[108:111]
  v_exp_f32 v101, v101
  v_mfma_f32_16x16x32_bf16 v[140:143], a[236:239], v[136:139], v[140:143]
  v_exp_f32 v102, v102
  v_mfma_f32_16x16x32_bf16 v[172:175], a[236:239], v[168:171], v[172:175]
  v_exp_f32 v103, v103
  v_mfma_f32_16x16x32_bf16 v[204:207], a[236:239], v[200:203], v[204:207]
  v_exp_f32 v132, v132
  v_mfma_f32_16x16x32_bf16 v[76:79], a[240:243], v[80:83], v[76:79]
  v_exp_f32 v133, v133
  v_mfma_f32_16x16x32_bf16 v[108:111], a[240:243], v[112:115], v[108:111]
  v_exp_f32 v134, v134
  v_mfma_f32_16x16x32_bf16 v[140:143], a[240:243], v[144:147], v[140:143]
  v_exp_f32 v135, v135
  v_mfma_f32_16x16x32_bf16 v[172:175], a[240:243], v[176:179], v[172:175]
  v_exp_f32 v164, v164
  v_mfma_f32_16x16x32_bf16 v[204:207], a[240:243], v[208:211], v[204:207]
  s_waitcnt lgkmcnt(15)
  v_exp_f32 v165, v165
  v_mfma_f32_16x16x32_bf16 v[76:79], a[244:247], v[88:91], v[76:79]
  v_exp_f32 v166, v166
  v_mfma_f32_16x16x32_bf16 v[108:111], a[244:247], v[120:123], v[108:111]
  v_exp_f32 v167, v167
  v_mfma_f32_16x16x32_bf16 v[140:143], a[244:247], v[152:155], v[140:143]
  v_exp_f32 v196, v196
  v_mfma_f32_16x16x32_bf16 v[172:175], a[244:247], v[184:187], v[172:175]
  v_exp_f32 v197, v197
  v_mfma_f32_16x16x32_bf16 v[204:207], a[244:247], v[216:219], v[204:207]
  s_waitcnt lgkmcnt(13)
  v_exp_f32 v198, v198
  v_mfma_f32_16x16x32_bf16 a[0:3], a[184:187], v[84:87], a[0:3]
  v_exp_f32 v199, v199
  v_mfma_f32_16x16x32_bf16 a[32:35], a[184:187], v[116:119], a[32:35]
  ds_read_b64_tr_b16 a[214:215], v33 offset:36864
  v_mfma_f32_16x16x32_bf16 a[64:67], a[184:187], v[148:151], a[64:67]
  v_exp_f32 v76, v76
  v_mfma_f32_16x16x32_bf16 a[96:99], a[184:187], v[180:183], a[96:99]
  v_exp_f32 v77, v77
  v_mfma_f32_16x16x32_bf16 a[128:131], a[184:187], v[212:215], a[128:131]
  s_waitcnt lgkmcnt(12)
  v_exp_f32 v78, v78
  v_mfma_f32_16x16x32_bf16 a[4:7], a[188:191], v[84:87], a[4:7]
  v_exp_f32 v79, v79
  v_mfma_f32_16x16x32_bf16 a[36:39], a[188:191], v[116:119], a[36:39]
  v_exp_f32 v108, v108
  v_mfma_f32_16x16x32_bf16 a[68:71], a[188:191], v[148:151], a[68:71]
  v_exp_f32 v109, v109
  v_mfma_f32_16x16x32_bf16 a[100:103], a[188:191], v[180:183], a[100:103]
  v_exp_f32 v110, v110
  v_mfma_f32_16x16x32_bf16 a[132:135], a[188:191], v[212:215], a[132:135]
  s_waitcnt lgkmcnt(10)
  v_exp_f32 v111, v111
  v_mfma_f32_16x16x32_bf16 a[8:11], a[192:195], v[84:87], a[8:11]
  v_exp_f32 v140, v140
  v_mfma_f32_16x16x32_bf16 a[40:43], a[192:195], v[116:119], a[40:43]
  v_exp_f32 v141, v141
  v_mfma_f32_16x16x32_bf16 a[72:75], a[192:195], v[148:151], a[72:75]
  v_exp_f32 v142, v142
  v_mfma_f32_16x16x32_bf16 a[104:107], a[192:195], v[180:183], a[104:107]
  v_exp_f32 v143, v143
  v_mfma_f32_16x16x32_bf16 a[136:139], a[192:195], v[212:215], a[136:139]
  s_waitcnt lgkmcnt(8)
  v_exp_f32 v172, v172
  v_mfma_f32_16x16x32_bf16 a[12:15], a[196:199], v[84:87], a[12:15]
  v_exp_f32 v173, v173
  v_mfma_f32_16x16x32_bf16 a[44:47], a[196:199], v[116:119], a[44:47]
  v_exp_f32 v174, v174
  v_mfma_f32_16x16x32_bf16 a[76:79], a[196:199], v[148:151], a[76:79]
  v_exp_f32 v175, v175
  v_mfma_f32_16x16x32_bf16 a[108:111], a[196:199], v[180:183], a[108:111]
  v_exp_f32 v204, v204
  v_mfma_f32_16x16x32_bf16 a[140:143], a[196:199], v[212:215], a[140:143]
  s_waitcnt lgkmcnt(6)
  v_exp_f32 v205, v205
  v_mfma_f32_16x16x32_bf16 a[16:19], a[200:203], v[84:87], a[16:19]
  v_exp_f32 v206, v206
  v_mfma_f32_16x16x32_bf16 a[48:51], a[200:203], v[116:119], a[48:51]
  v_exp_f32 v207, v207
  v_mfma_f32_16x16x32_bf16 a[80:83], a[200:203], v[148:151], a[80:83]
  v_mfma_f32_16x16x32_bf16 a[112:115], a[200:203], v[180:183], a[112:115]
  v_mfma_f32_16x16x32_bf16 a[144:147], a[200:203], v[212:215], a[144:147]
  s_waitcnt vmcnt(17) lgkmcnt(0)
  s_barrier
  v_mfma_f32_16x16x32_bf16 a[20:23], a[204:207], v[84:87], a[20:23]
  ds_read_b64_tr_b16 a[184:185], v26 offset:49152
  v_cvt_pk_bf16_f32 v92, v68, v69
  v_mfma_f32_16x16x32_bf16 a[52:55], a[204:207], v[116:119], a[52:55]
  ds_read_b64_tr_b16 a[186:187], v26 offset:53248
  v_cvt_pk_bf16_f32 v93, v70, v71
  v_mfma_f32_16x16x32_bf16 a[84:87], a[204:207], v[148:151], a[84:87]
  ds_read_b64_tr_b16 a[188:189], v27 offset:49152
  v_cvt_pk_bf16_f32 v124, v100, v101
  v_mfma_f32_16x16x32_bf16 a[116:119], a[204:207], v[180:183], a[116:119]
  ds_read_b64_tr_b16 a[190:191], v27 offset:53248
  v_cvt_pk_bf16_f32 v125, v102, v103
  v_mfma_f32_16x16x32_bf16 a[148:151], a[204:207], v[212:215], a[148:151]
  ds_read_b64_tr_b16 a[192:193], v28 offset:49152
  v_cvt_pk_bf16_f32 v156, v132, v133
  v_mfma_f32_16x16x32_bf16 a[24:27], a[208:211], v[84:87], a[24:27]
  ds_read_b64_tr_b16 a[194:195], v28 offset:53248
  v_cvt_pk_bf16_f32 v157, v134, v135
  v_mfma_f32_16x16x32_bf16 a[56:59], a[208:211], v[116:119], a[56:59]
  ds_read_b64_tr_b16 a[196:197], v29 offset:49152
  v_cvt_pk_bf16_f32 v188, v164, v165
  v_mfma_f32_16x16x32_bf16 a[88:91], a[208:211], v[148:151], a[88:91]
  ds_read_b64_tr_b16 a[198:199], v29 offset:53248
  v_cvt_pk_bf16_f32 v189, v166, v167
  v_mfma_f32_16x16x32_bf16 a[120:123], a[208:211], v[180:183], a[120:123]
  ds_read_b64_tr_b16 a[200:201], v30 offset:49152
  v_cvt_pk_bf16_f32 v220, v196, v197
  v_mfma_f32_16x16x32_bf16 a[152:155], a[208:211], v[212:215], a[152:155]
  ds_read_b64_tr_b16 a[202:203], v30 offset:53248
  v_cvt_pk_bf16_f32 v221, v198, v199
  v_mfma_f32_16x16x32_bf16 a[28:31], a[212:215], v[84:87], a[28:31]
  v_cvt_pk_bf16_f32 v94, v76, v77
  v_mfma_f32_16x16x32_bf16 a[60:63], a[212:215], v[116:119], a[60:63]
  v_cvt_pk_bf16_f32 v95, v78, v79
  v_mfma_f32_16x16x32_bf16 a[92:95], a[212:215], v[148:151], a[92:95]
  v_cvt_pk_bf16_f32 v126, v108, v109
  v_mfma_f32_16x16x32_bf16 a[124:127], a[212:215], v[180:183], a[124:127]
  v_cvt_pk_bf16_f32 v127, v110, v111
  v_mfma_f32_16x16x32_bf16 a[156:159], a[212:215], v[212:215], a[156:159]
  v_cvt_pk_bf16_f32 v158, v140, v141
  v_mfma_f32_16x16x32_bf16 a[160:163], a[180:183], v[84:87], a[160:163]
  ds_read_b64_tr_b16 a[204:205], v31 offset:49152
  v_cvt_pk_bf16_f32 v159, v142, v143
  v_mfma_f32_16x16x32_bf16 a[164:167], a[180:183], v[116:119], a[164:167]
  ds_read_b64_tr_b16 a[206:207], v31 offset:53248
  v_cvt_pk_bf16_f32 v190, v172, v173
  v_mfma_f32_16x16x32_bf16 a[168:171], a[180:183], v[148:151], a[168:171]
  ds_read_b64_tr_b16 a[208:209], v32 offset:49152
  v_cvt_pk_bf16_f32 v191, v174, v175
  v_mfma_f32_16x16x32_bf16 a[172:175], a[180:183], v[180:183], a[172:175]
  ds_read_b64_tr_b16 a[210:211], v32 offset:53248
  v_cvt_pk_bf16_f32 v222, v204, v205
  v_mfma_f32_16x16x32_bf16 a[176:179], a[180:183], v[212:215], a[176:179]
  s_waitcnt lgkmcnt(12)
  ds_read_b64_tr_b16 a[212:213], v33 offset:49152
  v_cvt_pk_bf16_f32 v223, v206, v207
  v_mfma_f32_16x16x32_bf16 a[0:3], a[184:187], v[92:95], a[0:3]
  s_waitcnt vmcnt(8)
  ds_read_b64_tr_b16 a[214:215], v33 offset:53248
  v_mfma_f32_16x16x32_bf16 a[32:35], a[184:187], v[124:127], a[32:35]
  ds_read_b64_tr_b16 a[216:217], v38 offset:32768
  ds_read_b64_tr_b16 a[218:219], v38 offset:36864
  v_mfma_f32_16x16x32_bf16 a[64:67], a[184:187], v[156:159], a[64:67]
  ds_read_b64_tr_b16 a[220:221], v38 offset:32776
  ds_read_b64_tr_b16 a[222:223], v38 offset:36872
  v_mfma_f32_16x16x32_bf16 a[96:99], a[184:187], v[188:191], a[96:99]
  ds_read_b64_tr_b16 a[224:225], v39 offset:32768
  ds_read_b64_tr_b16 a[226:227], v39 offset:36864
  v_mfma_f32_16x16x32_bf16 a[128:131], a[184:187], v[220:223], a[128:131]
  s_waitcnt lgkmcnt(15)
  ds_read_b64_tr_b16 a[228:229], v39 offset:32776
  ds_read_b64_tr_b16 a[230:231], v39 offset:36872
  v_mfma_f32_16x16x32_bf16 a[4:7], a[188:191], v[92:95], a[4:7]
  ds_read_b64_tr_b16 a[232:233], v40 offset:32768
  ds_read_b64_tr_b16 a[234:235], v40 offset:36864
  v_mfma_f32_16x16x32_bf16 a[36:39], a[188:191], v[124:127], a[36:39]
  ds_read_b64_tr_b16 a[236:237], v40 offset:32776
  ds_read_b64_tr_b16 a[238:239], v40 offset:36872
  v_mfma_f32_16x16x32_bf16 a[68:71], a[188:191], v[156:159], a[68:71]
  ds_read_b64_tr_b16 a[240:241], v41 offset:32768
  ds_read_b64_tr_b16 a[242:243], v41 offset:36864
  v_mfma_f32_16x16x32_bf16 a[100:103], a[188:191], v[188:191], a[100:103]
  s_waitcnt vmcnt(0)
  ds_read_b64_tr_b16 a[244:245], v41 offset:32776
  ds_read_b64_tr_b16 a[246:247], v41 offset:36872
  v_mfma_f32_16x16x32_bf16 a[132:135], a[188:191], v[220:223], a[132:135]
  ds_read_b64_tr_b16 v[192:193], v38
  ds_read_b64_tr_b16 v[194:195], v38 offset:4096
  v_mfma_f32_16x16x32_bf16 a[8:11], a[192:195], v[92:95], a[8:11]
  ds_read_b64_tr_b16 v[200:201], v38 offset:8
  ds_read_b64_tr_b16 v[202:203], v38 offset:4104
  v_mfma_f32_16x16x32_bf16 a[40:43], a[192:195], v[124:127], a[40:43]
  ds_read_b64_tr_b16 v[208:209], v39
  ds_read_b64_tr_b16 v[210:211], v39 offset:4096
  v_mfma_f32_16x16x32_bf16 a[72:75], a[192:195], v[156:159], a[72:75]
  ds_read_b64_tr_b16 v[216:217], v39 offset:8
  ds_read_b64_tr_b16 v[218:219], v39 offset:4104
  v_mfma_f32_16x16x32_bf16 a[104:107], a[192:195], v[188:191], a[104:107]
  ds_read_b64_tr_b16 v[224:225], v40
  ds_read_b64_tr_b16 v[226:227], v40 offset:4096
  v_mfma_f32_16x16x32_bf16 a[136:139], a[192:195], v[220:223], a[136:139]
  s_waitcnt lgkmcnt(15)
  ds_read_b64_tr_b16 v[228:229], v40 offset:8
  ds_read_b64_tr_b16 v[230:231], v40 offset:4104
  v_mfma_f32_16x16x32_bf16 a[12:15], a[196:199], v[92:95], a[12:15]
  ds_read_b64_tr_b16 v[232:233], v41
  ds_read_b64_tr_b16 v[234:235], v41 offset:4096
  v_mfma_f32_16x16x32_bf16 a[44:47], a[196:199], v[124:127], a[44:47]
  s_lshl_b32 s50, s57, 2
  s_add_u32 s50, s50, 0
  ds_read_b64_tr_b16 v[236:237], v41 offset:8
  ds_read_b64_tr_b16 v[238:239], v41 offset:4104
  v_mfma_f32_16x16x32_bf16 a[76:79], a[196:199], v[156:159], a[76:79]
  v_lshlrev_b32 v14, 8, v1
  v_add_u32 v14, s50, v14
  v_mfma_f32_16x16x32_bf16 a[108:111], a[196:199], v[188:191], a[108:111]
  s_waitcnt lgkmcnt(0)
  buffer_load_dword v15, v14, s[72:75], 0 offen sc1
  v_mfma_f32_16x16x32_bf16 a[140:143], a[196:199], v[220:223], a[140:143]
  v_mfma_f32_16x16x32_bf16 a[16:19], a[200:203], v[92:95], a[16:19]
  s_lshl_b32 s50, s28, 13
  s_add_u32 m0, s50, 131072
  s_xor_b32 s51, s39, 65536
  v_mfma_f32_16x16x32_bf16 a[48:51], a[200:203], v[124:127], a[48:51]
  buffer_load_dwordx4 v34, s[20:23], s51 offen lds
  v_mfma_f32_16x16x32_bf16 a[80:83], a[200:203], v[156:159], a[80:83]
  v_mfma_f32_16x16x32_bf16 a[112:115], a[200:203], v[188:191], a[112:115]
  v_mfma_f32_16x16x32_bf16 a[144:147], a[200:203], v[220:223], a[144:147]
  buffer_load_dwordx4 v35, s[20:23], s51 offen offset:1024 lds
  v_mfma_f32_16x16x32_bf16 a[20:23], a[204:207], v[92:95], a[20:23]
  v_mfma_f32_16x16x32_bf16 a[52:55], a[204:207], v[124:127], a[52:55]
  v_mfma_f32_16x16x32_bf16 a[84:87], a[204:207], v[156:159], a[84:87]
  buffer_load_dwordx4 v36, s[20:23], s51 offen offset:2048 lds
  v_mfma_f32_16x16x32_bf16 a[116:119], a[204:207], v[188:191], a[116:119]
  v_mfma_f32_16x16x32_bf16 a[148:151], a[204:207], v[220:223], a[148:151]
  v_mfma_f32_16x16x32_bf16 a[24:27], a[208:211], v[92:95], a[24:27]
  buffer_load_dwordx4 v37, s[20:23], s51 offen offset:3072 lds
  v_mfma_f32_16x16x32_bf16 a[56:59], a[208:211], v[124:127], a[56:59]
  v_mfma_f32_16x16x32_bf16 a[88:91], a[208:211], v[156:159], a[88:91]
  v_mfma_f32_16x16x32_bf16 a[120:123], a[208:211], v[188:191], a[120:123]
  s_lshl_b32 s50, s28, 13
  s_add_u32 m0, s50, 135168
  s_xor_b32 s51, s39, 81920
  v_mfma_f32_16x16x32_bf16 a[152:155], a[208:211], v[220:223], a[152:155]
  buffer_load_dwordx4 v34, s[20:23], s51 offen lds
  v_mfma_f32_16x16x32_bf16 a[28:31], a[212:215], v[92:95], a[28:31]
  v_mfma_f32_16x16x32_bf16 a[60:63], a[212:215], v[124:127], a[60:63]
  v_mfma_f32_16x16x32_bf16 a[92:95], a[212:215], v[156:159], a[92:95]
  buffer_load_dwordx4 v35, s[20:23], s51 offen offset:1024 lds
  v_mfma_f32_16x16x32_bf16 a[124:127], a[212:215], v[188:191], a[124:127]
  v_mfma_f32_16x16x32_bf16 a[156:159], a[212:215], v[220:223], a[156:159]
  v_mfma_f32_16x16x32_bf16 a[160:163], a[180:183], v[92:95], a[160:163]
  buffer_load_dwordx4 v36, s[20:23], s51 offen offset:2048 lds
  v_mfma_f32_16x16x32_bf16 a[164:167], a[180:183], v[124:127], a[164:167]
  v_mfma_f32_16x16x32_bf16 a[168:171], a[180:183], v[156:159], a[168:171]
  v_mfma_f32_16x16x32_bf16 a[172:175], a[180:183], v[188:191], a[172:175]
  buffer_load_dwordx4 v37, s[20:23], s51 offen offset:3072 lds
  v_mfma_f32_16x16x32_bf16 a[176:179], a[180:183], v[220:223], a[176:179]
  s_barrier
  s_nop 3
  s_lshl_b32 s51, s30, 11
  v_subrev_u32 v51, s51, v42
  v_add_u32 v42, s51, v42
  s_lshl_b32 s50, s29, 12
  s_add_u32 s50, s50, 32768
  s_add_u32 s50, s50, s51
  v_add_u32 v50, s50, v43
  v_accvgpr_read_b32 v46, a160
  v_rcp_f32 v48, v46
  s_nop 0
  v_mov_b32 v49, v48
  v_mov_b32 v47, v46
  v_accvgpr_read_b32 v52, a0
  v_accvgpr_read_b32 v53, a1
  v_accvgpr_read_b32 v54, a2
  v_accvgpr_read_b32 v55, a3
  v_accvgpr_read_b32 v56, a4
  v_accvgpr_read_b32 v57, a5
  v_accvgpr_read_b32 v58, a6
  v_accvgpr_read_b32 v59, a7
  s_lshl_b32 s50, s28, 13
  s_add_u32 m0, s50, 98304
  s_xor_b32 s51, s39, 98304
  s_nop 0
  buffer_load_dwordx4 v34, s[20:23], s51 offen lds
  v_pk_mul_f32 v[52:53], v[52:53], v[48:49]
  v_pk_mul_f32 v[54:55], v[54:55], v[48:49]
  v_pk_mul_f32 v[56:57], v[56:57], v[48:49]
  v_pk_mul_f32 v[58:59], v[58:59], v[48:49]
  v_cvt_pk_bf16_f32 v60, v52, v53
  v_cvt_pk_bf16_f32 v61, v54, v55
  v_cvt_pk_bf16_f32 v62, v56, v57
  v_cvt_pk_bf16_f32 v63, v58, v59
  ds_write_b128 v42, v[60:63] offset:0
  v_accvgpr_read_b32 v52, a8
  v_accvgpr_read_b32 v53, a9
  v_accvgpr_read_b32 v54, a10
  v_accvgpr_read_b32 v55, a11
  v_accvgpr_read_b32 v56, a12
  v_accvgpr_read_b32 v57, a13
  v_accvgpr_read_b32 v58, a14
  v_accvgpr_read_b32 v59, a15
  buffer_load_dwordx4 v35, s[20:23], s51 offen offset:1024 lds
  v_pk_mul_f32 v[52:53], v[52:53], v[48:49]
  v_pk_mul_f32 v[54:55], v[54:55], v[48:49]
  v_pk_mul_f32 v[56:57], v[56:57], v[48:49]
  v_pk_mul_f32 v[58:59], v[58:59], v[48:49]
  v_cvt_pk_bf16_f32 v60, v52, v53
  v_cvt_pk_bf16_f32 v61, v54, v55
  v_cvt_pk_bf16_f32 v62, v56, v57
  v_cvt_pk_bf16_f32 v63, v58, v59
  ds_write_b128 v42, v[60:63] offset:1024
  v_accvgpr_read_b32 v52, a16
  v_accvgpr_read_b32 v53, a17
  v_accvgpr_read_b32 v54, a18
  v_accvgpr_read_b32 v55, a19
  v_accvgpr_read_b32 v56, a20
  v_accvgpr_read_b32 v57, a21
  v_accvgpr_read_b32 v58, a22
  v_accvgpr_read_b32 v59, a23
  buffer_load_dwordx4 v36, s[20:23], s51 offen offset:2048 lds
  v_pk_mul_f32 v[52:53], v[52:53], v[48:49]
  v_pk_mul_f32 v[54:55], v[54:55], v[48:49]
  v_pk_mul_f32 v[56:57], v[56:57], v[48:49]
  v_pk_mul_f32 v[58:59], v[58:59], v[48:49]
  v_cvt_pk_bf16_f32 v60, v52, v53
  v_cvt_pk_bf16_f32 v61, v54, v55
  v_cvt_pk_bf16_f32 v62, v56, v57
  v_cvt_pk_bf16_f32 v63, v58, v59
  ds_write_b128 v51, v[60:63] offset:2048
  v_accvgpr_read_b32 v52, a24
  v_accvgpr_read_b32 v53, a25
  v_accvgpr_read_b32 v54, a26
  v_accvgpr_read_b32 v55, a27
  v_accvgpr_read_b32 v56, a28
  v_accvgpr_read_b32 v57, a29
  v_accvgpr_read_b32 v58, a30
  v_accvgpr_read_b32 v59, a31
  buffer_load_dwordx4 v37, s[20:23], s51 offen offset:3072 lds
  v_pk_mul_f32 v[52:53], v[52:53], v[48:49]
  v_pk_mul_f32 v[54:55], v[54:55], v[48:49]
  v_pk_mul_f32 v[56:57], v[56:57], v[48:49]
  v_pk_mul_f32 v[58:59], v[58:59], v[48:49]
  v_cvt_pk_bf16_f32 v60, v52, v53
  v_cvt_pk_bf16_f32 v61, v54, v55
  v_cvt_pk_bf16_f32 v62, v56, v57
  v_cvt_pk_bf16_f32 v63, v58, v59
  ds_write_b128 v51, v[60:63] offset:3072
  v_accvgpr_read_b32 v46, a164
  v_rcp_f32 v48, v46
  s_nop 0
  v_mov_b32 v49, v48
  v_max_f32 v47, v47, v46
  s_waitcnt vmcnt(4)
  v_readfirstlane_b32 s52, v15
  s_nop 3
  s_cmp_lt_u32 s52, 16
  s_cbranch_scc1 L_cnt_spin
L_cnt_ok:
  ds_read_b64_tr_b16 a[0:1], v38 offset:32768
  ds_read_b64_tr_b16 a[2:3], v38 offset:36864
  ds_read_b64_tr_b16 a[4:5], v38 offset:32776
  ds_read_b64_tr_b16 a[6:7], v38 offset:36872
  ds_read_b64_tr_b16 a[8:9], v39 offset:32768
  ds_read_b64_tr_b16 a[10:11], v39 offset:36864
  v_accvgpr_read_b32 v52, a32
  v_accvgpr_read_b32 v53, a33
  v_accvgpr_read_b32 v54, a34
  v_accvgpr_read_b32 v55, a35
  v_accvgpr_read_b32 v56, a36
  v_accvgpr_read_b32 v57, a37
  v_accvgpr_read_b32 v58, a38
  v_accvgpr_read_b32 v59, a39
  s_lshl_b32 s50, s28, 13
  s_add_u32 m0, s50, 102400
  s_xor_b32 s51, s39, 114688
  s_nop 0
  buffer_load_dwordx4 v34, s[20:23], s51 offen lds
  v_pk_mul_f32 v[52:53], v[52:53], v[48:49]
  v_pk_mul_f32 v[54:55], v[54:55], v[48:49]
  v_pk_mul_f32 v[56:57], v[56:57], v[48:49]
  v_pk_mul_f32 v[58:59], v[58:59], v[48:49]
  v_cvt_pk_bf16_f32 v60, v52, v53
  v_cvt_pk_bf16_f32 v61, v54, v55
  v_cvt_pk_bf16_f32 v62, v56, v57
  v_cvt_pk_bf16_f32 v63, v58, v59
  ds_write_b128 v42, v[60:63] offset:8192
  ds_read_b64_tr_b16 a[12:13], v39 offset:32776
  ds_read_b64_tr_b16 a[14:15], v39 offset:36872
  ds_read_b64_tr_b16 a[16:17], v40 offset:32768
  ds_read_b64_tr_b16 a[18:19], v40 offset:36864
  ds_read_b64_tr_b16 a[20:21], v40 offset:32776
  v_accvgpr_read_b32 v52, a40
  v_accvgpr_read_b32 v53, a41
  v_accvgpr_read_b32 v54, a42
  v_accvgpr_read_b32 v55, a43
  v_accvgpr_read_b32 v56, a44
  v_accvgpr_read_b32 v57, a45
  v_accvgpr_read_b32 v58, a46
  v_accvgpr_read_b32 v59, a47
  buffer_load_dwordx4 v35, s[20:23], s51 offen offset:1024 lds
  v_pk_mul_f32 v[52:53], v[52:53], v[48:49]
  v_pk_mul_f32 v[54:55], v[54:55], v[48:49]
  v_pk_mul_f32 v[56:57], v[56:57], v[48:49]
  v_pk_mul_f32 v[58:59], v[58:59], v[48:49]
  v_cvt_pk_bf16_f32 v60, v52, v53
  v_cvt_pk_bf16_f32 v61, v54, v55
  v_cvt_pk_bf16_f32 v62, v56, v57
  v_cvt_pk_bf16_f32 v63, v58, v59
  ds_write_b128 v42, v[60:63] offset:9216
  ds_read_b64_tr_b16 a[22:23], v40 offset:36872
  ds_read_b64_tr_b16 a[24:25], v41 offset:32768
  ds_read_b64_tr_b16 a[26:27], v41 offset:36864
  ds_read_b64_tr_b16 a[28:29], v41 offset:32776
  ds_read_b64_tr_b16 a[30:31], v41 offset:36872
  v_accvgpr_read_b32 v52, a48
  v_accvgpr_read_b32 v53, a49
  v_accvgpr_read_b32 v54, a50
  v_accvgpr_read_b32 v55, a51
  v_accvgpr_read_b32 v56, a52
  v_accvgpr_read_b32 v57, a53
  v_accvgpr_read_b32 v58, a54
  v_accvgpr_read_b32 v59, a55
  buffer_load_dwordx4 v36, s[20:23], s51 offen offset:2048 lds
  v_pk_mul_f32 v[52:53], v[52:53], v[48:49]
  v_pk_mul_f32 v[54:55], v[54:55], v[48:49]
  v_pk_mul_f32 v[56:57], v[56:57], v[48:49]
  v_pk_mul_f32 v[58:59], v[58:59], v[48:49]
  v_cvt_pk_bf16_f32 v60, v52, v53
  v_cvt_pk_bf16_f32 v61, v54, v55
  v_cvt_pk_bf16_f32 v62, v56, v57
  v_cvt_pk_bf16_f32 v63, v58, v59
  ds_write_b128 v51, v[60:63] offset:10240
  v_accvgpr_read_b32 v52, a56
  v_accvgpr_read_b32 v53, a57
  v_accvgpr_read_b32 v54, a58
  v_accvgpr_read_b32 v55, a59
  v_accvgpr_read_b32 v56, a60
  v_accvgpr_read_b32 v57, a61
  v_accvgpr_read_b32 v58, a62
  v_accvgpr_read_b32 v59, a63
  buffer_load_dwordx4 v37, s[20:23], s51 offen offset:3072 lds
  v_pk_mul_f32 v[52:53], v[52:53], v[48:49]
  v_pk_mul_f32 v[54:55], v[54:55], v[48:49]
  v_pk_mul_f32 v[56:57], v[56:57], v[48:49]
  v_pk_mul_f32 v[58:59], v[58:59], v[48:49]
  v_cvt_pk_bf16_f32 v60, v52, v53
  v_cvt_pk_bf16_f32 v61, v54, v55
  v_cvt_pk_bf16_f32 v62, v56, v57
  v_cvt_pk_bf16_f32 v63, v58, v59
  ds_write_b128 v51, v[60:63] offset:11264
  v_accvgpr_read_b32 v46, a168
  v_rcp_f32 v48, v46
  s_nop 0
  v_mov_b32 v49, v48
  v_max_f32 v47, v47, v46
  s_waitcnt lgkmcnt(0)
  v_accvgpr_read_b32 v52, a64
  v_accvgpr_read_b32 v53, a65
  v_accvgpr_read_b32 v54, a66
  v_accvgpr_read_b32 v55, a67
  v_accvgpr_read_b32 v56, a68
  v_accvgpr_read_b32 v57, a69
  v_accvgpr_read_b32 v58, a70
  v_accvgpr_read_b32 v59, a71
  s_lshl_b32 s50, s28, 13
  s_add_u32 m0, s50, 131072
  s_xor_b32 s51, s39, 131072
  s_nop 0
  buffer_load_dwordx4 v34, s[20:23], s51 offen lds
  v_pk_mul_f32 v[52:53], v[52:53], v[48:49]
  v_pk_mul_f32 v[54:55], v[54:55], v[48:49]
  v_pk_mul_f32 v[56:57], v[56:57], v[48:49]
  v_pk_mul_f32 v[58:59], v[58:59], v[48:49]
  v_cvt_pk_bf16_f32 v60, v52, v53
  v_cvt_pk_bf16_f32 v61, v54, v55
  v_cvt_pk_bf16_f32 v62, v56, v57
  v_cvt_pk_bf16_f32 v63, v58, v59
  ds_write_b128 v42, v[60:63] offset:16384
  v_accvgpr_read_b32 v52, a72
  v_accvgpr_read_b32 v53, a73
  v_accvgpr_read_b32 v54, a74
  v_accvgpr_read_b32 v55, a75
  v_accvgpr_read_b32 v56, a76
  v_accvgpr_read_b32 v57, a77
  v_accvgpr_read_b32 v58, a78
  v_accvgpr_read_b32 v59, a79
  buffer_load_dwordx4 v35, s[20:23], s51 offen offset:1024 lds
  v_pk_mul_f32 v[52:53], v[52:53], v[48:49]
  v_pk_mul_f32 v[54:55], v[54:55], v[48:49]
  v_pk_mul_f32 v[56:57], v[56:57], v[48:49]
  v_pk_mul_f32 v[58:59], v[58:59], v[48:49]
  v_cvt_pk_bf16_f32 v60, v52, v53
  v_cvt_pk_bf16_f32 v61, v54, v55
  v_cvt_pk_bf16_f32 v62, v56, v57
  v_cvt_pk_bf16_f32 v63, v58, v59
  ds_write_b128 v42, v[60:63] offset:17408
  v_accvgpr_read_b32 v52, a80
  v_accvgpr_read_b32 v53, a81
  v_accvgpr_read_b32 v54, a82
  v_accvgpr_read_b32 v55, a83
  v_accvgpr_read_b32 v56, a84
  v_accvgpr_read_b32 v57, a85
  v_accvgpr_read_b32 v58, a86
  v_accvgpr_read_b32 v59, a87
  buffer_load_dwordx4 v36, s[20:23], s51 offen offset:2048 lds
  v_pk_mul_f32 v[52:53], v[52:53], v[48:49]
  v_pk_mul_f32 v[54:55], v[54:55], v[48:49]
  v_pk_mul_f32 v[56:57], v[56:57], v[48:49]
  v_pk_mul_f32 v[58:59], v[58:59], v[48:49]
  v_cvt_pk_bf16_f32 v60, v52, v53
  v_cvt_pk_bf16_f32 v61, v54, v55
  v_cvt_pk_bf16_f32 v62, v56, v57
  v_cvt_pk_bf16_f32 v63, v58, v59
  ds_write_b128 v51, v[60:63] offset:18432
  v_accvgpr_read_b32 v52, a88
  v_accvgpr_read_b32 v53, a89
  v_accvgpr_read_b32 v54, a90
  v_accvgpr_read_b32 v55, a91
  v_accvgpr_read_b32 v56, a92
  v_accvgpr_read_b32 v57, a93
  v_accvgpr_read_b32 v58, a94
  v_accvgpr_read_b32 v59, a95
  buffer_load_dwordx4 v37, s[20:23], s51 offen offset:3072 lds
  v_pk_mul_f32 v[52:53], v[52:53], v[48:49]
  v_pk_mul_f32 v[54:55], v[54:55], v[48:49]
  v_pk_mul_f32 v[56:57], v[56:57], v[48:49]
  v_pk_mul_f32 v[58:59], v[58:59], v[48:49]
  v_cvt_pk_bf16_f32 v60, v52, v53
  v_cvt_pk_bf16_f32 v61, v54, v55
  v_cvt_pk_bf16_f32 v62, v56, v57
  v_cvt_pk_bf16_f32 v63, v58, v59
  ds_write_b128 v51, v[60:63] offset:19456
  v_accvgpr_read_b32 v46, a172
  v_rcp_f32 v48, v46
  s_nop 0
  v_mov_b32 v49, v48
  v_max_f32 v47, v47, v46
  s_waitcnt vmcnt(4)
  ds_read_b64_tr_b16 a[32:33], v38
  ds_read_b64_tr_b16 a[34:35], v38 offset:4096
  ds_read_b64_tr_b16 a[36:37], v38 offset:8
  ds_read_b64_tr_b16 a[38:39], v38 offset:4104
  ds_read_b64_tr_b16 a[40:41], v39
  ds_read_b64_tr_b16 a[42:43], v39 offset:4096
  v_accvgpr_read_b32 v52, a96
  v_accvgpr_read_b32 v53, a97
  v_accvgpr_read_b32 v54, a98
  v_accvgpr_read_b32 v55, a99
  v_accvgpr_read_b32 v56, a100
  v_accvgpr_read_b32 v57, a101
  v_accvgpr_read_b32 v58, a102
  v_accvgpr_read_b32 v59, a103
  s_lshl_b32 s50, s28, 13
  s_add_u32 m0, s50, 135168
  s_xor_b32 s51, s39, 147456
  s_nop 0
  buffer_load_dwordx4 v34, s[20:23], s51 offen lds
  v_pk_mul_f32 v[52:53], v[52:53], v[48:49]
  v_pk_mul_f32 v[54:55], v[54:55], v[48:49]
  v_pk_mul_f32 v[56:57], v[56:57], v[48:49]
  v_pk_mul_f32 v[58:59], v[58:59], v[48:49]
  v_cvt_pk_bf16_f32 v60, v52, v53
  v_cvt_pk_bf16_f32 v61, v54, v55
  v_cvt_pk_bf16_f32 v62, v56, v57
  v_cvt_pk_bf16_f32 v63, v58, v59
  ds_write_b128 v42, v[60:63] offset:24576
  ds_read_b64_tr_b16 a[44:45], v39 offset:8
  ds_read_b64_tr_b16 a[46:47], v39 offset:4104
  ds_read_b64_tr_b16 a[48:49], v40
  ds_read_b64_tr_b16 a[50:51], v40 offset:4096
  ds_read_b64_tr_b16 a[52:53], v40 offset:8
  v_accvgpr_read_b32 v52, a104
  v_accvgpr_read_b32 v53, a105
  v_accvgpr_read_b32 v54, a106
  v_accvgpr_read_b32 v55, a107
  v_accvgpr_read_b32 v56, a108
  v_accvgpr_read_b32 v57, a109
  v_accvgpr_read_b32 v58, a110
  v_accvgpr_read_b32 v59, a111
  buffer_load_dwordx4 v35, s[20:23], s51 offen offset:1024 lds
  v_pk_mul_f32 v[52:53], v[52:53], v[48:49]
  v_pk_mul_f32 v[54:55], v[54:55], v[48:49]
  v_pk_mul_f32 v[56:57], v[56:57], v[48:49]
  v_pk_mul_f32 v[58:59], v[58:59], v[48:49]
  v_cvt_pk_bf16_f32 v60, v52, v53
  v_cvt_pk_bf16_f32 v61, v54, v55
  v_cvt_pk_bf16_f32 v62, v56, v57
  v_cvt_pk_bf16_f32 v63, v58, v59
  ds_write_b128 v42, v[60:63] offset:25600
  ds_read_b64_tr_b16 a[54:55], v40 offset:4104
  ds_read_b64_tr_b16 a[56:57], v41
  ds_read_b64_tr_b16 a[58:59], v41 offset:4096
  ds_read_b64_tr_b16 a[60:61], v41 offset:8
  ds_read_b64_tr_b16 a[62:63], v41 offset:4104
  v_accvgpr_read_b32 v52, a112
  v_accvgpr_read_b32 v53, a113
  v_accvgpr_read_b32 v54, a114
  v_accvgpr_read_b32 v55, a115
  v_accvgpr_read_b32 v56, a116
  v_accvgpr_read_b32 v57, a117
  v_accvgpr_read_b32 v58, a118
  v_accvgpr_read_b32 v59, a119
  buffer_load_dwordx4 v36, s[20:23], s51 offen offset:2048 lds
  v_pk_mul_f32 v[52:53], v[52:53], v[48:49]
  v_pk_mul_f32 v[54:55], v[54:55], v[48:49]
  v_pk_mul_f32 v[56:57], v[56:57], v[48:49]
  v_pk_mul_f32 v[58:59], v[58:59], v[48:49]
  v_cvt_pk_bf16_f32 v60, v52, v53
  v_cvt_pk_bf16_f32 v61, v54, v55
  v_cvt_pk_bf16_f32 v62, v56, v57
  v_cvt_pk_bf16_f32 v63, v58, v59
  ds_write_b128 v51, v[60:63] offset:26624
  v_accvgpr_read_b32 v52, a120
  v_accvgpr_read_b32 v53, a121
  v_accvgpr_read_b32 v54, a122
  v_accvgpr_read_b32 v55, a123
  v_accvgpr_read_b32 v56, a124
  v_accvgpr_read_b32 v57, a125
  v_accvgpr_read_b32 v58, a126
  v_accvgpr_read_b32 v59, a127
  buffer_load_dwordx4 v37, s[20:23], s51 offen offset:3072 lds
  v_pk_mul_f32 v[52:53], v[52:53], v[48:49]
  v_pk_mul_f32 v[54:55], v[54:55], v[48:49]
  v_pk_mul_f32 v[56:57], v[56:57], v[48:49]
  v_pk_mul_f32 v[58:59], v[58:59], v[48:49]
  v_cvt_pk_bf16_f32 v60, v52, v53
  v_cvt_pk_bf16_f32 v61, v54, v55
  v_cvt_pk_bf16_f32 v62, v56, v57
  v_cvt_pk_bf16_f32 v63, v58, v59
  ds_write_b128 v51, v[60:63] offset:27648
  v_accvgpr_read_b32 v46, a176
  v_rcp_f32 v48, v46
  s_nop 0
  v_mov_b32 v49, v48
  v_max_f32 v47, v47, v46
  v_cmp_nge_f32 vcc, 0x4b800000, v47
  s_lshl_b32 s50, s28, 2
  s_add_u32 s50, s50, 90112
  v_mov_b32 v52, s50
  s_nop 0
  s_cmp_lg_u64 vcc, 0
  s_cselect_b32 s51, 1, 0
  v_mov_b32 v53, s51
  ds_write_b32 v52, v53
  s_waitcnt lgkmcnt(0)
  v_accvgpr_read_b32 v52, a128
  v_accvgpr_read_b32 v53, a129
  v_accvgpr_read_b32 v54, a130
  v_accvgpr_read_b32 v55, a131
  v_accvgpr_read_b32 v56, a132
  v_accvgpr_read_b32 v57, a133
  v_accvgpr_read_b32 v58, a134
  v_accvgpr_read_b32 v59, a135
  s_lshl_b32 s50, s28, 13
  s_add_u32 m0, s50, 98304
  s_xor_b32 s51, s39, 163840
  s_nop 0
  buffer_load_dwordx4 v34, s[20:23], s51 offen lds
  buffer_load_dwordx4 v35, s[20:23], s51 offen offset:1024 lds
  buffer_load_dwordx4 v36, s[20:23], s51 offen offset:2048 lds
  buffer_load_dwordx4 v37, s[20:23], s51 offen offset:3072 lds
  v_pk_mul_f32 v[52:53], v[52:53], v[48:49]
  v_pk_mul_f32 v[54:55], v[54:55], v[48:49]
  v_pk_mul_f32 v[56:57], v[56:57], v[48:49]
  v_pk_mul_f32 v[58:59], v[58:59], v[48:49]
  v_cvt_pk_bf16_f32 v60, v52, v53
  v_cvt_pk_bf16_f32 v61, v54, v55
  v_cvt_pk_bf16_f32 v62, v56, v57
  v_cvt_pk_bf16_f32 v63, v58, v59
  ds_write_b128 v50, v[60:63] offset:0
  v_accvgpr_read_b32 v52, a136
  v_accvgpr_read_b32 v53, a137
  v_accvgpr_read_b32 v54, a138
  v_accvgpr_read_b32 v55, a139
  v_accvgpr_read_b32 v56, a140
  v_accvgpr_read_b32 v57, a141
  v_accvgpr_read_b32 v58, a142
  v_accvgpr_read_b32 v59, a143
  s_lshl_b32 s50, s28, 13
  s_add_u32 m0, s50, 102400
  s_xor_b32 s51, s39, 180224
  s_nop 0
  buffer_load_dwordx4 v34, s[20:23], s51 offen lds
  buffer_load_dwordx4 v35, s[20:23], s51 offen offset:1024 lds
  buffer_load_dwordx4 v36, s[20:23], s51 offen offset:2048 lds
  buffer_load_dwordx4 v37, s[20:23], s51 offen offset:3072 lds
  v_pk_mul_f32 v[52:53], v[52:53], v[48:49]
  v_pk_mul_f32 v[54:55], v[54:55], v[48:49]
  v_pk_mul_f32 v[56:57], v[56:57], v[48:49]
  v_pk_mul_f32 v[58:59], v[58:59], v[48:49]
  v_cvt_pk_bf16_f32 v60, v52, v53
  v_cvt_pk_bf16_f32 v61, v54, v55
  v_cvt_pk_bf16_f32 v62, v56, v57
  v_cvt_pk_bf16_f32 v63, v58, v59
  ds_write_b128 v50, v[60:63] offset:1024
  s_waitcnt lgkmcnt(0)
  s_barrier
  s_mul_i32 s60, s28, 589824
  s_lshr_b32 s50, s54, 2
  s_and_b32 s51, s54, 3
  s_cmp_eq_u32 s50, s28
  s_cselect_b32 s49, s51, 7
  s_cmp_eq_u32 s49, 0
  s_cselect_b32 s50, 0x40000000, 0
  v_or_b32 v196, s50, v45
  s_cmp_eq_u32 s49, 1
  s_cselect_b32 s50, 0x40000000, 0
  v_or_b32 v197, s50, v45
  s_cmp_eq_u32 s49, 2
  s_cselect_b32 s50, 0x40000000, 0
  v_or_b32 v198, s50, v45
  s_cmp_eq_u32 s49, 3
  s_cselect_b32 s50, 0x40000000, 0
  v_or_b32 v199, s50, v45
  v_add_u32 v204, 73728, v43
  v_mov_b32 v56, 90112
  ds_read_b128 v[52:55], v56
  s_xor_b32 s50, s55, 0
  s_lshl_b32 s50, s50, 10
  v_add_u32 v240, s50, v43
  s_xor_b32 s50, s55, 1
  s_lshl_b32 s50, s50, 10
  v_add_u32 v241, s50, v43
  s_xor_b32 s50, s55, 2
  s_lshl_b32 s50, s50, 10
  v_add_u32 v242, s50, v43
  s_xor_b32 s50, s55, 3
  s_lshl_b32 s50, s50, 10
  v_add_u32 v243, s50, v43
  s_xor_b32 s50, s55, 4
  s_lshl_b32 s50, s50, 10
  v_add_u32 v244, s50, v43
  s_xor_b32 s50, s55, 5
  s_lshl_b32 s50, s50, 10
  v_add_u32 v245, s50, v43
  s_xor_b32 s50, s55, 6
  s_lshl_b32 s50, s50, 10
  v_add_u32 v246, s50, v43
  s_xor_b32 s50, s55, 7
  s_lshl_b32 s50, s50, 10
  v_add_u32 v247, s50, v43
  ds_read_b128 v[2:5], v240
  ds_read_b128 v[6:9], v241
  ds_read_b128 v[10:13], v242
  ds_read_b128 v[14:17], v243
  ds_read_b128 v[18:21], v244
  ds_read_b128 v[22:25], v245
  ds_read_b128 v[26:29], v246
  ds_read_b128 v[30:33], v247
  v_add_u32 v240, 0x2000, v240
  v_add_u32 v241, 0x2000, v241
  v_add_u32 v242, 0x2000, v242
  v_add_u32 v243, 0x2000, v243
  v_add_u32 v244, 0x2000, v244
  v_add_u32 v245, 0x2000, v245
  v_add_u32 v246, 0x2000, v246
  v_add_u32 v247, 0x2000, v247
  s_waitcnt lgkmcnt(0)
  v_or3_b32 v52, v52, v53, v54
  v_or_b32 v52, v52, v55
  s_nop 0
  v_readfirstlane_b32 s50, v52
  s_nop 3
  s_andn2_b32 s50, s50, s61
  s_cmp_lg_u32 s50, 0
  s_cbranch_scc1 L_restart
  v_mfma_f32_16x16x32_bf16 v[128:131], a[216:219], v[2:5], 0
  s_waitcnt vmcnt(8)
  ds_read_b64_tr_b16 a[64:65], v38 offset:32768
  ds_read_b64_tr_b16 a[66:67], v38 offset:36864
  v_mfma_f32_16x16x32_bf16 v[132:135], a[220:223], v[2:5], 0
  ds_read_b64_tr_b16 a[68:69], v38 offset:32776
  ds_read_b64_tr_b16 a[70:71], v38 offset:36872
  v_mfma_f32_16x16x32_bf16 v[136:139], a[224:227], v[2:5], 0
  ds_read_b64_tr_b16 a[72:73], v39 offset:32768
  ds_read_b64_tr_b16 a[74:75], v39 offset:36864
  v_mfma_f32_16x16x32_bf16 v[140:143], a[228:231], v[2:5], 0
  ds_read_b64_tr_b16 a[76:77], v39 offset:32776
  ds_read_b64_tr_b16 a[78:79], v39 offset:36872
  v_mfma_f32_16x16x32_bf16 v[144:147], a[232:235], v[2:5], 0
  ds_read_b64_tr_b16 a[80:81], v40 offset:32768
  ds_read_b64_tr_b16 a[82:83], v40 offset:36864
  v_mfma_f32_16x16x32_bf16 v[148:151], a[236:239], v[2:5], 0
  ds_read_b64_tr_b16 a[84:85], v40 offset:32776
  ds_read_b64_tr_b16 a[86:87], v40 offset:36872
  v_mfma_f32_16x16x32_bf16 v[152:155], a[240:243], v[2:5], 0
  ds_read_b64_tr_b16 a[88:89], v41 offset:32768
  ds_read_b64_tr_b16 a[90:91], v41 offset:36864
  v_mfma_f32_16x16x32_bf16 v[156:159], a[244:247], v[2:5], 0
  ds_read_b64_tr_b16 a[92:93], v41 offset:32776
  ds_read_b64_tr_b16 a[94:95], v41 offset:36872
  v_mfma_f32_16x16x32_bf16 v[128:131], v[192:195], v[6:9], v[128:131]
  ds_read_b128 v[2:5], v240
  v_mfma_f32_16x16x32_bf16 v[132:135], v[200:203], v[6:9], v[132:135]
  s_waitcnt lgkmcnt(0)
  v_mfma_f32_16x16x32_bf16 v[136:139], v[208:211], v[6:9], v[136:139]
  s_lshl_b32 s50, s28, 13
  s_add_u32 m0, s50, 131072
  s_xor_b32 s51, s39, 196608
  s_waitcnt vmcnt(0)
  v_mfma_f32_16x16x32_bf16 v[140:143], v[216:219], v[6:9], v[140:143]
  buffer_load_dwordx4 v34, s[20:23], s51 offen lds
  v_mfma_f32_16x16x32_bf16 v[144:147], v[224:227], v[6:9], v[144:147]
  ds_read_b64_tr_b16 a[96:97], v38
  ds_read_b64_tr_b16 a[98:99], v38 offset:4096
  v_mfma_f32_16x16x32_bf16 v[148:151], v[228:231], v[6:9], v[148:151]
  buffer_load_dwordx4 v35, s[20:23], s51 offen offset:1024 lds
  v_mfma_f32_16x16x32_bf16 v[152:155], v[232:235], v[6:9], v[152:155]
  ds_read_b64_tr_b16 a[100:101], v38 offset:8
  ds_read_b64_tr_b16 a[102:103], v38 offset:4104
  v_mfma_f32_16x16x32_bf16 v[156:159], v[236:239], v[6:9], v[156:159]
  buffer_load_dwordx4 v36, s[20:23], s51 offen offset:2048 lds
  v_mfma_f32_16x16x32_bf16 v[128:131], a[0:3], v[10:13], v[128:131]
  ds_read_b64_tr_b16 a[104:105], v39
  ds_read_b64_tr_b16 a[106:107], v39 offset:4096
  v_mfma_f32_16x16x32_bf16 v[132:135], a[4:7], v[10:13], v[132:135]
  buffer_load_dwordx4 v37, s[20:23], s51 offen offset:3072 lds
  v_mfma_f32_16x16x32_bf16 v[136:139], a[8:11], v[10:13], v[136:139]
  s_lshl_b32 s50, s28, 13
  s_add_u32 m0, s50, 135168
  s_xor_b32 s51, s39, 212992
  ds_read_b64_tr_b16 a[108:109], v39 offset:8
  ds_read_b64_tr_b16 a[110:111], v39 offset:4104
  v_mfma_f32_16x16x32_bf16 v[140:143], a[12:15], v[10:13], v[140:143]
  buffer_load_dwordx4 v34, s[20:23], s51 offen lds
  v_mfma_f32_16x16x32_bf16 v[144:147], a[16:19], v[10:13], v[144:147]
  ds_read_b64_tr_b16 a[112:113], v40
  ds_read_b64_tr_b16 a[114:115], v40 offset:4096
  v_mfma_f32_16x16x32_bf16 v[148:151], a[20:23], v[10:13], v[148:151]
  buffer_load_dwordx4 v35, s[20:23], s51 offen offset:1024 lds
  v_mfma_f32_16x16x32_bf16 v[152:155], a[24:27], v[10:13], v[152:155]
  ds_read_b64_tr_b16 a[116:117], v40 offset:8
  ds_read_b64_tr_b16 a[118:119], v40 offset:4104
  v_mfma_f32_16x16x32_bf16 v[156:159], a[28:31], v[10:13], v[156:159]
  buffer_load_dwordx4 v36, s[20:23], s51 offen offset:2048 lds
  v_mfma_f32_16x16x32_bf16 v[128:131], a[32:35], v[14:17], v[128:131]
  ds_read_b64_tr_b16 a[120:121], v41
  ds_read_b64_tr_b16 a[122:123], v41 offset:4096
  v_mfma_f32_16x16x32_bf16 v[132:135], a[36:39], v[14:17], v[132:135]
  buffer_load_dwordx4 v37, s[20:23], s51 offen offset:3072 lds
  v_mfma_f32_16x16x32_bf16 v[136:139], a[40:43], v[14:17], v[136:139]
  ds_read_b64_tr_b16 a[124:125], v41 offset:8
  ds_read_b64_tr_b16 a[126:127], v41 offset:4104
  v_mfma_f32_16x16x32_bf16 v[140:143], a[44:47], v[14:17], v[140:143]
  ds_read_b128 v[6:9], v241
  ds_read_b128 v[10:13], v242
  v_mfma_f32_16x16x32_bf16 v[144:147], a[48:51], v[14:17], v[144:147]
  s_waitcnt lgkmcnt(0)
  v_mfma_f32_16x16x32_bf16 v[148:151], a[52:55], v[14:17], v[148:151]
  s_lshl_b32 s50, s28, 13
  s_add_u32 m0, s50, 98304
  s_xor_b32 s51, s39, 229376
  v_mfma_f32_16x16x32_bf16 v[152:155], a[56:59], v[14:17], v[152:155]
  buffer_load_dwordx4 v34, s[20:23], s51 offen lds
  v_mfma_f32_16x16x32_bf16 v[156:159], a[60:63], v[14:17], v[156:159]
  v_mfma_f32_16x16x32_bf16 v[128:131], a[64:67], v[18:21], v[128:131]
  buffer_load_dwordx4 v35, s[20:23], s51 offen offset:1024 lds
  v_mfma_f32_16x16x32_bf16 v[132:135], a[68:71], v[18:21], v[132:135]
  ds_read_b128 v[14:17], v243
  v_mfma_f32_16x16x32_bf16 v[136:139], a[72:75], v[18:21], v[136:139]
  buffer_load_dwordx4 v36, s[20:23], s51 offen offset:2048 lds
  v_mfma_f32_16x16x32_bf16 v[140:143], a[76:79], v[18:21], v[140:143]
  v_mfma_f32_16x16x32_bf16 v[144:147], a[80:83], v[18:21], v[144:147]
  buffer_load_dwordx4 v37, s[20:23], s51 offen offset:3072 lds
  v_mfma_f32_16x16x32_bf16 v[148:151], a[84:87], v[18:21], v[148:151]
  s_lshl_b32 s50, s28, 13
  s_add_u32 m0, s50, 102400
  s_xor_b32 s51, s39, 245760
  v_mfma_f32_16x16x32_bf16 v[152:155], a[88:91], v[18:21], v[152:155]
  buffer_load_dwordx4 v34, s[20:23], s51 offen lds
  v_mfma_f32_16x16x32_bf16 v[156:159], a[92:95], v[18:21], v[156:159]
  v_mfma_f32_16x16x32_bf16 v[128:131], a[96:99], v[22:25], v[128:131]
  buffer_load_dwordx4 v35, s[20:23], s51 offen offset:1024 lds
  v_mfma_f32_16x16x32_bf16 v[132:135], a[100:103], v[22:25], v[132:135]
  ds_read_b128 v[18:21], v244
  v_mfma_f32_16x16x32_bf16 v[136:139], a[104:107], v[22:25], v[136:139]
  buffer_load_dwordx4 v36, s[20:23], s51 offen offset:2048 lds
  v_mfma_f32_16x16x32_bf16 v[140:143], a[108:111], v[22:25], v[140:143]
  v_mfma_f32_16x16x32_bf16 v[144:147], a[112:115], v[22:25], v[144:147]
  buffer_load_dwordx4 v37, s[20:23], s51 offen offset:3072 lds
  v_mfma_f32_16x16x32_bf16 v[148:151], a[116:119], v[22:25], v[148:151]
  v_mfma_f32_16x16x32_bf16 v[152:155], a[120:123], v[22:25], v[152:155]
  s_waitcnt vmcnt(8)
  ds_read_b64_tr_b16 a[128:129], v38 offset:32768
  ds_read_b64_tr_b16 a[130:131], v38 offset:36864
  ds_read_b64_tr_b16 a[132:133], v38 offset:32776
  ds_read_b64_tr_b16 a[134:135], v38 offset:36872
  v_mfma_f32_16x16x32_bf16 v[156:159], a[124:127], v[22:25], v[156:159]
  s_waitcnt lgkmcnt(2)
  ds_read_b64_tr_b16 a[136:137], v39 offset:32768
  ds_read_b64_tr_b16 a[138:139], v39 offset:36864
  ds_read_b64_tr_b16 a[140:141], v39 offset:32776
  ds_read_b64_tr_b16 a[142:143], v39 offset:36872
  v_mfma_f32_16x16x32_bf16 v[128:131], a[128:131], v[26:29], v[128:131]
  s_waitcnt lgkmcnt(4)
  ds_read_b64_tr_b16 a[144:145], v40 offset:32768
  ds_read_b64_tr_b16 a[146:147], v40 offset:36864
  ds_read_b64_tr_b16 a[148:149], v40 offset:32776
  ds_read_b64_tr_b16 a[150:151], v40 offset:36872
  v_mfma_f32_16x16x32_bf16 v[132:135], a[132:135], v[26:29], v[132:135]
  s_waitcnt lgkmcnt(6)
  ds_read_b64_tr_b16 a[152:153], v41 offset:32768
  ds_read_b64_tr_b16 a[154:155], v41 offset:36864
  ds_read_b64_tr_b16 a[156:157], v41 offset:32776
  ds_read_b64_tr_b16 a[158:159], v41 offset:36872
  v_mfma_f32_16x16x32_bf16 v[136:139], a[136:139], v[26:29], v[136:139]
  s_waitcnt lgkmcnt(8)
  ds_read_b128 v[22:25], v245
  v_mfma_f32_16x16x32_bf16 v[140:143], a[140:143], v[26:29], v[140:143]
  s_waitcnt lgkmcnt(7)
  v_mfma_f32_16x16x32_bf16 v[144:147], a[144:147], v[26:29], v[144:147]
  s_waitcnt lgkmcnt(5)
  v_mfma_f32_16x16x32_bf16 v[148:151], a[148:151], v[26:29], v[148:151]
  s_waitcnt lgkmcnt(3)
  v_mfma_f32_16x16x32_bf16 v[152:155], a[152:155], v[26:29], v[152:155]
  s_waitcnt lgkmcnt(1)
  s_waitcnt vmcnt(0)
  ds_read_b64_tr_b16 a[160:161], v38
  ds_read_b64_tr_b16 a[162:163], v38 offset:4096
  ds_read_b64_tr_b16 a[164:165], v38 offset:8
  ds_read_b64_tr_b16 a[166:167], v38 offset:4104
  v_mfma_f32_16x16x32_bf16 v[156:159], a[156:159], v[26:29], v[156:159]
  s_waitcnt lgkmcnt(2)
  ds_read_b64_tr_b16 a[168:169], v39
  ds_read_b64_tr_b16 a[170:171], v39 offset:4096
  ds_read_b64_tr_b16 a[172:173], v39 offset:8
  ds_read_b64_tr_b16 a[174:175], v39 offset:4104
  ds_read_b64_tr_b16 a[176:177], v40
  ds_read_b64_tr_b16 a[178:179], v40 offset:4096
  ds_read_b64_tr_b16 a[180:181], v40 offset:8
  ds_read_b64_tr_b16 a[182:183], v40 offset:4104
  ds_read_b64_tr_b16 a[184:185], v41
  ds_read_b64_tr_b16 a[186:187], v41 offset:4096
  ds_read_b64_tr_b16 a[188:189], v41 offset:8
  ds_read_b64_tr_b16 a[190:191], v41 offset:4104
  v_mfma_f32_16x16x32_bf16 v[128:131], a[160:163], v[30:33], v[128:131]
  s_waitcnt lgkmcnt(12)
  ds_read_b128 v[26:29], v246
  v_mfma_f32_16x16x32_bf16 v[132:135], a[164:167], v[30:33], v[132:135]
  s_waitcnt lgkmcnt(11)
  v_mfma_f32_16x16x32_bf16 v[136:139], a[168:171], v[30:33], v[136:139]
  s_waitcnt lgkmcnt(9)
  v_mfma_f32_16x16x32_bf16 v[140:143], a[172:175], v[30:33], v[140:143]
  s_waitcnt lgkmcnt(7)
  v_mfma_f32_16x16x32_bf16 v[144:147], a[176:179], v[30:33], v[144:147]
  s_waitcnt lgkmcnt(5)
  v_mfma_f32_16x16x32_bf16 v[148:151], a[180:183], v[30:33], v[148:151]
  s_waitcnt lgkmcnt(3)
  v_mfma_f32_16x16x32_bf16 v[152:155], a[184:187], v[30:33], v[152:155]
  s_waitcnt lgkmcnt(1)
  v_mfma_f32_16x16x32_bf16 v[156:159], a[188:191], v[30:33], v[156:159]
  v_mfma_f32_16x16x32_bf16 v[160:163], a[216:219], v[2:5], 0
  v_mfma_f32_16x16x32_bf16 v[164:167], a[220:223], v[2:5], 0
  ds_read_b128 v[30:33], v247
  v_mfma_f32_16x16x32_bf16 v[168:171], a[224:227], v[2:5], 0
  v_mfma_f32_16x16x32_bf16 v[172:175], a[228:231], v[2:5], 0
  v_mfma_f32_16x16x32_bf16 v[176:179], a[232:235], v[2:5], 0
  v_mfma_f32_16x16x32_bf16 v[180:183], a[236:239], v[2:5], 0
  v_mfma_f32_16x16x32_bf16 v[184:187], a[240:243], v[2:5], 0
  v_cvt_pk_bf16_f32 v48, v128, v129
  v_cvt_pk_bf16_f32 v49, v130, v131
  v_mfma_f32_16x16x32_bf16 v[188:191], a[244:247], v[2:5], 0
  s_add_u32 s51, s60, 0
  v_cvt_pk_bf16_f32 v50, v132, v133
  v_cvt_pk_bf16_f32 v51, v134, v135
  v_mfma_f32_16x16x32_bf16 v[160:163], v[192:195], v[6:9], v[160:163]
  s_cmp_eq_u32 s49, 0
  s_cbranch_scc1 L_own_0_0
L_ownb_0_0:
  buffer_store_dwordx4 v[48:51], v196, s[24:27], s51 offen sc1
  v_mfma_f32_16x16x32_bf16 v[164:167], v[200:203], v[6:9], v[164:167]
  ds_read_b128 v[2:5], v240 offset:8192
  v_mfma_f32_16x16x32_bf16 v[168:171], v[208:211], v[6:9], v[168:171]
  v_mfma_f32_16x16x32_bf16 v[172:175], v[216:219], v[6:9], v[172:175]
  v_mfma_f32_16x16x32_bf16 v[176:179], v[224:227], v[6:9], v[176:179]
  v_mfma_f32_16x16x32_bf16 v[180:183], v[228:231], v[6:9], v[180:183]
  v_mfma_f32_16x16x32_bf16 v[184:187], v[232:235], v[6:9], v[184:187]
  v_mfma_f32_16x16x32_bf16 v[188:191], v[236:239], v[6:9], v[188:191]
  v_mfma_f32_16x16x32_bf16 v[160:163], a[0:3], v[10:13], v[160:163]
  ds_read_b128 v[6:9], v241 offset:8192
  v_mfma_f32_16x16x32_bf16 v[164:167], a[4:7], v[10:13], v[164:167]
  v_mfma_f32_16x16x32_bf16 v[168:171], a[8:11], v[10:13], v[168:171]
  v_cvt_pk_bf16_f32 v52, v136, v137
  v_cvt_pk_bf16_f32 v53, v138, v139
  v_mfma_f32_16x16x32_bf16 v[172:175], a[12:15], v[10:13], v[172:175]
  s_add_u32 s51, s60, 147456
  v_cvt_pk_bf16_f32 v54, v140, v141
  v_cvt_pk_bf16_f32 v55, v142, v143
  v_mfma_f32_16x16x32_bf16 v[176:179], a[16:19], v[10:13], v[176:179]
  s_cmp_eq_u32 s49, 1
  s_cbranch_scc1 L_own_0_1
L_ownb_0_1:
  buffer_store_dwordx4 v[52:55], v197, s[24:27], s51 offen sc1
  v_mfma_f32_16x16x32_bf16 v[180:183], a[20:23], v[10:13], v[180:183]
  v_mfma_f32_16x16x32_bf16 v[184:187], a[24:27], v[10:13], v[184:187]
  v_mfma_f32_16x16x32_bf16 v[188:191], a[28:31], v[10:13], v[188:191]
  v_mfma_f32_16x16x32_bf16 v[160:163], a[32:35], v[14:17], v[160:163]
  ds_read_b128 v[10:13], v242 offset:8192
  v_mfma_f32_16x16x32_bf16 v[164:167], a[36:39], v[14:17], v[164:167]
  v_mfma_f32_16x16x32_bf16 v[168:171], a[40:43], v[14:17], v[168:171]
  v_mfma_f32_16x16x32_bf16 v[172:175], a[44:47], v[14:17], v[172:175]
  v_mfma_f32_16x16x32_bf16 v[176:179], a[48:51], v[14:17], v[176:179]
  v_mfma_f32_16x16x32_bf16 v[180:183], a[52:55], v[14:17], v[180:183]
  v_mfma_f32_16x16x32_bf16 v[184:187], a[56:59], v[14:17], v[184:187]
  v_cvt_pk_bf16_f32 v56, v144, v145
  v_cvt_pk_bf16_f32 v57, v146, v147
  v_mfma_f32_16x16x32_bf16 v[188:191], a[60:63], v[14:17], v[188:191]
  s_add_u32 s51, s60, 294912
  v_cvt_pk_bf16_f32 v58, v148, v149
  v_cvt_pk_bf16_f32 v59, v150, v151
  v_mfma_f32_16x16x32_bf16 v[160:163], a[64:67], v[18:21], v[160:163]
  s_cmp_eq_u32 s49, 2
  s_cbranch_scc1 L_own_0_2
L_ownb_0_2:
  buffer_store_dwordx4 v[56:59], v198, s[24:27], s51 offen sc1
  v_mfma_f32_16x16x32_bf16 v[164:167], a[68:71], v[18:21], v[164:167]
  ds_read_b128 v[14:17], v243 offset:8192
  v_mfma_f32_16x16x32_bf16 v[168:171], a[72:75], v[18:21], v[168:171]
  v_mfma_f32_16x16x32_bf16 v[172:175], a[76:79], v[18:21], v[172:175]
  v_mfma_f32_16x16x32_bf16 v[176:179], a[80:83], v[18:21], v[176:179]
  v_mfma_f32_16x16x32_bf16 v[180:183], a[84:87], v[18:21], v[180:183]
  v_mfma_f32_16x16x32_bf16 v[184:187], a[88:91], v[18:21], v[184:187]
  v_mfma_f32_16x16x32_bf16 v[188:191], a[92:95], v[18:21], v[188:191]
  v_mfma_f32_16x16x32_bf16 v[160:163], a[96:99], v[22:25], v[160:163]
  ds_read_b128 v[18:21], v244 offset:8192
  v_mfma_f32_16x16x32_bf16 v[164:167], a[100:103], v[22:25], v[164:167]
  v_mfma_f32_16x16x32_bf16 v[168:171], a[104:107], v[22:25], v[168:171]
  v_cvt_pk_bf16_f32 v60, v152, v153
  v_cvt_pk_bf16_f32 v61, v154, v155
  v_mfma_f32_16x16x32_bf16 v[172:175], a[108:111], v[22:25], v[172:175]
  s_add_u32 s51, s60, 442368
  v_cvt_pk_bf16_f32 v62, v156, v157
  v_cvt_pk_bf16_f32 v63, v158, v159
  v_mfma_f32_16x16x32_bf16 v[176:179], a[112:115], v[22:25], v[176:179]
  s_cmp_eq_u32 s49, 3
  s_cbranch_scc1 L_own_0_3
L_ownb_0_3:
  buffer_store_dwordx4 v[60:63], v199, s[24:27], s51 offen sc1
  v_mfma_f32_16x16x32_bf16 v[180:183], a[116:119], v[22:25], v[180:183]
  v_mfma_f32_16x16x32_bf16 v[184:187], a[120:123], v[22:25], v[184:187]
  s_branch L_ownx_0
L_own_0_0:
  ds_write_b128 v204, v[48:51] offset:0
  s_branch L_ownb_0_0
L_own_0_1:
  ds_write_b128 v204, v[52:55] offset:0
  s_branch L_ownb_0_1
L_own_0_2:
  ds_write_b128 v204, v[56:59] offset:0
  s_branch L_ownb_0_2
L_own_0_3:
  ds_write_b128 v204, v[60:63] offset:0
  s_branch L_ownb_0_3
L_ownx_0:
  v_mfma_f32_16x16x32_bf16 v[188:191], a[124:127], v[22:25], v[188:191]
  s_waitcnt lgkmcnt(6)
  v_mfma_f32_16x16x32_bf16 v[160:163], a[128:131], v[26:29], v[160:163]
  ds_read_b128 v[22:25], v245 offset:8192
  v_mfma_f32_16x16x32_bf16 v[164:167], a[132:135], v[26:29], v[164:167]
  v_mfma_f32_16x16x32_bf16 v[168:171], a[136:139], v[26:29], v[168:171]
  v_mfma_f32_16x16x32_bf16 v[172:175], a[140:143], v[26:29], v[172:175]
  v_mfma_f32_16x16x32_bf16 v[176:179], a[144:147], v[26:29], v[176:179]
  v_mfma_f32_16x16x32_bf16 v[180:183], a[148:151], v[26:29], v[180:183]
  v_mfma_f32_16x16x32_bf16 v[184:187], a[152:155], v[26:29], v[184:187]
  v_mfma_f32_16x16x32_bf16 v[188:191], a[156:159], v[26:29], v[188:191]
  s_waitcnt lgkmcnt(6)
  v_mfma_f32_16x16x32_bf16 v[160:163], a[160:163], v[30:33], v[160:163]
  ds_read_b128 v[26:29], v246 offset:8192
  v_mfma_f32_16x16x32_bf16 v[164:167], a[164:167], v[30:33], v[164:167]
  v_mfma_f32_16x16x32_bf16 v[168:171], a[168:171], v[30:33], v[168:171]
  v_mfma_f32_16x16x32_bf16 v[172:175], a[172:175], v[30:33], v[172:175]
  v_mfma_f32_16x16x32_bf16 v[176:179], a[176:179], v[30:33], v[176:179]
  v_mfma_f32_16x16x32_bf16 v[180:183], a[180:183], v[30:33], v[180:183]
  v_mfma_f32_16x16x32_bf16 v[184:187], a[184:187], v[30:33], v[184:187]
  v_mfma_f32_16x16x32_bf16 v[188:191], a[188:191], v[30:33], v[188:191]
  s_waitcnt lgkmcnt(6)
  v_mfma_f32_16x16x32_bf16 v[128:131], a[216:219], v[2:5], 0
  v_mfma_f32_16x16x32_bf16 v[132:135], a[220:223], v[2:5], 0
  ds_read_b128 v[30:33], v247 offset:8192
  v_mfma_f32_16x16x32_bf16 v[136:139], a[224:227], v[2:5], 0
  v_mfma_f32_16x16x32_bf16 v[140:143], a[228:231], v[2:5], 0
  v_mfma_f32_16x16x32_bf16 v[144:147], a[232:235], v[2:5], 0
  v_mfma_f32_16x16x32_bf16 v[148:151], a[236:239], v[2:5], 0
  v_mfma_f32_16x16x32_bf16 v[152:155], a[240:243], v[2:5], 0
  v_cvt_pk_bf16_f32 v48, v160, v161
  v_cvt_pk_bf16_f32 v49, v162, v163
  v_mfma_f32_16x16x32_bf16 v[156:159], a[244:247], v[2:5], 0
  s_waitcnt lgkmcnt(6)
  s_add_u32 s51, s60, 16384
  v_cvt_pk_bf16_f32 v50, v164, v165
  v_cvt_pk_bf16_f32 v51, v166, v167
  v_mfma_f32_16x16x32_bf16 v[128:131], v[192:195], v[6:9], v[128:131]
  s_cmp_eq_u32 s49, 0
  s_cbranch_scc1 L_own_1_0
L_ownb_1_0:
  buffer_store_dwordx4 v[48:51], v196, s[24:27], s51 offen sc1
  v_mfma_f32_16x16x32_bf16 v[132:135], v[200:203], v[6:9], v[132:135]
  ds_read_b128 v[2:5], v240 offset:16384
  v_mfma_f32_16x16x32_bf16 v[136:139], v[208:211], v[6:9], v[136:139]
  v_mfma_f32_16x16x32_bf16 v[140:143], v[216:219], v[6:9], v[140:143]
  v_mfma_f32_16x16x32_bf16 v[144:147], v[224:227], v[6:9], v[144:147]
  v_mfma_f32_16x16x32_bf16 v[148:151], v[228:231], v[6:9], v[148:151]
  v_mfma_f32_16x16x32_bf16 v[152:155], v[232:235], v[6:9], v[152:155]
  v_mfma_f32_16x16x32_bf16 v[156:159], v[236:239], v[6:9], v[156:159]
  s_waitcnt lgkmcnt(6)
  v_mfma_f32_16x16x32_bf16 v[128:131], a[0:3], v[10:13], v[128:131]
  ds_read_b128 v[6:9], v241 offset:16384
  v_mfma_f32_16x16x32_bf16 v[132:135], a[4:7], v[10:13], v[132:135]
  v_mfma_f32_16x16x32_bf16 v[136:139], a[8:11], v[10:13], v[136:139]
  v_cvt_pk_bf16_f32 v52, v168, v169
  v_cvt_pk_bf16_f32 v53, v170, v171
  v_mfma_f32_16x16x32_bf16 v[140:143], a[12:15], v[10:13], v[140:143]
  s_add_u32 s51, s60, 163840
  v_cvt_pk_bf16_f32 v54, v172, v173
  v_cvt_pk_bf16_f32 v55, v174, v175
  v_mfma_f32_16x16x32_bf16 v[144:147], a[16:19], v[10:13], v[144:147]
  s_cmp_eq_u32 s49, 1
  s_cbranch_scc1 L_own_1_1
L_ownb_1_1:
  buffer_store_dwordx4 v[52:55], v197, s[24:27], s51 offen sc1
  v_mfma_f32_16x16x32_bf16 v[148:151], a[20:23], v[10:13], v[148:151]
  v_mfma_f32_16x16x32_bf16 v[152:155], a[24:27], v[10:13], v[152:155]
  v_mfma_f32_16x16x32_bf16 v[156:159], a[28:31], v[10:13], v[156:159]
  s_waitcnt lgkmcnt(6)
  v_mfma_f32_16x16x32_bf16 v[128:131], a[32:35], v[14:17], v[128:131]
  ds_read_b128 v[10:13], v242 offset:16384
  v_mfma_f32_16x16x32_bf16 v[132:135], a[36:39], v[14:17], v[132:135]
  v_mfma_f32_16x16x32_bf16 v[136:139], a[40:43], v[14:17], v[136:139]
  v_mfma_f32_16x16x32_bf16 v[140:143], a[44:47], v[14:17], v[140:143]
  v_mfma_f32_16x16x32_bf16 v[144:147], a[48:51], v[14:17], v[144:147]
  v_mfma_f32_16x16x32_bf16 v[148:151], a[52:55], v[14:17], v[148:151]
  v_mfma_f32_16x16x32_bf16 v[152:155], a[56:59], v[14:17], v[152:155]
  v_cvt_pk_bf16_f32 v56, v176, v177
  v_cvt_pk_bf16_f32 v57, v178, v179
  v_mfma_f32_16x16x32_bf16 v[156:159], a[60:63], v[14:17], v[156:159]
  s_waitcnt lgkmcnt(6)
  s_add_u32 s51, s60, 311296
  v_cvt_pk_bf16_f32 v58, v180, v181
  v_cvt_pk_bf16_f32 v59, v182, v183
  v_mfma_f32_16x16x32_bf16 v[128:131], a[64:67], v[18:21], v[128:131]
  s_cmp_eq_u32 s49, 2
  s_cbranch_scc1 L_own_1_2
L_ownb_1_2:
  buffer_store_dwordx4 v[56:59], v198, s[24:27], s51 offen sc1
  v_mfma_f32_16x16x32_bf16 v[132:135], a[68:71], v[18:21], v[132:135]
  ds_read_b128 v[14:17], v243 offset:16384
  v_mfma_f32_16x16x32_bf16 v[136:139], a[72:75], v[18:21], v[136:139]
  v_mfma_f32_16x16x32_bf16 v[140:143], a[76:79], v[18:21], v[140:143]
  v_mfma_f32_16x16x32_bf16 v[144:147], a[80:83], v[18:21], v[144:147]
  v_mfma_f32_16x16x32_bf16 v[148:151], a[84:87], v[18:21], v[148:151]
  v_mfma_f32_16x16x32_bf16 v[152:155], a[88:91], v[18:21], v[152:155]
  v_mfma_f32_16x16x32_bf16 v[156:159], a[92:95], v[18:21], v[156:159]
  s_waitcnt lgkmcnt(6)
  v_mfma_f32_16x16x32_bf16 v[128:131], a[96:99], v[22:25], v[128:131]
  ds_read_b128 v[18:21], v244 offset:16384
  v_mfma_f32_16x16x32_bf16 v[132:135], a[100:103], v[22:25], v[132:135]
  v_mfma_f32_16x16x32_bf16 v[136:139], a[104:107], v[22:25], v[136:139]
  v_cvt_pk_bf16_f32 v60, v184, v185
  v_cvt_pk_bf16_f32 v61, v186, v187
  v_mfma_f32_16x16x32_bf16 v[140:143], a[108:111], v[22:25], v[140:143]
  s_add_u32 s51, s60, 458752
  v_cvt_pk_bf16_f32 v62, v188, v189
  v_cvt_pk_bf16_f32 v63, v190, v191
  v_mfma_f32_16x16x32_bf16 v[144:147], a[112:115], v[22:25], v[144:147]
  s_cmp_eq_u32 s49, 3
  s_cbranch_scc1 L_own_1_3
L_ownb_1_3:
  buffer_store_dwordx4 v[60:63], v199, s[24:27], s51 offen sc1
  v_mfma_f32_16x16x32_bf16 v[148:151], a[116:119], v[22:25], v[148:151]
  v_mfma_f32_16x16x32_bf16 v[152:155], a[120:123], v[22:25], v[152:155]
  s_branch L_ownx_1
L_own_1_0:
  ds_write_b128 v204, v[48:51] offset:1024
  s_branch L_ownb_1_0
L_own_1_1:
  ds_write_b128 v204, v[52:55] offset:1024
  s_branch L_ownb_1_1
L_own_1_2:
  ds_write_b128 v204, v[56:59] offset:1024
  s_branch L_ownb_1_2
L_own_1_3:
  ds_write_b128 v204, v[60:63] offset:1024
  s_branch L_ownb_1_3
L_ownx_1:
  v_mfma_f32_16x16x32_bf16 v[156:159], a[124:127], v[22:25], v[156:159]
  s_waitcnt lgkmcnt(6)
  v_mfma_f32_16x16x32_bf16 v[128:131], a[128:131], v[26:29], v[128:131]
  ds_read_b128 v[22:25], v245 offset:16384
  v_mfma_f32_16x16x32_bf16 v[132:135], a[132:135], v[26:29], v[132:135]
  v_mfma_f32_16x16x32_bf16 v[136:139], a[136:139], v[26:29], v[136:139]
  v_mfma_f32_16x16x32_bf16 v[140:143], a[140:143], v[26:29], v[140:143]
  v_mfma_f32_16x16x32_bf16 v[144:147], a[144:147], v[26:29], v[144:147]
  v_mfma_f32_16x16x32_bf16 v[148:151], a[148:151], v[26:29], v[148:151]
  v_mfma_f32_16x16x32_bf16 v[152:155], a[152:155], v[26:29], v[152:155]
  v_mfma_f32_16x16x32_bf16 v[156:159], a[156:159], v[26:29], v[156:159]
  s_waitcnt lgkmcnt(6)
  v_mfma_f32_16x16x32_bf16 v[128:131], a[160:163], v[30:33], v[128:131]
  ds_read_b128 v[26:29], v246 offset:16384
  v_mfma_f32_16x16x32_bf16 v[132:135], a[164:167], v[30:33], v[132:135]
  v_mfma_f32_16x16x32_bf16 v[136:139], a[168:171], v[30:33], v[136:139]
  v_mfma_f32_16x16x32_bf16 v[140:143], a[172:175], v[30:33], v[140:143]
  v_mfma_f32_16x16x32_bf16 v[144:147], a[176:179], v[30:33], v[144:147]
  v_mfma_f32_16x16x32_bf16 v[148:151], a[180:183], v[30:33], v[148:151]
  v_mfma_f32_16x16x32_bf16 v[152:155], a[184:187], v[30:33], v[152:155]
  v_mfma_f32_16x16x32_bf16 v[156:159], a[188:191], v[30:33], v[156:159]
  s_waitcnt lgkmcnt(6)
  v_mfma_f32_16x16x32_bf16 v[160:163], a[216:219], v[2:5], 0
  v_mfma_f32_16x16x32_bf16 v[164:167], a[220:223], v[2:5], 0
  ds_read_b128 v[30:33], v247 offset:16384
  v_mfma_f32_16x16x32_bf16 v[168:171], a[224:227], v[2:5], 0
  v_mfma_f32_16x16x32_bf16 v[172:175], a[228:231], v[2:5], 0
  v_mfma_f32_16x16x32_bf16 v[176:179], a[232:235], v[2:5], 0
  v_mfma_f32_16x16x32_bf16 v[180:183], a[236:239], v[2:5], 0
  v_mfma_f32_16x16x32_bf16 v[184:187], a[240:243], v[2:5], 0
  v_cvt_pk_bf16_f32 v48, v128, v129
  v_cvt_pk_bf16_f32 v49, v130, v131
  v_mfma_f32_16x16x32_bf16 v[188:191], a[244:247], v[2:5], 0
  s_waitcnt lgkmcnt(6)
  s_add_u32 s51, s60, 32768
  v_cvt_pk_bf16_f32 v50, v132, v133
  v_cvt_pk_bf16_f32 v51, v134, v135
  v_mfma_f32_16x16x32_bf16 v[160:163], v[192:195], v[6:9], v[160:163]
  s_cmp_eq_u32 s49, 0
  s_cbranch_scc1 L_own_2_0
L_ownb_2_0:
  buffer_store_dwordx4 v[48:51], v196, s[24:27], s51 offen sc1
  v_mfma_f32_16x16x32_bf16 v[164:167], v[200:203], v[6:9], v[164:167]
  ds_read_b128 v[2:5], v240 offset:24576
  v_mfma_f32_16x16x32_bf16 v[168:171], v[208:211], v[6:9], v[168:171]
  v_mfma_f32_16x16x32_bf16 v[172:175], v[216:219], v[6:9], v[172:175]
  v_mfma_f32_16x16x32_bf16 v[176:179], v[224:227], v[6:9], v[176:179]
  v_mfma_f32_16x16x32_bf16 v[180:183], v[228:231], v[6:9], v[180:183]
  v_mfma_f32_16x16x32_bf16 v[184:187], v[232:235], v[6:9], v[184:187]
  v_mfma_f32_16x16x32_bf16 v[188:191], v[236:239], v[6:9], v[188:191]
  s_waitcnt lgkmcnt(6)
  v_mfma_f32_16x16x32_bf16 v[160:163], a[0:3], v[10:13], v[160:163]
  ds_read_b128 v[6:9], v241 offset:24576
  v_mfma_f32_16x16x32_bf16 v[164:167], a[4:7], v[10:13], v[164:167]
  v_mfma_f32_16x16x32_bf16 v[168:171], a[8:11], v[10:13], v[168:171]
  v_cvt_pk_bf16_f32 v52, v136, v137
  v_cvt_pk_bf16_f32 v53, v138, v139
  v_mfma_f32_16x16x32_bf16 v[172:175], a[12:15], v[10:13], v[172:175]
  s_add_u32 s51, s60, 180224
  v_cvt_pk_bf16_f32 v54, v140, v141
  v_cvt_pk_bf16_f32 v55, v142, v143
  v_mfma_f32_16x16x32_bf16 v[176:179], a[16:19], v[10:13], v[176:179]
  s_cmp_eq_u32 s49, 1
  s_cbranch_scc1 L_own_2_1
L_ownb_2_1:
  buffer_store_dwordx4 v[52:55], v197, s[24:27], s51 offen sc1
  v_mfma_f32_16x16x32_bf16 v[180:183], a[20:23], v[10:13], v[180:183]
  v_mfma_f32_16x16x32_bf16 v[184:187], a[24:27], v[10:13], v[184:187]
  v_mfma_f32_16x16x32_bf16 v[188:191], a[28:31], v[10:13], v[188:191]
  s_waitcnt lgkmcnt(6)
  v_mfma_f32_16x16x32_bf16 v[160:163], a[32:35], v[14:17], v[160:163]
  ds_read_b128 v[10:13], v242 offset:24576
  v_mfma_f32_16x16x32_bf16 v[164:167], a[36:39], v[14:17], v[164:167]
  v_mfma_f32_16x16x32_bf16 v[168:171], a[40:43], v[14:17], v[168:171]
  v_mfma_f32_16x16x32_bf16 v[172:175], a[44:47], v[14:17], v[172:175]
  v_mfma_f32_16x16x32_bf16 v[176:179], a[48:51], v[14:17], v[176:179]
  v_mfma_f32_16x16x32_bf16 v[180:183], a[52:55], v[14:17], v[180:183]
  v_mfma_f32_16x16x32_bf16 v[184:187], a[56:59], v[14:17], v[184:187]
  v_cvt_pk_bf16_f32 v56, v144, v145
  v_cvt_pk_bf16_f32 v57, v146, v147
  v_mfma_f32_16x16x32_bf16 v[188:191], a[60:63], v[14:17], v[188:191]
  s_waitcnt lgkmcnt(6)
  s_add_u32 s51, s60, 327680
  v_cvt_pk_bf16_f32 v58, v148, v149
  v_cvt_pk_bf16_f32 v59, v150, v151
  v_mfma_f32_16x16x32_bf16 v[160:163], a[64:67], v[18:21], v[160:163]
  s_cmp_eq_u32 s49, 2
  s_cbranch_scc1 L_own_2_2
L_ownb_2_2:
  buffer_store_dwordx4 v[56:59], v198, s[24:27], s51 offen sc1
  v_mfma_f32_16x16x32_bf16 v[164:167], a[68:71], v[18:21], v[164:167]
  ds_read_b128 v[14:17], v243 offset:24576
  v_mfma_f32_16x16x32_bf16 v[168:171], a[72:75], v[18:21], v[168:171]
  v_mfma_f32_16x16x32_bf16 v[172:175], a[76:79], v[18:21], v[172:175]
  v_mfma_f32_16x16x32_bf16 v[176:179], a[80:83], v[18:21], v[176:179]
  v_mfma_f32_16x16x32_bf16 v[180:183], a[84:87], v[18:21], v[180:183]
  v_mfma_f32_16x16x32_bf16 v[184:187], a[88:91], v[18:21], v[184:187]
  v_mfma_f32_16x16x32_bf16 v[188:191], a[92:95], v[18:21], v[188:191]
  s_waitcnt lgkmcnt(6)
  v_mfma_f32_16x16x32_bf16 v[160:163], a[96:99], v[22:25], v[160:163]
  ds_read_b128 v[18:21], v244 offset:24576
  v_mfma_f32_16x16x32_bf16 v[164:167], a[100:103], v[22:25], v[164:167]
  v_mfma_f32_16x16x32_bf16 v[168:171], a[104:107], v[22:25], v[168:171]
  v_cvt_pk_bf16_f32 v60, v152, v153
  v_cvt_pk_bf16_f32 v61, v154, v155
  v_mfma_f32_16x16x32_bf16 v[172:175], a[108:111], v[22:25], v[172:175]
  s_add_u32 s51, s60, 475136
  v_cvt_pk_bf16_f32 v62, v156, v157
  v_cvt_pk_bf16_f32 v63, v158, v159
  v_mfma_f32_16x16x32_bf16 v[176:179], a[112:115], v[22:25], v[176:179]
  s_cmp_eq_u32 s49, 3
  s_cbranch_scc1 L_own_2_3
L_ownb_2_3:
  buffer_store_dwordx4 v[60:63], v199, s[24:27], s51 offen sc1
  v_mfma_f32_16x16x32_bf16 v[180:183], a[116:119], v[22:25], v[180:183]
  v_mfma_f32_16x16x32_bf16 v[184:187], a[120:123], v[22:25], v[184:187]
  s_branch L_ownx_2
L_own_2_0:
  ds_write_b128 v204, v[48:51] offset:2048
  s_branch L_ownb_2_0
L_own_2_1:
  ds_write_b128 v204, v[52:55] offset:2048
  s_branch L_ownb_2_1
L_own_2_2:
  ds_write_b128 v204, v[56:59] offset:2048
  s_branch L_ownb_2_2
L_own_2_3:
  ds_write_b128 v204, v[60:63] offset:2048
  s_branch L_ownb_2_3
L_ownx_2:
  v_mfma_f32_16x16x32_bf16 v[188:191], a[124:127], v[22:25], v[188:191]
  s_waitcnt lgkmcnt(6)
  v_mfma_f32_16x16x32_bf16 v[160:163], a[128:131], v[26:29], v[160:163]
  ds_read_b128 v[22:25], v245 offset:24576
  v_mfma_f32_16x16x32_bf16 v[164:167], a[132:135], v[26:29], v[164:167]
  s_lshl_b32 s50, s28, 7
  s_lshl_b32 s52, s54, 2
  s_add_u32 s50, s50, s52
  v_mfma_f32_16x16x32_bf16 v[168:171], a[136:139], v[26:29], v[168:171]
  v_lshlrev_b32 v36, 13, v1
  v_add_u32 v36, s50, v36
  v_mfma_f32_16x16x32_bf16 v[172:175], a[140:143], v[26:29], v[172:175]
  v_mov_b32 v37, 1
  v_mfma_f32_16x16x32_bf16 v[176:179], a[144:147], v[26:29], v[176:179]
  s_lshr_b32 s50, s54, 2
  s_lshl_b32 s50, s50, 7
  v_mfma_f32_16x16x32_bf16 v[180:183], a[148:151], v[26:29], v[180:183]
  v_lshrrev_b32 v46, 4, v1
  v_lshlrev_b32 v46, 9, v46
  v_mfma_f32_16x16x32_bf16 v[184:187], a[152:155], v[26:29], v[184:187]
  v_and_b32 v47, 15, v1
  v_mfma_f32_16x16x32_bf16 v[188:191], a[156:159], v[26:29], v[188:191]
  s_waitcnt lgkmcnt(6)
  v_mfma_f32_16x16x32_bf16 v[160:163], a[160:163], v[30:33], v[160:163]
  ds_read_b128 v[26:29], v246 offset:24576
  v_mfma_f32_16x16x32_bf16 v[164:167], a[164:167], v[30:33], v[164:167]
  v_mfma_f32_16x16x32_bf16 v[168:171], a[168:171], v[30:33], v[168:171]
  v_lshl_add_u32 v46, v47, 2, v46
  v_add_u32 v46, s50, v46
  v_mfma_f32_16x16x32_bf16 v[172:175], a[172:175], v[30:33], v[172:175]
  v_mfma_f32_16x16x32_bf16 v[176:179], a[176:179], v[30:33], v[176:179]
  v_mfma_f32_16x16x32_bf16 v[180:183], a[180:183], v[30:33], v[180:183]
  v_mfma_f32_16x16x32_bf16 v[184:187], a[184:187], v[30:33], v[184:187]
  v_mfma_f32_16x16x32_bf16 v[188:191], a[188:191], v[30:33], v[188:191]
  s_waitcnt lgkmcnt(6)
  v_mfma_f32_16x16x32_bf16 v[128:131], a[216:219], v[2:5], 0
  v_mfma_f32_16x16x32_bf16 v[132:135], a[220:223], v[2:5], 0
  ds_read_b128 v[30:33], v247 offset:24576
  v_mfma_f32_16x16x32_bf16 v[136:139], a[224:227], v[2:5], 0
  v_mfma_f32_16x16x32_bf16 v[140:143], a[228:231], v[2:5], 0
  v_mfma_f32_16x16x32_bf16 v[144:147], a[232:235], v[2:5], 0
  v_mfma_f32_16x16x32_bf16 v[148:151], a[236:239], v[2:5], 0
  v_mfma_f32_16x16x32_bf16 v[152:155], a[240:243], v[2:5], 0
  v_cvt_pk_bf16_f32 v48, v160, v161
  v_cvt_pk_bf16_f32 v49, v162, v163
  v_mfma_f32_16x16x32_bf16 v[156:159], a[244:247], v[2:5], 0
  s_waitcnt lgkmcnt(6)
  s_add_u32 s51, s60, 49152
  v_cvt_pk_bf16_f32 v50, v164, v165
  v_cvt_pk_bf16_f32 v51, v166, v167
  v_mfma_f32_16x16x32_bf16 v[128:131], v[192:195], v[6:9], v[128:131]
  s_cmp_eq_u32 s49, 0
  s_cbranch_scc1 L_own_3_0
L_ownb_3_0:
  buffer_store_dwordx4 v[48:51], v196, s[24:27], s51 offen sc1
  v_mfma_f32_16x16x32_bf16 v[132:135], v[200:203], v[6:9], v[132:135]
  ds_read_b128 v[2:5], v240 offset:32768
  v_mfma_f32_16x16x32_bf16 v[136:139], v[208:211], v[6:9], v[136:139]
  v_mfma_f32_16x16x32_bf16 v[140:143], v[216:219], v[6:9], v[140:143]
  v_mfma_f32_16x16x32_bf16 v[144:147], v[224:227], v[6:9], v[144:147]
  v_mfma_f32_16x16x32_bf16 v[148:151], v[228:231], v[6:9], v[148:151]
  v_mfma_f32_16x16x32_bf16 v[152:155], v[232:235], v[6:9], v[152:155]
  v_mfma_f32_16x16x32_bf16 v[156:159], v[236:239], v[6:9], v[156:159]
  s_waitcnt lgkmcnt(6)
  v_mfma_f32_16x16x32_bf16 v[128:131], a[0:3], v[10:13], v[128:131]
  ds_read_b128 v[6:9], v241 offset:32768
  v_mfma_f32_16x16x32_bf16 v[132:135], a[4:7], v[10:13], v[132:135]
  v_mfma_f32_16x16x32_bf16 v[136:139], a[8:11], v[10:13], v[136:139]
  v_cvt_pk_bf16_f32 v52, v168, v169
  v_cvt_pk_bf16_f32 v53, v170, v171
  v_mfma_f32_16x16x32_bf16 v[140:143], a[12:15], v[10:13], v[140:143]
  s_add_u32 s51, s60, 196608
  v_cvt_pk_bf16_f32 v54, v172, v173
  v_cvt_pk_bf16_f32 v55, v174, v175
  v_mfma_f32_16x16x32_bf16 v[144:147], a[16:19], v[10:13], v[144:147]
  s_cmp_eq_u32 s49, 1
  s_cbranch_scc1 L_own_3_1
L_ownb_3_1:
  buffer_store_dwordx4 v[52:55], v197, s[24:27], s51 offen sc1
  v_mfma_f32_16x16x32_bf16 v[148:151], a[20:23], v[10:13], v[148:151]
  v_mfma_f32_16x16x32_bf16 v[152:155], a[24:27], v[10:13], v[152:155]
  v_mfma_f32_16x16x32_bf16 v[156:159], a[28:31], v[10:13], v[156:159]
  s_waitcnt lgkmcnt(6)
  v_mfma_f32_16x16x32_bf16 v[128:131], a[32:35], v[14:17], v[128:131]
  ds_read_b128 v[10:13], v242 offset:32768
  v_mfma_f32_16x16x32_bf16 v[132:135], a[36:39], v[14:17], v[132:135]
  v_mfma_f32_16x16x32_bf16 v[136:139], a[40:43], v[14:17], v[136:139]
  v_mfma_f32_16x16x32_bf16 v[140:143], a[44:47], v[14:17], v[140:143]
  v_mfma_f32_16x16x32_bf16 v[144:147], a[48:51], v[14:17], v[144:147]
  v_mfma_f32_16x16x32_bf16 v[148:151], a[52:55], v[14:17], v[148:151]
  v_mfma_f32_16x16x32_bf16 v[152:155], a[56:59], v[14:17], v[152:155]
  v_cvt_pk_bf16_f32 v56, v176, v177
  v_cvt_pk_bf16_f32 v57, v178, v179
  v_mfma_f32_16x16x32_bf16 v[156:159], a[60:63], v[14:17], v[156:159]
  s_waitcnt lgkmcnt(6)
  s_add_u32 s51, s60, 344064
  v_cvt_pk_bf16_f32 v58, v180, v181
  v_cvt_pk_bf16_f32 v59, v182, v183
  v_mfma_f32_16x16x32_bf16 v[128:131], a[64:67], v[18:21], v[128:131]
  s_cmp_eq_u32 s49, 2
  s_cbranch_scc1 L_own_3_2
L_ownb_3_2:
  buffer_store_dwordx4 v[56:59], v198, s[24:27], s51 offen sc1
  v_mfma_f32_16x16x32_bf16 v[132:135], a[68:71], v[18:21], v[132:135]
  ds_read_b128 v[14:17], v243 offset:32768
  v_mfma_f32_16x16x32_bf16 v[136:139], a[72:75], v[18:21], v[136:139]
  v_mfma_f32_16x16x32_bf16 v[140:143], a[76:79], v[18:21], v[140:143]
  v_mfma_f32_16x16x32_bf16 v[144:147], a[80:83], v[18:21], v[144:147]
  v_mfma_f32_16x16x32_bf16 v[148:151], a[84:87], v[18:21], v[148:151]
  v_mfma_f32_16x16x32_bf16 v[152:155], a[88:91], v[18:21], v[152:155]
  v_mfma_f32_16x16x32_bf16 v[156:159], a[92:95], v[18:21], v[156:159]
  s_waitcnt lgkmcnt(6)
  v_mfma_f32_16x16x32_bf16 v[128:131], a[96:99], v[22:25], v[128:131]
  ds_read_b128 v[18:21], v244 offset:32768
  v_mfma_f32_16x16x32_bf16 v[132:135], a[100:103], v[22:25], v[132:135]
  v_mfma_f32_16x16x32_bf16 v[136:139], a[104:107], v[22:25], v[136:139]
  v_cvt_pk_bf16_f32 v60, v184, v185
  v_cvt_pk_bf16_f32 v61, v186, v187
  v_mfma_f32_16x16x32_bf16 v[140:143], a[108:111], v[22:25], v[140:143]
  s_add_u32 s51, s60, 491520
  v_cvt_pk_bf16_f32 v62, v188, v189
  v_cvt_pk_bf16_f32 v63, v190, v191
  v_mfma_f32_16x16x32_bf16 v[144:147], a[112:115], v[22:25], v[144:147]
  s_cmp_eq_u32 s49, 3
  s_cbranch_scc1 L_own_3_3
L_ownb_3_3:
  buffer_store_dwordx4 v[60:63], v199, s[24:27], s51 offen sc1
  v_mfma_f32_16x16x32_bf16 v[148:151], a[116:119], v[22:25], v[148:151]
  v_mfma_f32_16x16x32_bf16 v[152:155], a[120:123], v[22:25], v[152:155]
  s_branch L_ownx_3
L_own_3_0:
  ds_write_b128 v204, v[48:51] offset:3072
  s_branch L_ownb_3_0
L_own_3_1:
  ds_write_b128 v204, v[52:55] offset:3072
  s_branch L_ownb_3_1
L_own_3_2:
  ds_write_b128 v204, v[56:59] offset:3072
  s_branch L_ownb_3_2
L_own_3_3:
  ds_write_b128 v204, v[60:63] offset:3072
  s_branch L_ownb_3_3
L_ownx_3:
  v_mfma_f32_16x16x32_bf16 v[156:159], a[124:127], v[22:25], v[156:159]
  s_waitcnt lgkmcnt(6)
  v_mfma_f32_16x16x32_bf16 v[128:131], a[128:131], v[26:29], v[128:131]
  ds_read_b128 v[22:25], v245 offset:32768
  v_mfma_f32_16x16x32_bf16 v[132:135], a[132:135], v[26:29], v[132:135]
  v_mfma_f32_16x16x32_bf16 v[136:139], a[136:139], v[26:29], v[136:139]
  v_mfma_f32_16x16x32_bf16 v[140:143], a[140:143], v[26:29], v[140:143]
  v_mfma_f32_16x16x32_bf16 v[144:147], a[144:147], v[26:29], v[144:147]
  v_mfma_f32_16x16x32_bf16 v[148:151], a[148:151], v[26:29], v[148:151]
  v_mfma_f32_16x16x32_bf16 v[152:155], a[152:155], v[26:29], v[152:155]
  v_mfma_f32_16x16x32_bf16 v[156:159], a[156:159], v[26:29], v[156:159]
  s_waitcnt lgkmcnt(6)
  v_mfma_f32_16x16x32_bf16 v[128:131], a[160:163], v[30:33], v[128:131]
  ds_read_b128 v[26:29], v246 offset:32768
  v_mfma_f32_16x16x32_bf16 v[132:135], a[164:167], v[30:33], v[132:135]
  v_mfma_f32_16x16x32_bf16 v[136:139], a[168:171], v[30:33], v[136:139]
  v_mfma_f32_16x16x32_bf16 v[140:143], a[172:175], v[30:33], v[140:143]
  v_mfma_f32_16x16x32_bf16 v[144:147], a[176:179], v[30:33], v[144:147]
  v_mfma_f32_16x16x32_bf16 v[148:151], a[180:183], v[30:33], v[148:151]
  v_mfma_f32_16x16x32_bf16 v[152:155], a[184:187], v[30:33], v[152:155]
  v_mfma_f32_16x16x32_bf16 v[156:159], a[188:191], v[30:33], v[156:159]
  s_waitcnt lgkmcnt(6)
  v_mfma_f32_16x16x32_bf16 v[160:163], a[216:219], v[2:5], 0
  v_mfma_f32_16x16x32_bf16 v[164:167], a[220:223], v[2:5], 0
  ds_read_b128 v[30:33], v247 offset:32768
  v_mfma_f32_16x16x32_bf16 v[168:171], a[224:227], v[2:5], 0
  v_mfma_f32_16x16x32_bf16 v[172:175], a[228:231], v[2:5], 0
  v_mfma_f32_16x16x32_bf16 v[176:179], a[232:235], v[2:5], 0
  v_mfma_f32_16x16x32_bf16 v[180:183], a[236:239], v[2:5], 0
  v_mfma_f32_16x16x32_bf16 v[184:187], a[240:243], v[2:5], 0
  v_cvt_pk_bf16_f32 v48, v128, v129
  v_cvt_pk_bf16_f32 v49, v130, v131
  v_mfma_f32_16x16x32_bf16 v[188:191], a[244:247], v[2:5], 0
  s_waitcnt lgkmcnt(6)
  s_add_u32 s51, s60, 65536
  v_cvt_pk_bf16_f32 v50, v132, v133
  v_cvt_pk_bf16_f32 v51, v134, v135
  v_mfma_f32_16x16x32_bf16 v[160:163], v[192:195], v[6:9], v[160:163]
  s_cmp_eq_u32 s49, 0
  s_cbranch_scc1 L_own_4_0
L_ownb_4_0:
  buffer_store_dwordx4 v[48:51], v196, s[24:27], s51 offen sc1
  v_mfma_f32_16x16x32_bf16 v[164:167], v[200:203], v[6:9], v[164:167]
  ds_read_b128 v[2:5], v240 offset:40960
  v_mfma_f32_16x16x32_bf16 v[168:171], v[208:211], v[6:9], v[168:171]
  v_mfma_f32_16x16x32_bf16 v[172:175], v[216:219], v[6:9], v[172:175]
  v_mfma_f32_16x16x32_bf16 v[176:179], v[224:227], v[6:9], v[176:179]
  v_mfma_f32_16x16x32_bf16 v[180:183], v[228:231], v[6:9], v[180:183]
  v_mfma_f32_16x16x32_bf16 v[184:187], v[232:235], v[6:9], v[184:187]
  v_mfma_f32_16x16x32_bf16 v[188:191], v[236:239], v[6:9], v[188:191]
  s_waitcnt lgkmcnt(6)
  v_mfma_f32_16x16x32_bf16 v[160:163], a[0:3], v[10:13], v[160:163]
  ds_read_b128 v[6:9], v241 offset:40960
  v_mfma_f32_16x16x32_bf16 v[164:167], a[4:7], v[10:13], v[164:167]
  v_mfma_f32_16x16x32_bf16 v[168:171], a[8:11], v[10:13], v[168:171]
  v_cvt_pk_bf16_f32 v52, v136, v137
  v_cvt_pk_bf16_f32 v53, v138, v139
  v_mfma_f32_16x16x32_bf16 v[172:175], a[12:15], v[10:13], v[172:175]
  s_add_u32 s51, s60, 212992
  v_cvt_pk_bf16_f32 v54, v140, v141
  v_cvt_pk_bf16_f32 v55, v142, v143
  v_mfma_f32_16x16x32_bf16 v[176:179], a[16:19], v[10:13], v[176:179]
  s_cmp_eq_u32 s49, 1
  s_cbranch_scc1 L_own_4_1
L_ownb_4_1:
  buffer_store_dwordx4 v[52:55], v197, s[24:27], s51 offen sc1
  v_mfma_f32_16x16x32_bf16 v[180:183], a[20:23], v[10:13], v[180:183]
  v_mfma_f32_16x16x32_bf16 v[184:187], a[24:27], v[10:13], v[184:187]
  v_mfma_f32_16x16x32_bf16 v[188:191], a[28:31], v[10:13], v[188:191]
  s_waitcnt lgkmcnt(6)
  v_mfma_f32_16x16x32_bf16 v[160:163], a[32:35], v[14:17], v[160:163]
  ds_read_b128 v[10:13], v242 offset:40960
  v_mfma_f32_16x16x32_bf16 v[164:167], a[36:39], v[14:17], v[164:167]
  v_mfma_f32_16x16x32_bf16 v[168:171], a[40:43], v[14:17], v[168:171]
  v_mfma_f32_16x16x32_bf16 v[172:175], a[44:47], v[14:17], v[172:175]
  v_mfma_f32_16x16x32_bf16 v[176:179], a[48:51], v[14:17], v[176:179]
  v_mfma_f32_16x16x32_bf16 v[180:183], a[52:55], v[14:17], v[180:183]
  v_mfma_f32_16x16x32_bf16 v[184:187], a[56:59], v[14:17], v[184:187]
  v_cvt_pk_bf16_f32 v56, v144, v145
  v_cvt_pk_bf16_f32 v57, v146, v147
  v_mfma_f32_16x16x32_bf16 v[188:191], a[60:63], v[14:17], v[188:191]
  s_waitcnt lgkmcnt(6)
  s_add_u32 s51, s60, 360448
  v_cvt_pk_bf16_f32 v58, v148, v149
  v_cvt_pk_bf16_f32 v59, v150, v151
  v_mfma_f32_16x16x32_bf16 v[160:163], a[64:67], v[18:21], v[160:163]
  s_cmp_eq_u32 s49, 2
  s_cbranch_scc1 L_own_4_2
L_ownb_4_2:
  buffer_store_dwordx4 v[56:59], v198, s[24:27], s51 offen sc1
  v_mfma_f32_16x16x32_bf16 v[164:167], a[68:71], v[18:21], v[164:167]
  ds_read_b128 v[14:17], v243 offset:40960
  v_mfma_f32_16x16x32_bf16 v[168:171], a[72:75], v[18:21], v[168:171]
  v_mfma_f32_16x16x32_bf16 v[172:175], a[76:79], v[18:21], v[172:175]
  v_mfma_f32_16x16x32_bf16 v[176:179], a[80:83], v[18:21], v[176:179]
  v_mfma_f32_16x16x32_bf16 v[180:183], a[84:87], v[18:21], v[180:183]
  v_mfma_f32_16x16x32_bf16 v[184:187], a[88:91], v[18:21], v[184:187]
  v_mfma_f32_16x16x32_bf16 v[188:191], a[92:95], v[18:21], v[188:191]
  s_waitcnt lgkmcnt(6)
  v_mfma_f32_16x16x32_bf16 v[160:163], a[96:99], v[22:25], v[160:163]
  ds_read_b128 v[18:21], v244 offset:40960
  v_mfma_f32_16x16x32_bf16 v[164:167], a[100:103], v[22:25], v[164:167]
  v_mfma_f32_16x16x32_bf16 v[168:171], a[104:107], v[22:25], v[168:171]
  v_cvt_pk_bf16_f32 v60, v152, v153
  v_cvt_pk_bf16_f32 v61, v154, v155
  v_mfma_f32_16x16x32_bf16 v[172:175], a[108:111], v[22:25], v[172:175]
  s_add_u32 s51, s60, 507904
  v_cvt_pk_bf16_f32 v62, v156, v157
  v_cvt_pk_bf16_f32 v63, v158, v159
  v_mfma_f32_16x16x32_bf16 v[176:179], a[112:115], v[22:25], v[176:179]
  s_cmp_eq_u32 s49, 3
  s_cbranch_scc1 L_own_4_3
L_ownb_4_3:
  buffer_store_dwordx4 v[60:63], v199, s[24:27], s51 offen sc1
  v_mfma_f32_16x16x32_bf16 v[180:183], a[116:119], v[22:25], v[180:183]
  v_mfma_f32_16x16x32_bf16 v[184:187], a[120:123], v[22:25], v[184:187]
  s_branch L_ownx_4
L_own_4_0:
  ds_write_b128 v204, v[48:51] offset:4096
  s_branch L_ownb_4_0
L_own_4_1:
  ds_write_b128 v204, v[52:55] offset:4096
  s_branch L_ownb_4_1
L_own_4_2:
  ds_write_b128 v204, v[56:59] offset:4096
  s_branch L_ownb_4_2
L_own_4_3:
  ds_write_b128 v204, v[60:63] offset:4096
  s_branch L_ownb_4_3
L_ownx_4:
  v_mfma_f32_16x16x32_bf16 v[188:191], a[124:127], v[22:25], v[188:191]
  s_waitcnt lgkmcnt(6)
  v_mfma_f32_16x16x32_bf16 v[160:163], a[128:131], v[26:29], v[160:163]
  ds_read_b128 v[22:25], v245 offset:40960
  v_mfma_f32_16x16x32_bf16 v[164:167], a[132:135], v[26:29], v[164:167]
  v_mfma_f32_16x16x32_bf16 v[168:171], a[136:139], v[26:29], v[168:171]
  v_mfma_f32_16x16x32_bf16 v[172:175], a[140:143], v[26:29], v[172:175]
  v_mfma_f32_16x16x32_bf16 v[176:179], a[144:147], v[26:29], v[176:179]
  v_mfma_f32_16x16x32_bf16 v[180:183], a[148:151], v[26:29], v[180:183]
  v_mfma_f32_16x16x32_bf16 v[184:187], a[152:155], v[26:29], v[184:187]
  v_mfma_f32_16x16x32_bf16 v[188:191], a[156:159], v[26:29], v[188:191]
  s_waitcnt lgkmcnt(6)
  v_mfma_f32_16x16x32_bf16 v[160:163], a[160:163], v[30:33], v[160:163]
  ds_read_b128 v[26:29], v246 offset:40960
  v_mfma_f32_16x16x32_bf16 v[164:167], a[164:167], v[30:33], v[164:167]
  v_mfma_f32_16x16x32_bf16 v[168:171], a[168:171], v[30:33], v[168:171]
  v_mfma_f32_16x16x32_bf16 v[172:175], a[172:175], v[30:33], v[172:175]
  v_mfma_f32_16x16x32_bf16 v[176:179], a[176:179], v[30:33], v[176:179]
  v_mfma_f32_16x16x32_bf16 v[180:183], a[180:183], v[30:33], v[180:183]
  v_mfma_f32_16x16x32_bf16 v[184:187], a[184:187], v[30:33], v[184:187]
  v_mfma_f32_16x16x32_bf16 v[188:191], a[188:191], v[30:33], v[188:191]
  s_waitcnt lgkmcnt(6)
  v_mfma_f32_16x16x32_bf16 v[128:131], a[216:219], v[2:5], 0
  v_mfma_f32_16x16x32_bf16 v[132:135], a[220:223], v[2:5], 0
  ds_read_b128 v[30:33], v247 offset:40960
  v_mfma_f32_16x16x32_bf16 v[136:139], a[224:227], v[2:5], 0
  v_mfma_f32_16x16x32_bf16 v[140:143], a[228:231], v[2:5], 0
  v_mfma_f32_16x16x32_bf16 v[144:147], a[232:235], v[2:5], 0
  v_mfma_f32_16x16x32_bf16 v[148:151], a[236:239], v[2:5], 0
  v_mfma_f32_16x16x32_bf16 v[152:155], a[240:243], v[2:5], 0
  v_cvt_pk_bf16_f32 v48, v160, v161
  v_cvt_pk_bf16_f32 v49, v162, v163
  v_mfma_f32_16x16x32_bf16 v[156:159], a[244:247], v[2:5], 0
  s_waitcnt lgkmcnt(6)
  s_add_u32 s51, s60, 81920
  v_cvt_pk_bf16_f32 v50, v164, v165
  v_cvt_pk_bf16_f32 v51, v166, v167
  v_mfma_f32_16x16x32_bf16 v[128:131], v[192:195], v[6:9], v[128:131]
  s_cmp_eq_u32 s49, 0
  s_cbranch_scc1 L_own_5_0
L_ownb_5_0:
  buffer_store_dwordx4 v[48:51], v196, s[24:27], s51 offen sc1
  v_mfma_f32_16x16x32_bf16 v[132:135], v[200:203], v[6:9], v[132:135]
  ds_read_b128 v[2:5], v240 offset:49152
  v_mfma_f32_16x16x32_bf16 v[136:139], v[208:211], v[6:9], v[136:139]
  v_mfma_f32_16x16x32_bf16 v[140:143], v[216:219], v[6:9], v[140:143]
  v_mfma_f32_16x16x32_bf16 v[144:147], v[224:227], v[6:9], v[144:147]
  v_mfma_f32_16x16x32_bf16 v[148:151], v[228:231], v[6:9], v[148:151]
  v_mfma_f32_16x16x32_bf16 v[152:155], v[232:235], v[6:9], v[152:155]
  v_mfma_f32_16x16x32_bf16 v[156:159], v[236:239], v[6:9], v[156:159]
  s_waitcnt lgkmcnt(6)
  v_mfma_f32_16x16x32_bf16 v[128:131], a[0:3], v[10:13], v[128:131]
  ds_read_b128 v[6:9], v241 offset:49152
  v_mfma_f32_16x16x32_bf16 v[132:135], a[4:7], v[10:13], v[132:135]
  v_mfma_f32_16x16x32_bf16 v[136:139], a[8:11], v[10:13], v[136:139]
  v_cvt_pk_bf16_f32 v52, v168, v169
  v_cvt_pk_bf16_f32 v53, v170, v171
  v_mfma_f32_16x16x32_bf16 v[140:143], a[12:15], v[10:13], v[140:143]
  s_add_u32 s51, s60, 229376
  v_cvt_pk_bf16_f32 v54, v172, v173
  v_cvt_pk_bf16_f32 v55, v174, v175
  v_mfma_f32_16x16x32_bf16 v[144:147], a[16:19], v[10:13], v[144:147]
  s_cmp_eq_u32 s49, 1
  s_cbranch_scc1 L_own_5_1
L_ownb_5_1:
  buffer_store_dwordx4 v[52:55], v197, s[24:27], s51 offen sc1
  v_mfma_f32_16x16x32_bf16 v[148:151], a[20:23], v[10:13], v[148:151]
  v_mfma_f32_16x16x32_bf16 v[152:155], a[24:27], v[10:13], v[152:155]
  v_mfma_f32_16x16x32_bf16 v[156:159], a[28:31], v[10:13], v[156:159]
  s_waitcnt lgkmcnt(6)
  v_mfma_f32_16x16x32_bf16 v[128:131], a[32:35], v[14:17], v[128:131]
  ds_read_b128 v[10:13], v242 offset:49152
  v_mfma_f32_16x16x32_bf16 v[132:135], a[36:39], v[14:17], v[132:135]
  v_mfma_f32_16x16x32_bf16 v[136:139], a[40:43], v[14:17], v[136:139]
  v_mfma_f32_16x16x32_bf16 v[140:143], a[44:47], v[14:17], v[140:143]
  v_mfma_f32_16x16x32_bf16 v[144:147], a[48:51], v[14:17], v[144:147]
  v_mfma_f32_16x16x32_bf16 v[148:151], a[52:55], v[14:17], v[148:151]
  v_mfma_f32_16x16x32_bf16 v[152:155], a[56:59], v[14:17], v[152:155]
  v_cvt_pk_bf16_f32 v56, v176, v177
  v_cvt_pk_bf16_f32 v57, v178, v179
  v_mfma_f32_16x16x32_bf16 v[156:159], a[60:63], v[14:17], v[156:159]
  s_waitcnt lgkmcnt(6)
  s_add_u32 s51, s60, 376832
  v_cvt_pk_bf16_f32 v58, v180, v181
  v_cvt_pk_bf16_f32 v59, v182, v183
  v_mfma_f32_16x16x32_bf16 v[128:131], a[64:67], v[18:21], v[128:131]
  s_cmp_eq_u32 s49, 2
  s_cbranch_scc1 L_own_5_2
L_ownb_5_2:
  buffer_store_dwordx4 v[56:59], v198, s[24:27], s51 offen sc1
  v_mfma_f32_16x16x32_bf16 v[132:135], a[68:71], v[18:21], v[132:135]
  ds_read_b128 v[14:17], v243 offset:49152
  v_mfma_f32_16x16x32_bf16 v[136:139], a[72:75], v[18:21], v[136:139]
  v_mfma_f32_16x16x32_bf16 v[140:143], a[76:79], v[18:21], v[140:143]
  v_mfma_f32_16x16x32_bf16 v[144:147], a[80:83], v[18:21], v[144:147]
  v_mfma_f32_16x16x32_bf16 v[148:151], a[84:87], v[18:21], v[148:151]
  v_mfma_f32_16x16x32_bf16 v[152:155], a[88:91], v[18:21], v[152:155]
  v_mfma_f32_16x16x32_bf16 v[156:159], a[92:95], v[18:21], v[156:159]
  s_waitcnt lgkmcnt(6)
  v_mfma_f32_16x16x32_bf16 v[128:131], a[96:99], v[22:25], v[128:131]
  ds_read_b128 v[18:21], v244 offset:49152
  v_mfma_f32_16x16x32_bf16 v[132:135], a[100:103], v[22:25], v[132:135]
  v_mfma_f32_16x16x32_bf16 v[136:139], a[104:107], v[22:25], v[136:139]
  v_cvt_pk_bf16_f32 v60, v184, v185
  v_cvt_pk_bf16_f32 v61, v186, v187
  v_mfma_f32_16x16x32_bf16 v[140:143], a[108:111], v[22:25], v[140:143]
  s_add_u32 s51, s60, 524288
  v_cvt_pk_bf16_f32 v62, v188, v189
  v_cvt_pk_bf16_f32 v63, v190, v191
  v_mfma_f32_16x16x32_bf16 v[144:147], a[112:115], v[22:25], v[144:147]
  s_cmp_eq_u32 s49, 3
  s_cbranch_scc1 L_own_5_3
L_ownb_5_3:
  buffer_store_dwordx4 v[60:63], v199, s[24:27], s51 offen sc1
  v_mfma_f32_16x16x32_bf16 v[148:151], a[116:119], v[22:25], v[148:151]
  v_mfma_f32_16x16x32_bf16 v[152:155], a[120:123], v[22:25], v[152:155]
  s_branch L_ownx_5
L_own_5_0:
  ds_write_b128 v204, v[48:51] offset:5120
  s_branch L_ownb_5_0
L_own_5_1:
  ds_write_b128 v204, v[52:55] offset:5120
  s_branch L_ownb_5_1
L_own_5_2:
  ds_write_b128 v204, v[56:59] offset:5120
  s_branch L_ownb_5_2
L_own_5_3:
  ds_write_b128 v204, v[60:63] offset:5120
  s_branch L_ownb_5_3
L_ownx_5:
  v_mfma_f32_16x16x32_bf16 v[156:159], a[124:127], v[22:25], v[156:159]
  s_waitcnt lgkmcnt(6)
  v_mfma_f32_16x16x32_bf16 v[128:131], a[128:131], v[26:29], v[128:131]
  ds_read_b128 v[22:25], v245 offset:49152
  v_mfma_f32_16x16x32_bf16 v[132:135], a[132:135], v[26:29], v[132:135]
  v_mfma_f32_16x16x32_bf16 v[136:139], a[136:139], v[26:29], v[136:139]
  v_mfma_f32_16x16x32_bf16 v[140:143], a[140:143], v[26:29], v[140:143]
  v_mfma_f32_16x16x32_bf16 v[144:147], a[144:147], v[26:29], v[144:147]
  v_mfma_f32_16x16x32_bf16 v[148:151], a[148:151], v[26:29], v[148:151]
  v_mfma_f32_16x16x32_bf16 v[152:155], a[152:155], v[26:29], v[152:155]
  v_mfma_f32_16x16x32_bf16 v[156:159], a[156:159], v[26:29], v[156:159]
  s_waitcnt lgkmcnt(6)
  v_mfma_f32_16x16x32_bf16 v[128:131], a[160:163], v[30:33], v[128:131]
  ds_read_b128 v[26:29], v246 offset:49152
  v_mfma_f32_16x16x32_bf16 v[132:135], a[164:167], v[30:33], v[132:135]
  v_mfma_f32_16x16x32_bf16 v[136:139], a[168:171], v[30:33], v[136:139]
  v_mfma_f32_16x16x32_bf16 v[140:143], a[172:175], v[30:33], v[140:143]
  v_mfma_f32_16x16x32_bf16 v[144:147], a[176:179], v[30:33], v[144:147]
  v_mfma_f32_16x16x32_bf16 v[148:151], a[180:183], v[30:33], v[148:151]
  v_mfma_f32_16x16x32_bf16 v[152:155], a[184:187], v[30:33], v[152:155]
  v_mfma_f32_16x16x32_bf16 v[156:159], a[188:191], v[30:33], v[156:159]
  s_waitcnt lgkmcnt(6)
  v_mfma_f32_16x16x32_bf16 v[160:163], a[216:219], v[2:5], 0
  v_mfma_f32_16x16x32_bf16 v[164:167], a[220:223], v[2:5], 0
  ds_read_b128 v[30:33], v247 offset:49152
  v_mfma_f32_16x16x32_bf16 v[168:171], a[224:227], v[2:5], 0
  v_mfma_f32_16x16x32_bf16 v[172:175], a[228:231], v[2:5], 0
  v_mfma_f32_16x16x32_bf16 v[176:179], a[232:235], v[2:5], 0
  v_mfma_f32_16x16x32_bf16 v[180:183], a[236:239], v[2:5], 0
  v_mfma_f32_16x16x32_bf16 v[184:187], a[240:243], v[2:5], 0
  v_cvt_pk_bf16_f32 v48, v128, v129
  v_cvt_pk_bf16_f32 v49, v130, v131
  v_mfma_f32_16x16x32_bf16 v[188:191], a[244:247], v[2:5], 0
  s_waitcnt lgkmcnt(6)
  s_add_u32 s51, s60, 98304
  v_cvt_pk_bf16_f32 v50, v132, v133
  v_cvt_pk_bf16_f32 v51, v134, v135
  v_mfma_f32_16x16x32_bf16 v[160:163], v[192:195], v[6:9], v[160:163]
  s_cmp_eq_u32 s49, 0
  s_cbranch_scc1 L_own_6_0
L_ownb_6_0:
  buffer_store_dwordx4 v[48:51], v196, s[24:27], s51 offen sc1
  v_mfma_f32_16x16x32_bf16 v[164:167], v[200:203], v[6:9], v[164:167]
  ds_read_b128 v[2:5], v240 offset:57344
  v_mfma_f32_16x16x32_bf16 v[168:171], v[208:211], v[6:9], v[168:171]
  v_mfma_f32_16x16x32_bf16 v[172:175], v[216:219], v[6:9], v[172:175]
  v_mfma_f32_16x16x32_bf16 v[176:179], v[224:227], v[6:9], v[176:179]
  v_mfma_f32_16x16x32_bf16 v[180:183], v[228:231], v[6:9], v[180:183]
  v_mfma_f32_16x16x32_bf16 v[184:187], v[232:235], v[6:9], v[184:187]
  v_mfma_f32_16x16x32_bf16 v[188:191], v[236:239], v[6:9], v[188:191]
  s_waitcnt lgkmcnt(6)
  v_mfma_f32_16x16x32_bf16 v[160:163], a[0:3], v[10:13], v[160:163]
  ds_read_b128 v[6:9], v241 offset:57344
  v_mfma_f32_16x16x32_bf16 v[164:167], a[4:7], v[10:13], v[164:167]
  v_mfma_f32_16x16x32_bf16 v[168:171], a[8:11], v[10:13], v[168:171]
  v_cvt_pk_bf16_f32 v52, v136, v137
  v_cvt_pk_bf16_f32 v53, v138, v139
  v_mfma_f32_16x16x32_bf16 v[172:175], a[12:15], v[10:13], v[172:175]
  s_add_u32 s51, s60, 245760
  v_cvt_pk_bf16_f32 v54, v140, v141
  v_cvt_pk_bf16_f32 v55, v142, v143
  v_mfma_f32_16x16x32_bf16 v[176:179], a[16:19], v[10:13], v[176:179]
  s_cmp_eq_u32 s49, 1
  s_cbranch_scc1 L_own_6_1
L_ownb_6_1:
  buffer_store_dwordx4 v[52:55], v197, s[24:27], s51 offen sc1
  v_mfma_f32_16x16x32_bf16 v[180:183], a[20:23], v[10:13], v[180:183]
  v_mfma_f32_16x16x32_bf16 v[184:187], a[24:27], v[10:13], v[184:187]
  v_mfma_f32_16x16x32_bf16 v[188:191], a[28:31], v[10:13], v[188:191]
  s_waitcnt lgkmcnt(6)
  v_mfma_f32_16x16x32_bf16 v[160:163], a[32:35], v[14:17], v[160:163]
  ds_read_b128 v[10:13], v242 offset:57344
  v_mfma_f32_16x16x32_bf16 v[164:167], a[36:39], v[14:17], v[164:167]
  v_mfma_f32_16x16x32_bf16 v[168:171], a[40:43], v[14:17], v[168:171]
  v_mfma_f32_16x16x32_bf16 v[172:175], a[44:47], v[14:17], v[172:175]
  v_mfma_f32_16x16x32_bf16 v[176:179], a[48:51], v[14:17], v[176:179]
  v_mfma_f32_16x16x32_bf16 v[180:183], a[52:55], v[14:17], v[180:183]
  v_mfma_f32_16x16x32_bf16 v[184:187], a[56:59], v[14:17], v[184:187]
  v_cvt_pk_bf16_f32 v56, v144, v145
  v_cvt_pk_bf16_f32 v57, v146, v147
  v_mfma_f32_16x16x32_bf16 v[188:191], a[60:63], v[14:17], v[188:191]
  s_waitcnt lgkmcnt(6)
  s_add_u32 s51, s60, 393216
  v_cvt_pk_bf16_f32 v58, v148, v149
  v_cvt_pk_bf16_f32 v59, v150, v151
  v_mfma_f32_16x16x32_bf16 v[160:163], a[64:67], v[18:21], v[160:163]
  s_cmp_eq_u32 s49, 2
  s_cbranch_scc1 L_own_6_2
L_ownb_6_2:
  buffer_store_dwordx4 v[56:59], v198, s[24:27], s51 offen sc1
  v_mfma_f32_16x16x32_bf16 v[164:167], a[68:71], v[18:21], v[164:167]
  ds_read_b128 v[14:17], v243 offset:57344
  v_mfma_f32_16x16x32_bf16 v[168:171], a[72:75], v[18:21], v[168:171]
  v_mfma_f32_16x16x32_bf16 v[172:175], a[76:79], v[18:21], v[172:175]
  v_mfma_f32_16x16x32_bf16 v[176:179], a[80:83], v[18:21], v[176:179]
  v_mfma_f32_16x16x32_bf16 v[180:183], a[84:87], v[18:21], v[180:183]
  v_mfma_f32_16x16x32_bf16 v[184:187], a[88:91], v[18:21], v[184:187]
  v_mfma_f32_16x16x32_bf16 v[188:191], a[92:95], v[18:21], v[188:191]
  s_waitcnt lgkmcnt(6)
  v_mfma_f32_16x16x32_bf16 v[160:163], a[96:99], v[22:25], v[160:163]
  ds_read_b128 v[18:21], v244 offset:57344
  v_mfma_f32_16x16x32_bf16 v[164:167], a[100:103], v[22:25], v[164:167]
  v_mfma_f32_16x16x32_bf16 v[168:171], a[104:107], v[22:25], v[168:171]
  v_cvt_pk_bf16_f32 v60, v152, v153
  v_cvt_pk_bf16_f32 v61, v154, v155
  v_mfma_f32_16x16x32_bf16 v[172:175], a[108:111], v[22:25], v[172:175]
  s_add_u32 s51, s60, 540672
  v_cvt_pk_bf16_f32 v62, v156, v157
  v_cvt_pk_bf16_f32 v63, v158, v159
  v_mfma_f32_16x16x32_bf16 v[176:179], a[112:115], v[22:25], v[176:179]
  s_cmp_eq_u32 s49, 3
  s_cbranch_scc1 L_own_6_3
L_ownb_6_3:
  buffer_store_dwordx4 v[60:63], v199, s[24:27], s51 offen sc1
  v_mfma_f32_16x16x32_bf16 v[180:183], a[116:119], v[22:25], v[180:183]
  v_mfma_f32_16x16x32_bf16 v[184:187], a[120:123], v[22:25], v[184:187]
  s_branch L_ownx_6
L_own_6_0:
  ds_write_b128 v204, v[48:51] offset:6144
  s_branch L_ownb_6_0
L_own_6_1:
  ds_write_b128 v204, v[52:55] offset:6144
  s_branch L_ownb_6_1
L_own_6_2:
  ds_write_b128 v204, v[56:59] offset:6144
  s_branch L_ownb_6_2
L_own_6_3:
  ds_write_b128 v204, v[60:63] offset:6144
  s_branch L_ownb_6_3
L_ownx_6:
  v_mfma_f32_16x16x32_bf16 v[188:191], a[124:127], v[22:25], v[188:191]
  s_waitcnt lgkmcnt(6)
  v_mfma_f32_16x16x32_bf16 v[160:163], a[128:131], v[26:29], v[160:163]
  ds_read_b128 v[22:25], v245 offset:57344
  v_mfma_f32_16x16x32_bf16 v[164:167], a[132:135], v[26:29], v[164:167]
  v_mfma_f32_16x16x32_bf16 v[168:171], a[136:139], v[26:29], v[168:171]
  v_mfma_f32_16x16x32_bf16 v[172:175], a[140:143], v[26:29], v[172:175]
  v_mfma_f32_16x16x32_bf16 v[176:179], a[144:147], v[26:29], v[176:179]
  v_mfma_f32_16x16x32_bf16 v[180:183], a[148:151], v[26:29], v[180:183]
  v_mfma_f32_16x16x32_bf16 v[184:187], a[152:155], v[26:29], v[184:187]
  v_mfma_f32_16x16x32_bf16 v[188:191], a[156:159], v[26:29], v[188:191]
  s_waitcnt lgkmcnt(6)
  v_mfma_f32_16x16x32_bf16 v[160:163], a[160:163], v[30:33], v[160:163]
  ds_read_b128 v[26:29], v246 offset:57344
  v_mfma_f32_16x16x32_bf16 v[164:167], a[164:167], v[30:33], v[164:167]
  v_mfma_f32_16x16x32_bf16 v[168:171], a[168:171], v[30:33], v[168:171]
  v_mfma_f32_16x16x32_bf16 v[172:175], a[172:175], v[30:33], v[172:175]
  v_mfma_f32_16x16x32_bf16 v[176:179], a[176:179], v[30:33], v[176:179]
  v_mfma_f32_16x16x32_bf16 v[180:183], a[180:183], v[30:33], v[180:183]
  v_mfma_f32_16x16x32_bf16 v[184:187], a[184:187], v[30:33], v[184:187]
  v_mfma_f32_16x16x32_bf16 v[188:191], a[188:191], v[30:33], v[188:191]
  s_waitcnt lgkmcnt(6)
  v_mfma_f32_16x16x32_bf16 v[128:131], a[216:219], v[2:5], 0
  v_mfma_f32_16x16x32_bf16 v[132:135], a[220:223], v[2:5], 0
  ds_read_b128 v[30:33], v247 offset:57344
  v_mfma_f32_16x16x32_bf16 v[136:139], a[224:227], v[2:5], 0
  v_mfma_f32_16x16x32_bf16 v[140:143], a[228:231], v[2:5], 0
  v_mfma_f32_16x16x32_bf16 v[144:147], a[232:235], v[2:5], 0
  v_mfma_f32_16x16x32_bf16 v[148:151], a[236:239], v[2:5], 0
  v_mfma_f32_16x16x32_bf16 v[152:155], a[240:243], v[2:5], 0
  v_cvt_pk_bf16_f32 v48, v160, v161
  v_cvt_pk_bf16_f32 v49, v162, v163
  v_mfma_f32_16x16x32_bf16 v[156:159], a[244:247], v[2:5], 0
  s_waitcnt lgkmcnt(6)
  s_add_u32 s51, s60, 114688
  v_cvt_pk_bf16_f32 v50, v164, v165
  v_cvt_pk_bf16_f32 v51, v166, v167
  v_mfma_f32_16x16x32_bf16 v[128:131], v[192:195], v[6:9], v[128:131]
  s_cmp_eq_u32 s49, 0
  s_cbranch_scc1 L_own_7_0
L_ownb_7_0:
  buffer_store_dwordx4 v[48:51], v196, s[24:27], s51 offen sc1
  v_mfma_f32_16x16x32_bf16 v[132:135], v[200:203], v[6:9], v[132:135]
  v_mfma_f32_16x16x32_bf16 v[136:139], v[208:211], v[6:9], v[136:139]
  v_mfma_f32_16x16x32_bf16 v[140:143], v[216:219], v[6:9], v[140:143]
  v_mfma_f32_16x16x32_bf16 v[144:147], v[224:227], v[6:9], v[144:147]
  v_mfma_f32_16x16x32_bf16 v[148:151], v[228:231], v[6:9], v[148:151]
  v_mfma_f32_16x16x32_bf16 v[152:155], v[232:235], v[6:9], v[152:155]
  v_mfma_f32_16x16x32_bf16 v[156:159], v[236:239], v[6:9], v[156:159]
  s_waitcnt lgkmcnt(5)
  v_mfma_f32_16x16x32_bf16 v[128:131], a[0:3], v[10:13], v[128:131]
  v_mfma_f32_16x16x32_bf16 v[132:135], a[4:7], v[10:13], v[132:135]
  v_mfma_f32_16x16x32_bf16 v[136:139], a[8:11], v[10:13], v[136:139]
  v_cvt_pk_bf16_f32 v52, v168, v169
  v_cvt_pk_bf16_f32 v53, v170, v171
  v_mfma_f32_16x16x32_bf16 v[140:143], a[12:15], v[10:13], v[140:143]
  s_add_u32 s51, s60, 262144
  v_cvt_pk_bf16_f32 v54, v172, v173
  v_cvt_pk_bf16_f32 v55, v174, v175
  v_mfma_f32_16x16x32_bf16 v[144:147], a[16:19], v[10:13], v[144:147]
  s_cmp_eq_u32 s49, 1
  s_cbranch_scc1 L_own_7_1
L_ownb_7_1:
  buffer_store_dwordx4 v[52:55], v197, s[24:27], s51 offen sc1
  v_mfma_f32_16x16x32_bf16 v[148:151], a[20:23], v[10:13], v[148:151]
  v_mfma_f32_16x16x32_bf16 v[152:155], a[24:27], v[10:13], v[152:155]
  v_mfma_f32_16x16x32_bf16 v[156:159], a[28:31], v[10:13], v[156:159]
  s_waitcnt lgkmcnt(4)
  v_mfma_f32_16x16x32_bf16 v[128:131], a[32:35], v[14:17], v[128:131]
  v_mfma_f32_16x16x32_bf16 v[132:135], a[36:39], v[14:17], v[132:135]
  v_mfma_f32_16x16x32_bf16 v[136:139], a[40:43], v[14:17], v[136:139]
  v_mfma_f32_16x16x32_bf16 v[140:143], a[44:47], v[14:17], v[140:143]
  v_mfma_f32_16x16x32_bf16 v[144:147], a[48:51], v[14:17], v[144:147]
  v_mfma_f32_16x16x32_bf16 v[148:151], a[52:55], v[14:17], v[148:151]
  v_mfma_f32_16x16x32_bf16 v[152:155], a[56:59], v[14:17], v[152:155]
  v_cvt_pk_bf16_f32 v56, v176, v177
  v_cvt_pk_bf16_f32 v57, v178, v179
  v_mfma_f32_16x16x32_bf16 v[156:159], a[60:63], v[14:17], v[156:159]
  s_waitcnt lgkmcnt(3)
  s_add_u32 s51, s60, 409600
  v_cvt_pk_bf16_f32 v58, v180, v181
  v_cvt_pk_bf16_f32 v59, v182, v183
  v_mfma_f32_16x16x32_bf16 v[128:131], a[64:67], v[18:21], v[128:131]
  s_cmp_eq_u32 s49, 2
  s_cbranch_scc1 L_own_7_2
L_ownb_7_2:
  buffer_store_dwordx4 v[56:59], v198, s[24:27], s51 offen sc1
  v_mfma_f32_16x16x32_bf16 v[132:135], a[68:71], v[18:21], v[132:135]
  v_mfma_f32_16x16x32_bf16 v[136:139], a[72:75], v[18:21], v[136:139]
  v_mfma_f32_16x16x32_bf16 v[140:143], a[76:79], v[18:21], v[140:143]
  v_mfma_f32_16x16x32_bf16 v[144:147], a[80:83], v[18:21], v[144:147]
  v_mfma_f32_16x16x32_bf16 v[148:151], a[84:87], v[18:21], v[148:151]
  v_mfma_f32_16x16x32_bf16 v[152:155], a[88:91], v[18:21], v[152:155]
  v_mfma_f32_16x16x32_bf16 v[156:159], a[92:95], v[18:21], v[156:159]
  s_waitcnt lgkmcnt(2)
  v_mfma_f32_16x16x32_bf16 v[128:131], a[96:99], v[22:25], v[128:131]
  s_waitcnt vmcnt(15)
  v_mfma_f32_16x16x32_bf16 v[132:135], a[100:103], v[22:25], v[132:135]
  buffer_store_dword v37, v36, s[68:71], 0 offen sc1
  v_mfma_f32_16x16x32_bf16 v[136:139], a[104:107], v[22:25], v[136:139]
  v_cvt_pk_bf16_f32 v60, v184, v185
  v_cvt_pk_bf16_f32 v61, v186, v187
  v_mfma_f32_16x16x32_bf16 v[140:143], a[108:111], v[22:25], v[140:143]
  s_add_u32 s51, s60, 557056
  v_cvt_pk_bf16_f32 v62, v188, v189
  v_cvt_pk_bf16_f32 v63, v190, v191
  v_mfma_f32_16x16x32_bf16 v[144:147], a[112:115], v[22:25], v[144:147]
  s_cmp_eq_u32 s49, 3
  s_cbranch_scc1 L_own_7_3
L_ownb_7_3:
  buffer_store_dwordx4 v[60:63], v199, s[24:27], s51 offen sc1
  v_mfma_f32_16x16x32_bf16 v[148:151], a[116:119], v[22:25], v[148:151]
  v_mfma_f32_16x16x32_bf16 v[152:155], a[120:123], v[22:25], v[152:155]
  s_branch L_ownx_7
L_own_7_0:
  ds_write_b128 v204, v[48:51] offset:7168
  s_branch L_ownb_7_0
L_own_7_1:
  ds_write_b128 v204, v[52:55] offset:7168
  s_branch L_ownb_7_1
L_own_7_2:
  ds_write_b128 v204, v[56:59] offset:7168
  s_branch L_ownb_7_2
L_own_7_3:
  ds_write_b128 v204, v[60:63] offset:7168
  s_branch L_ownb_7_3
L_ownx_7:
  v_mfma_f32_16x16x32_bf16 v[156:159], a[124:127], v[22:25], v[156:159]
  s_waitcnt lgkmcnt(1)
  v_mfma_f32_16x16x32_bf16 v[128:131], a[128:131], v[26:29], v[128:131]
  v_mfma_f32_16x16x32_bf16 v[132:135], a[132:135], v[26:29], v[132:135]
  v_mfma_f32_16x16x32_bf16 v[136:139], a[136:139], v[26:29], v[136:139]
  v_mfma_f32_16x16x32_bf16 v[140:143], a[140:143], v[26:29], v[140:143]
  v_mfma_f32_16x16x32_bf16 v[144:147], a[144:147], v[26:29], v[144:147]
  v_mfma_f32_16x16x32_bf16 v[148:151], a[148:151], v[26:29], v[148:151]
  v_mfma_f32_16x16x32_bf16 v[152:155], a[152:155], v[26:29], v[152:155]
  v_mfma_f32_16x16x32_bf16 v[156:159], a[156:159], v[26:29], v[156:159]
  s_waitcnt lgkmcnt(0)
  v_mfma_f32_16x16x32_bf16 v[128:131], a[160:163], v[30:33], v[128:131]
  v_mfma_f32_16x16x32_bf16 v[132:135], a[164:167], v[30:33], v[132:135]
  v_mfma_f32_16x16x32_bf16 v[136:139], a[168:171], v[30:33], v[136:139]
  v_mfma_f32_16x16x32_bf16 v[140:143], a[172:175], v[30:33], v[140:143]
  v_mfma_f32_16x16x32_bf16 v[144:147], a[176:179], v[30:33], v[144:147]
  buffer_load_dword v47, v46, s[68:71], 0 offen sc1
  v_mfma_f32_16x16x32_bf16 v[148:151], a[180:183], v[30:33], v[148:151]
  v_mfma_f32_16x16x32_bf16 v[152:155], a[184:187], v[30:33], v[152:155]
  v_mfma_f32_16x16x32_bf16 v[156:159], a[188:191], v[30:33], v[156:159]
  s_nop 7
  v_cvt_pk_bf16_f32 v48, v128, v129
  v_cvt_pk_bf16_f32 v49, v130, v131
  v_cvt_pk_bf16_f32 v50, v132, v133
  v_cvt_pk_bf16_f32 v51, v134, v135
  s_add_u32 s51, s60, 131072
  s_cmp_eq_u32 s49, 0
  s_cbranch_scc1 L_own_8_0
L_ownb_8_0:
  buffer_store_dwordx4 v[48:51], v196, s[24:27], s51 offen sc1
  v_cvt_pk_bf16_f32 v52, v136, v137
  v_cvt_pk_bf16_f32 v53, v138, v139
  v_cvt_pk_bf16_f32 v54, v140, v141
  v_cvt_pk_bf16_f32 v55, v142, v143
  s_add_u32 s51, s60, 278528
  s_cmp_eq_u32 s49, 1
  s_cbranch_scc1 L_own_8_1
L_ownb_8_1:
  buffer_store_dwordx4 v[52:55], v197, s[24:27], s51 offen sc1
  v_cvt_pk_bf16_f32 v56, v144, v145
  v_cvt_pk_bf16_f32 v57, v146, v147
  v_cvt_pk_bf16_f32 v58, v148, v149
  v_cvt_pk_bf16_f32 v59, v150, v151
  s_add_u32 s51, s60, 425984
  s_cmp_eq_u32 s49, 2
  s_cbranch_scc1 L_own_8_2
L_ownb_8_2:
  buffer_store_dwordx4 v[56:59], v198, s[24:27], s51 offen sc1
  v_cvt_pk_bf16_f32 v60, v152, v153
  v_cvt_pk_bf16_f32 v61, v154, v155
  v_cvt_pk_bf16_f32 v62, v156, v157
  v_cvt_pk_bf16_f32 v63, v158, v159
  s_add_u32 s51, s60, 573440
  s_cmp_eq_u32 s49, 3
  s_cbranch_scc1 L_own_8_3
L_ownb_8_3:
  buffer_store_dwordx4 v[60:63], v199, s[24:27], s51 offen sc1
  s_branch L_ownx_8
L_own_8_0:
  ds_write_b128 v204, v[48:51] offset:8192
  s_branch L_ownb_8_0
L_own_8_1:
  ds_write_b128 v204, v[52:55] offset:8192
  s_branch L_ownb_8_1
L_own_8_2:
  ds_write_b128 v204, v[56:59] offset:8192
  s_branch L_ownb_8_2
L_own_8_3:
  ds_write_b128 v204, v[60:63] offset:8192
  s_branch L_ownb_8_3
L_ownx_8:
  s_waitcnt vmcnt(4)
  buffer_store_dword v37, v36, s[68:71], 0 offen offset:512 sc1
  s_waitcnt vmcnt(1)
  buffer_store_dword v37, v36, s[68:71], 0 offen offset:1024 sc1
  v_lshrrev_b32 v30, 4, v1
  v_and_b32 v31, 15, v1
  v_lshlrev_b32 v32, 4, v1
  v_lshlrev_b32 v33, 11, v31
  v_lshl_add_u32 v33, v30, 4, v33
  s_mul_i32 s33, s54, 147456
  s_lshl_b32 s50, s28, 14
  s_add_u32 s34, s33, s50
  s_add_u32 s35, s34, 65536
  s_add_u32 s36, s33, 131072
  s_lshl_b32 s50, s28, 12
  s_add_u32 s36, s36, s50
  s_lshl_b32 s41, s28, 2
  s_mov_b32 s53, 262144
  s_mov_b32 s60, 0xffff0000
  s_cmp_eq_u32 s28, 0
  s_cbranch_scc0 L_poll_a_skip
L_poll_a:
  v_cmp_eq_u32 vcc, 1, v47
  s_nop 3
  s_and_b32 s50, vcc_lo, 0xffff
  s_cmp_eq_u32 s50, 0xffff
  s_cbranch_scc1 L_poll_a_ok
  s_sub_u32 s53, s53, 1
  s_cmp_eq_u32 s53, 0
  s_cbranch_scc1 L_poll_a_ok
  s_sleep 8
  buffer_load_dword v47, v46, s[68:71], 0 offen sc1
  s_waitcnt vmcnt(0)
  s_branch L_poll_a
L_poll_a_ok:
L_poll_a_skip:
  s_waitcnt lgkmcnt(0)
  s_barrier
  s_add_u32 s50, s34, 0
  s_cmp_eq_u32 s54, 0
  s_cbranch_scc1 L_rl_s34_0
  buffer_load_dwordx4 v[64:67], v32, s[24:27], s50 offen sc1
L_rl_s34_0:
  s_cmp_eq_u32 s54, 1
  s_cbranch_scc1 L_rl_s34_1
  buffer_load_dwordx4 v[68:71], v32, s[24:27], s50 offen offset:1024 sc1
L_rl_s34_1:
  s_cmp_eq_u32 s54, 2
  s_cbranch_scc1 L_rl_s34_2
  buffer_load_dwordx4 v[72:75], v32, s[24:27], s50 offen offset:2048 sc1
L_rl_s34_2:
  s_cmp_eq_u32 s54, 3
  s_cbranch_scc1 L_rl_s34_3
  buffer_load_dwordx4 v[76:79], v32, s[24:27], s50 offen offset:3072 sc1
L_rl_s34_3:
  s_add_u32 s50, s34, 4096
  s_cmp_eq_u32 s54, 4
  s_cbranch_scc1 L_rl_s34_4
  buffer_load_dwordx4 v[80:83], v32, s[24:27], s50 offen sc1
L_rl_s34_4:
  s_cmp_eq_u32 s54, 5
  s_cbranch_scc1 L_rl_s34_5
  buffer_load_dwordx4 v[84:87], v32, s[24:27], s50 offen offset:1024 sc1
L_rl_s34_5:
  s_cmp_eq_u32 s54, 6
  s_cbranch_scc1 L_rl_s34_6
  buffer_load_dwordx4 v[88:91], v32, s[24:27], s50 offen offset:2048 sc1
L_rl_s34_6:
  s_cmp_eq_u32 s54, 7
  s_cbranch_scc1 L_rl_s34_7
  buffer_load_dwordx4 v[92:95], v32, s[24:27], s50 offen offset:3072 sc1
L_rl_s34_7:
  s_add_u32 s50, s34, 8192
  s_cmp_eq_u32 s54, 8
  s_cbranch_scc1 L_rl_s34_8
  buffer_load_dwordx4 v[96:99], v32, s[24:27], s50 offen sc1
L_rl_s34_8:
  s_cmp_eq_u32 s54, 9
  s_cbranch_scc1 L_rl_s34_9
  buffer_load_dwordx4 v[100:103], v32, s[24:27], s50 offen offset:1024 sc1
L_rl_s34_9:
  s_cmp_eq_u32 s54, 10
  s_cbranch_scc1 L_rl_s34_10
  buffer_load_dwordx4 v[104:107], v32, s[24:27], s50 offen offset:2048 sc1
L_rl_s34_10:
  s_cmp_eq_u32 s54, 11
  s_cbranch_scc1 L_rl_s34_11
  buffer_load_dwordx4 v[108:111], v32, s[24:27], s50 offen offset:3072 sc1
L_rl_s34_11:
  s_add_u32 s50, s34, 12288
  s_cmp_eq_u32 s54, 12
  s_cbranch_scc1 L_rl_s34_12
  buffer_load_dwordx4 v[112:115], v32, s[24:27], s50 offen sc1
L_rl_s34_12:
  s_cmp_eq_u32 s54, 13
  s_cbranch_scc1 L_rl_s34_13
  buffer_load_dwordx4 v[116:119], v32, s[24:27], s50 offen offset:1024 sc1
L_rl_s34_13:
  s_cmp_eq_u32 s54, 14
  s_cbranch_scc1 L_rl_s34_14
  buffer_load_dwordx4 v[120:123], v32, s[24:27], s50 offen offset:2048 sc1
L_rl_s34_14:
  s_cmp_eq_u32 s54, 15
  s_cbranch_scc1 L_rl_s34_15
  buffer_load_dwordx4 v[124:127], v32, s[24:27], s50 offen offset:3072 sc1
L_rl_s34_15:
  s_lshl_b32 s50, s28, 10
  s_add_u32 s50, s50, 73728
  v_add_u32 v44, s50, v32
  ds_read_b128 v[36:39], v44
  ds_read_b128 v[40:43], v44 offset:4096
  v_mov_b32 v208, 0
  v_mov_b32 v209, 0
  v_mov_b32 v210, 0
  v_mov_b32 v211, 0
  v_mov_b32 v212, 0
  v_mov_b32 v213, 0
  v_mov_b32 v214, 0
  v_mov_b32 v215, 0
  v_mov_b32 v216, 0
  v_mov_b32 v217, 0
  v_mov_b32 v218, 0
  v_mov_b32 v219, 0
  v_mov_b32 v220, 0
  v_mov_b32 v221, 0
  v_mov_b32 v222, 0
  v_mov_b32 v223, 0
  v_mov_b32 v224, 0
  v_mov_b32 v225, 0
  v_mov_b32 v226, 0
  v_mov_b32 v227, 0
  v_mov_b32 v228, 0
  v_mov_b32 v229, 0
  v_mov_b32 v230, 0
  v_mov_b32 v231, 0
  s_mul_i32 s32, s55, 294912
  s_lshl_b32 s50, s56, 10
  s_add_u32 s32, s32, s50
  s_lshl_b32 s50, s54, 6
  s_add_u32 s32, s32, s50
  s_cmp_eq_u32 s28, 0
  s_cbranch_scc0 L_poll_b_skip
  buffer_load_dword v47, v46, s[68:71], 0 offen sc1
  s_waitcnt vmcnt(0)
L_poll_b:
  v_cmp_eq_u32 vcc, 1, v47
  s_nop 3
  s_lshr_b32 s50, vcc_lo, 16
  s_and_b32 s51, vcc_hi, 0xffff
  s_lshl_b32 s51, s51, 16
  s_or_b32 s50, s50, s51
  s_cmp_eq_u32 s50, -1
  s_cbranch_scc1 L_poll_b_ok
  s_sub_u32 s53, s53, 1
  s_cmp_eq_u32 s53, 0
  s_cbranch_scc1 L_poll_b_ok
  s_sleep 8
  buffer_load_dword v47, v46, s[68:71], 0 offen sc1
  s_waitcnt vmcnt(0)
  s_branch L_poll_b
L_poll_b_ok:
L_poll_b_skip:
  s_waitcnt vmcnt(0)
  s_barrier
  s_add_u32 s50, s35, 0
  s_cmp_eq_u32 s54, 0
  s_cbranch_scc1 L_rl_s35_0
  buffer_load_dwordx4 v[128:131], v32, s[24:27], s50 offen sc1
L_rl_s35_0:
  s_cmp_eq_u32 s54, 1
  s_cbranch_scc1 L_rl_s35_1
  buffer_load_dwordx4 v[132:135], v32, s[24:27], s50 offen offset:1024 sc1
L_rl_s35_1:
  s_cmp_eq_u32 s54, 2
  s_cbranch_scc1 L_rl_s35_2
  buffer_load_dwordx4 v[136:139], v32, s[24:27], s50 offen offset:2048 sc1
L_rl_s35_2:
  s_cmp_eq_u32 s54, 3
  s_cbranch_scc1 L_rl_s35_3
  buffer_load_dwordx4 v[140:143], v32, s[24:27], s50 offen offset:3072 sc1
L_rl_s35_3:
  s_add_u32 s50, s35, 4096
  s_cmp_eq_u32 s54, 4
  s_cbranch_scc1 L_rl_s35_4
  buffer_load_dwordx4 v[144:147], v32, s[24:27], s50 offen sc1
L_rl_s35_4:
  s_cmp_eq_u32 s54, 5
  s_cbranch_scc1 L_rl_s35_5
  buffer_load_dwordx4 v[148:151], v32, s[24:27], s50 offen offset:1024 sc1
L_rl_s35_5:
  s_cmp_eq_u32 s54, 6
  s_cbranch_scc1 L_rl_s35_6
  buffer_load_dwordx4 v[152:155], v32, s[24:27], s50 offen offset:2048 sc1
L_rl_s35_6:
  s_cmp_eq_u32 s54, 7
  s_cbranch_scc1 L_rl_s35_7
  buffer_load_dwordx4 v[156:159], v32, s[24:27], s50 offen offset:3072 sc1
L_rl_s35_7:
  s_add_u32 s50, s35, 8192
  s_cmp_eq_u32 s54, 8
  s_cbranch_scc1 L_rl_s35_8
  buffer_load_dwordx4 v[160:163], v32, s[24:27], s50 offen sc1
L_rl_s35_8:
  s_cmp_eq_u32 s54, 9
  s_cbranch_scc1 L_rl_s35_9
  buffer_load_dwordx4 v[164:167], v32, s[24:27], s50 offen offset:1024 sc1
L_rl_s35_9:
  s_cmp_eq_u32 s54, 10
  s_cbranch_scc1 L_rl_s35_10
  buffer_load_dwordx4 v[168:171], v32, s[24:27], s50 offen offset:2048 sc1
L_rl_s35_10:
  s_cmp_eq_u32 s54, 11
  s_cbranch_scc1 L_rl_s35_11
  buffer_load_dwordx4 v[172:175], v32, s[24:27], s50 offen offset:3072 sc1
L_rl_s35_11:
  s_add_u32 s50, s35, 12288
  s_cmp_eq_u32 s54, 12
  s_cbranch_scc1 L_rl_s35_12
  buffer_load_dwordx4 v[176:179], v32, s[24:27], s50 offen sc1
L_rl_s35_12:
  s_cmp_eq_u32 s54, 13
  s_cbranch_scc1 L_rl_s35_13
  buffer_load_dwordx4 v[180:183], v32, s[24:27], s50 offen offset:1024 sc1
L_rl_s35_13:
  s_cmp_eq_u32 s54, 14
  s_cbranch_scc1 L_rl_s35_14
  buffer_load_dwordx4 v[184:187], v32, s[24:27], s50 offen offset:2048 sc1
L_rl_s35_14:
  s_cmp_eq_u32 s54, 15
  s_cbranch_scc1 L_rl_s35_15
  buffer_load_dwordx4 v[188:191], v32, s[24:27], s50 offen offset:3072 sc1
L_rl_s35_15:
  s_add_u32 s50, s41, 0
  s_cmp_eq_u32 s54, s50
  s_cbranch_scc1 L_rl8_0
  buffer_load_dwordx4 v[192:195], v32, s[24:27], s36 offen sc1
L_rl8_0:
  s_add_u32 s50, s41, 1
  s_cmp_eq_u32 s54, s50
  s_cbranch_scc1 L_rl8_1
  buffer_load_dwordx4 v[196:199], v32, s[24:27], s36 offen offset:1024 sc1
L_rl8_1:
  s_add_u32 s50, s41, 2
  s_cmp_eq_u32 s54, s50
  s_cbranch_scc1 L_rl8_2
  buffer_load_dwordx4 v[200:203], v32, s[24:27], s36 offen offset:2048 sc1
L_rl8_2:
  s_add_u32 s50, s41, 3
  s_cmp_eq_u32 s54, s50
  s_cbranch_scc1 L_rl8_3
  buffer_load_dwordx4 v[204:207], v32, s[24:27], s36 offen offset:3072 sc1
L_rl8_3:
  s_cmp_eq_u32 s54, 0
  s_cbranch_scc1 L_rs_a0
  v_lshlrev_b32 v26, 16, v64
  v_and_b32 v27, s60, v64
  v_pk_add_f32 v[208:209], v[208:209], v[26:27]
  v_lshlrev_b32 v28, 16, v65
  v_and_b32 v29, s60, v65
  v_pk_add_f32 v[210:211], v[210:211], v[28:29]
  v_lshlrev_b32 v26, 16, v66
  v_and_b32 v27, s60, v66
  v_pk_add_f32 v[212:213], v[212:213], v[26:27]
  v_lshlrev_b32 v28, 16, v67
  v_and_b32 v29, s60, v67
  v_pk_add_f32 v[214:215], v[214:215], v[28:29]
L_rs_a0:
  s_cmp_eq_u32 s54, 1
  s_cbranch_scc1 L_rs_a1
  v_lshlrev_b32 v26, 16, v68
  v_and_b32 v27, s60, v68
  v_pk_add_f32 v[208:209], v[208:209], v[26:27]
  v_lshlrev_b32 v28, 16, v69
  v_and_b32 v29, s60, v69
  v_pk_add_f32 v[210:211], v[210:211], v[28:29]
  v_lshlrev_b32 v26, 16, v70
  v_and_b32 v27, s60, v70
  v_pk_add_f32 v[212:213], v[212:213], v[26:27]
  v_lshlrev_b32 v28, 16, v71
  v_and_b32 v29, s60, v71
  v_pk_add_f32 v[214:215], v[214:215], v[28:29]
L_rs_a1:
  s_cmp_eq_u32 s54, 2
  s_cbranch_scc1 L_rs_a2
  v_lshlrev_b32 v26, 16, v72
  v_and_b32 v27, s60, v72
  v_pk_add_f32 v[208:209], v[208:209], v[26:27]
  v_lshlrev_b32 v28, 16, v73
  v_and_b32 v29, s60, v73
  v_pk_add_f32 v[210:211], v[210:211], v[28:29]
  v_lshlrev_b32 v26, 16, v74
  v_and_b32 v27, s60, v74
  v_pk_add_f32 v[212:213], v[212:213], v[26:27]
  v_lshlrev_b32 v28, 16, v75
  v_and_b32 v29, s60, v75
  v_pk_add_f32 v[214:215], v[214:215], v[28:29]
L_rs_a2:
  s_cmp_eq_u32 s54, 3
  s_cbranch_scc1 L_rs_a3
  v_lshlrev_b32 v26, 16, v76
  v_and_b32 v27, s60, v76
  v_pk_add_f32 v[208:209], v[208:209], v[26:27]
  v_lshlrev_b32 v28, 16, v77
  v_and_b32 v29, s60, v77
  v_pk_add_f32 v[210:211], v[210:211], v[28:29]
  v_lshlrev_b32 v26, 16, v78
  v_and_b32 v27, s60, v78
  v_pk_add_f32 v[212:213], v[212:213], v[26:27]
  v_lshlrev_b32 v28, 16, v79
  v_and_b32 v29, s60, v79
  v_pk_add_f32 v[214:215], v[214:215], v[28:29]
L_rs_a3:
  s_cmp_eq_u32 s54, 4
  s_cbranch_scc1 L_rs_a4
  v_lshlrev_b32 v26, 16, v80
  v_and_b32 v27, s60, v80
  v_pk_add_f32 v[208:209], v[208:209], v[26:27]
  v_lshlrev_b32 v28, 16, v81
  v_and_b32 v29, s60, v81
  v_pk_add_f32 v[210:211], v[210:211], v[28:29]
  v_lshlrev_b32 v26, 16, v82
  v_and_b32 v27, s60, v82
  v_pk_add_f32 v[212:213], v[212:213], v[26:27]
  v_lshlrev_b32 v28, 16, v83
  v_and_b32 v29, s60, v83
  v_pk_add_f32 v[214:215], v[214:215], v[28:29]
L_rs_a4:
  s_cmp_eq_u32 s54, 5
  s_cbranch_scc1 L_rs_a5
  v_lshlrev_b32 v26, 16, v84
  v_and_b32 v27, s60, v84
  v_pk_add_f32 v[208:209], v[208:209], v[26:27]
  v_lshlrev_b32 v28, 16, v85
  v_and_b32 v29, s60, v85
  v_pk_add_f32 v[210:211], v[210:211], v[28:29]
  v_lshlrev_b32 v26, 16, v86
  v_and_b32 v27, s60, v86
  v_pk_add_f32 v[212:213], v[212:213], v[26:27]
  v_lshlrev_b32 v28, 16, v87
  v_and_b32 v29, s60, v87
  v_pk_add_f32 v[214:215], v[214:215], v[28:29]
L_rs_a5:
  s_cmp_eq_u32 s54, 6
  s_cbranch_scc1 L_rs_a6
  v_lshlrev_b32 v26, 16, v88
  v_and_b32 v27, s60, v88
  v_pk_add_f32 v[208:209], v[208:209], v[26:27]
  v_lshlrev_b32 v28, 16, v89
  v_and_b32 v29, s60, v89
  v_pk_add_f32 v[210:211], v[210:211], v[28:29]
  v_lshlrev_b32 v26, 16, v90
  v_and_b32 v27, s60, v90
  v_pk_add_f32 v[212:213], v[212:213], v[26:27]
  v_lshlrev_b32 v28, 16, v91
  v_and_b32 v29, s60, v91
  v_pk_add_f32 v[214:215], v[214:215], v[28:29]
L_rs_a6:
  s_cmp_eq_u32 s54, 7
  s_cbranch_scc1 L_rs_a7
  v_lshlrev_b32 v26, 16, v92
  v_and_b32 v27, s60, v92
  v_pk_add_f32 v[208:209], v[208:209], v[26:27]
  v_lshlrev_b32 v28, 16, v93
  v_and_b32 v29, s60, v93
  v_pk_add_f32 v[210:211], v[210:211], v[28:29]
  v_lshlrev_b32 v26, 16, v94
  v_and_b32 v27, s60, v94
  v_pk_add_f32 v[212:213], v[212:213], v[26:27]
  v_lshlrev_b32 v28, 16, v95
  v_and_b32 v29, s60, v95
  v_pk_add_f32 v[214:215], v[214:215], v[28:29]
L_rs_a7:
  s_cmp_eq_u32 s54, 8
  s_cbranch_scc1 L_rs_a8
  v_lshlrev_b32 v26, 16, v96
  v_and_b32 v27, s60, v96
  v_pk_add_f32 v[208:209], v[208:209], v[26:27]
  v_lshlrev_b32 v28, 16, v97
  v_and_b32 v29, s60, v97
  v_pk_add_f32 v[210:211], v[210:211], v[28:29]
  v_lshlrev_b32 v26, 16, v98
  v_and_b32 v27, s60, v98
  v_pk_add_f32 v[212:213], v[212:213], v[26:27]
  v_lshlrev_b32 v28, 16, v99
  v_and_b32 v29, s60, v99
  v_pk_add_f32 v[214:215], v[214:215], v[28:29]
L_rs_a8:
  s_cmp_eq_u32 s54, 9
  s_cbranch_scc1 L_rs_a9
  v_lshlrev_b32 v26, 16, v100
  v_and_b32 v27, s60, v100
  v_pk_add_f32 v[208:209], v[208:209], v[26:27]
  v_lshlrev_b32 v28, 16, v101
  v_and_b32 v29, s60, v101
  v_pk_add_f32 v[210:211], v[210:211], v[28:29]
  v_lshlrev_b32 v26, 16, v102
  v_and_b32 v27, s60, v102
  v_pk_add_f32 v[212:213], v[212:213], v[26:27]
  v_lshlrev_b32 v28, 16, v103
  v_and_b32 v29, s60, v103
  v_pk_add_f32 v[214:215], v[214:215], v[28:29]
L_rs_a9:
  s_cmp_eq_u32 s54, 10
  s_cbranch_scc1 L_rs_a10
  v_lshlrev_b32 v26, 16, v104
  v_and_b32 v27, s60, v104
  v_pk_add_f32 v[208:209], v[208:209], v[26:27]
  v_lshlrev_b32 v28, 16, v105
  v_and_b32 v29, s60, v105
  v_pk_add_f32 v[210:211], v[210:211], v[28:29]
  v_lshlrev_b32 v26, 16, v106
  v_and_b32 v27, s60, v106
  v_pk_add_f32 v[212:213], v[212:213], v[26:27]
  v_lshlrev_b32 v28, 16, v107
  v_and_b32 v29, s60, v107
  v_pk_add_f32 v[214:215], v[214:215], v[28:29]
L_rs_a10:
  s_cmp_eq_u32 s54, 11
  s_cbranch_scc1 L_rs_a11
  v_lshlrev_b32 v26, 16, v108
  v_and_b32 v27, s60, v108
  v_pk_add_f32 v[208:209], v[208:209], v[26:27]
  v_lshlrev_b32 v28, 16, v109
  v_and_b32 v29, s60, v109
  v_pk_add_f32 v[210:211], v[210:211], v[28:29]
  v_lshlrev_b32 v26, 16, v110
  v_and_b32 v27, s60, v110
  v_pk_add_f32 v[212:213], v[212:213], v[26:27]
  v_lshlrev_b32 v28, 16, v111
  v_and_b32 v29, s60, v111
  v_pk_add_f32 v[214:215], v[214:215], v[28:29]
L_rs_a11:
  s_cmp_eq_u32 s54, 12
  s_cbranch_scc1 L_rs_a12
  v_lshlrev_b32 v26, 16, v112
  v_and_b32 v27, s60, v112
  v_pk_add_f32 v[208:209], v[208:209], v[26:27]
  v_lshlrev_b32 v28, 16, v113
  v_and_b32 v29, s60, v113
  v_pk_add_f32 v[210:211], v[210:211], v[28:29]
  v_lshlrev_b32 v26, 16, v114
  v_and_b32 v27, s60, v114
  v_pk_add_f32 v[212:213], v[212:213], v[26:27]
  v_lshlrev_b32 v28, 16, v115
  v_and_b32 v29, s60, v115
  v_pk_add_f32 v[214:215], v[214:215], v[28:29]
L_rs_a12:
  s_cmp_eq_u32 s54, 13
  s_cbranch_scc1 L_rs_a13
  v_lshlrev_b32 v26, 16, v116
  v_and_b32 v27, s60, v116
  v_pk_add_f32 v[208:209], v[208:209], v[26:27]
  v_lshlrev_b32 v28, 16, v117
  v_and_b32 v29, s60, v117
  v_pk_add_f32 v[210:211], v[210:211], v[28:29]
  v_lshlrev_b32 v26, 16, v118
  v_and_b32 v27, s60, v118
  v_pk_add_f32 v[212:213], v[212:213], v[26:27]
  v_lshlrev_b32 v28, 16, v119
  v_and_b32 v29, s60, v119
  v_pk_add_f32 v[214:215], v[214:215], v[28:29]
L_rs_a13:
  s_cmp_eq_u32 s54, 14
  s_cbranch_scc1 L_rs_a14
  v_lshlrev_b32 v26, 16, v120
  v_and_b32 v27, s60, v120
  v_pk_add_f32 v[208:209], v[208:209], v[26:27]
  v_lshlrev_b32 v28, 16, v121
  v_and_b32 v29, s60, v121
  v_pk_add_f32 v[210:211], v[210:211], v[28:29]
  v_lshlrev_b32 v26, 16, v122
  v_and_b32 v27, s60, v122
  v_pk_add_f32 v[212:213], v[212:213], v[26:27]
  v_lshlrev_b32 v28, 16, v123
  v_and_b32 v29, s60, v123
  v_pk_add_f32 v[214:215], v[214:215], v[28:29]
L_rs_a14:
  s_cmp_eq_u32 s54, 15
  s_cbranch_scc1 L_rs_a15
  v_lshlrev_b32 v26, 16, v124
  v_and_b32 v27, s60, v124
  v_pk_add_f32 v[208:209], v[208:209], v[26:27]
  v_lshlrev_b32 v28, 16, v125
  v_and_b32 v29, s60, v125
  v_pk_add_f32 v[210:211], v[210:211], v[28:29]
  v_lshlrev_b32 v26, 16, v126
  v_and_b32 v27, s60, v126
  v_pk_add_f32 v[212:213], v[212:213], v[26:27]
  v_lshlrev_b32 v28, 16, v127
  v_and_b32 v29, s60, v127
  v_pk_add_f32 v[214:215], v[214:215], v[28:29]
L_rs_a15:
  s_waitcnt lgkmcnt(0)
  v_lshlrev_b32 v26, 16, v36
  v_and_b32 v27, s60, v36
  v_pk_add_f32 v[208:209], v[208:209], v[26:27]
  v_lshlrev_b32 v28, 16, v37
  v_and_b32 v29, s60, v37
  v_pk_add_f32 v[210:211], v[210:211], v[28:29]
  v_lshlrev_b32 v26, 16, v38
  v_and_b32 v27, s60, v38
  v_pk_add_f32 v[212:213], v[212:213], v[26:27]
  v_lshlrev_b32 v28, 16, v39
  v_and_b32 v29, s60, v39
  v_pk_add_f32 v[214:215], v[214:215], v[28:29]
  v_cvt_pk_bf16_f32 v64, v208, v209
  v_cvt_pk_bf16_f32 v65, v210, v211
  v_cvt_pk_bf16_f32 v66, v212, v213
  v_cvt_pk_bf16_f32 v67, v214, v215
  s_lshl_b32 s50, s28, 15
  s_add_u32 s37, s50, s32
  buffer_store_dwordx4 v[64:67], v33, s[80:83], s37 offen nt
  s_waitcnt vmcnt(18)
  s_cmp_eq_u32 s54, 0
  s_cbranch_scc1 L_rs_b0
  v_lshlrev_b32 v26, 16, v128
  v_and_b32 v27, s60, v128
  v_pk_add_f32 v[216:217], v[216:217], v[26:27]
  v_lshlrev_b32 v28, 16, v129
  v_and_b32 v29, s60, v129
  v_pk_add_f32 v[218:219], v[218:219], v[28:29]
  v_lshlrev_b32 v26, 16, v130
  v_and_b32 v27, s60, v130
  v_pk_add_f32 v[220:221], v[220:221], v[26:27]
  v_lshlrev_b32 v28, 16, v131
  v_and_b32 v29, s60, v131
  v_pk_add_f32 v[222:223], v[222:223], v[28:29]
L_rs_b0:
  s_waitcnt vmcnt(17)
  s_cmp_eq_u32 s54, 1
  s_cbranch_scc1 L_rs_b1
  v_lshlrev_b32 v26, 16, v132
  v_and_b32 v27, s60, v132
  v_pk_add_f32 v[216:217], v[216:217], v[26:27]
  v_lshlrev_b32 v28, 16, v133
  v_and_b32 v29, s60, v133
  v_pk_add_f32 v[218:219], v[218:219], v[28:29]
  v_lshlrev_b32 v26, 16, v134
  v_and_b32 v27, s60, v134
  v_pk_add_f32 v[220:221], v[220:221], v[26:27]
  v_lshlrev_b32 v28, 16, v135
  v_and_b32 v29, s60, v135
  v_pk_add_f32 v[222:223], v[222:223], v[28:29]
L_rs_b1:
  s_waitcnt vmcnt(16)
  s_cmp_eq_u32 s54, 2
  s_cbranch_scc1 L_rs_b2
  v_lshlrev_b32 v26, 16, v136
  v_and_b32 v27, s60, v136
  v_pk_add_f32 v[216:217], v[216:217], v[26:27]
  v_lshlrev_b32 v28, 16, v137
  v_and_b32 v29, s60, v137
  v_pk_add_f32 v[218:219], v[218:219], v[28:29]
  v_lshlrev_b32 v26, 16, v138
  v_and_b32 v27, s60, v138
  v_pk_add_f32 v[220:221], v[220:221], v[26:27]
  v_lshlrev_b32 v28, 16, v139
  v_and_b32 v29, s60, v139
  v_pk_add_f32 v[222:223], v[222:223], v[28:29]
L_rs_b2:
  s_waitcnt vmcnt(15)
  s_cmp_eq_u32 s54, 3
  s_cbranch_scc1 L_rs_b3
  v_lshlrev_b32 v26, 16, v140
  v_and_b32 v27, s60, v140
  v_pk_add_f32 v[216:217], v[216:217], v[26:27]
  v_lshlrev_b32 v28, 16, v141
  v_and_b32 v29, s60, v141
  v_pk_add_f32 v[218:219], v[218:219], v[28:29]
  v_lshlrev_b32 v26, 16, v142
  v_and_b32 v27, s60, v142
  v_pk_add_f32 v[220:221], v[220:221], v[26:27]
  v_lshlrev_b32 v28, 16, v143
  v_and_b32 v29, s60, v143
  v_pk_add_f32 v[222:223], v[222:223], v[28:29]
L_rs_b3:
  s_waitcnt vmcnt(14)
  s_cmp_eq_u32 s54, 4
  s_cbranch_scc1 L_rs_b4
  v_lshlrev_b32 v26, 16, v144
  v_and_b32 v27, s60, v144
  v_pk_add_f32 v[216:217], v[216:217], v[26:27]
  v_lshlrev_b32 v28, 16, v145
  v_and_b32 v29, s60, v145
  v_pk_add_f32 v[218:219], v[218:219], v[28:29]
  v_lshlrev_b32 v26, 16, v146
  v_and_b32 v27, s60, v146
  v_pk_add_f32 v[220:221], v[220:221], v[26:27]
  v_lshlrev_b32 v28, 16, v147
  v_and_b32 v29, s60, v147
  v_pk_add_f32 v[222:223], v[222:223], v[28:29]
L_rs_b4:
  s_waitcnt vmcnt(13)
  s_cmp_eq_u32 s54, 5
  s_cbranch_scc1 L_rs_b5
  v_lshlrev_b32 v26, 16, v148
  v_and_b32 v27, s60, v148
  v_pk_add_f32 v[216:217], v[216:217], v[26:27]
  v_lshlrev_b32 v28, 16, v149
  v_and_b32 v29, s60, v149
  v_pk_add_f32 v[218:219], v[218:219], v[28:29]
  v_lshlrev_b32 v26, 16, v150
  v_and_b32 v27, s60, v150
  v_pk_add_f32 v[220:221], v[220:221], v[26:27]
  v_lshlrev_b32 v28, 16, v151
  v_and_b32 v29, s60, v151
  v_pk_add_f32 v[222:223], v[222:223], v[28:29]
L_rs_b5:
  s_waitcnt vmcnt(12)
  s_cmp_eq_u32 s54, 6
  s_cbranch_scc1 L_rs_b6
  v_lshlrev_b32 v26, 16, v152
  v_and_b32 v27, s60, v152
  v_pk_add_f32 v[216:217], v[216:217], v[26:27]
  v_lshlrev_b32 v28, 16, v153
  v_and_b32 v29, s60, v153
  v_pk_add_f32 v[218:219], v[218:219], v[28:29]
  v_lshlrev_b32 v26, 16, v154
  v_and_b32 v27, s60, v154
  v_pk_add_f32 v[220:221], v[220:221], v[26:27]
  v_lshlrev_b32 v28, 16, v155
  v_and_b32 v29, s60, v155
  v_pk_add_f32 v[222:223], v[222:223], v[28:29]
L_rs_b6:
  s_waitcnt vmcnt(11)
  s_cmp_eq_u32 s54, 7
  s_cbranch_scc1 L_rs_b7
  v_lshlrev_b32 v26, 16, v156
  v_and_b32 v27, s60, v156
  v_pk_add_f32 v[216:217], v[216:217], v[26:27]
  v_lshlrev_b32 v28, 16, v157
  v_and_b32 v29, s60, v157
  v_pk_add_f32 v[218:219], v[218:219], v[28:29]
  v_lshlrev_b32 v26, 16, v158
  v_and_b32 v27, s60, v158
  v_pk_add_f32 v[220:221], v[220:221], v[26:27]
  v_lshlrev_b32 v28, 16, v159
  v_and_b32 v29, s60, v159
  v_pk_add_f32 v[222:223], v[222:223], v[28:29]
L_rs_b7:
  s_waitcnt vmcnt(10)
  s_cmp_eq_u32 s54, 8
  s_cbranch_scc1 L_rs_b8
  v_lshlrev_b32 v26, 16, v160
  v_and_b32 v27, s60, v160
  v_pk_add_f32 v[216:217], v[216:217], v[26:27]
  v_lshlrev_b32 v28, 16, v161
  v_and_b32 v29, s60, v161
  v_pk_add_f32 v[218:219], v[218:219], v[28:29]
  v_lshlrev_b32 v26, 16, v162
  v_and_b32 v27, s60, v162
  v_pk_add_f32 v[220:221], v[220:221], v[26:27]
  v_lshlrev_b32 v28, 16, v163
  v_and_b32 v29, s60, v163
  v_pk_add_f32 v[222:223], v[222:223], v[28:29]
L_rs_b8:
  s_waitcnt vmcnt(9)
  s_cmp_eq_u32 s54, 9
  s_cbranch_scc1 L_rs_b9
  v_lshlrev_b32 v26, 16, v164
  v_and_b32 v27, s60, v164
  v_pk_add_f32 v[216:217], v[216:217], v[26:27]
  v_lshlrev_b32 v28, 16, v165
  v_and_b32 v29, s60, v165
  v_pk_add_f32 v[218:219], v[218:219], v[28:29]
  v_lshlrev_b32 v26, 16, v166
  v_and_b32 v27, s60, v166
  v_pk_add_f32 v[220:221], v[220:221], v[26:27]
  v_lshlrev_b32 v28, 16, v167
  v_and_b32 v29, s60, v167
  v_pk_add_f32 v[222:223], v[222:223], v[28:29]
L_rs_b9:
  s_waitcnt vmcnt(8)
  s_cmp_eq_u32 s54, 10
  s_cbranch_scc1 L_rs_b10
  v_lshlrev_b32 v26, 16, v168
  v_and_b32 v27, s60, v168
  v_pk_add_f32 v[216:217], v[216:217], v[26:27]
  v_lshlrev_b32 v28, 16, v169
  v_and_b32 v29, s60, v169
  v_pk_add_f32 v[218:219], v[218:219], v[28:29]
  v_lshlrev_b32 v26, 16, v170
  v_and_b32 v27, s60, v170
  v_pk_add_f32 v[220:221], v[220:221], v[26:27]
  v_lshlrev_b32 v28, 16, v171
  v_and_b32 v29, s60, v171
  v_pk_add_f32 v[222:223], v[222:223], v[28:29]
L_rs_b10:
  s_waitcnt vmcnt(7)
  s_cmp_eq_u32 s54, 11
  s_cbranch_scc1 L_rs_b11
  v_lshlrev_b32 v26, 16, v172
  v_and_b32 v27, s60, v172
  v_pk_add_f32 v[216:217], v[216:217], v[26:27]
  v_lshlrev_b32 v28, 16, v173
  v_and_b32 v29, s60, v173
  v_pk_add_f32 v[218:219], v[218:219], v[28:29]
  v_lshlrev_b32 v26, 16, v174
  v_and_b32 v27, s60, v174
  v_pk_add_f32 v[220:221], v[220:221], v[26:27]
  v_lshlrev_b32 v28, 16, v175
  v_and_b32 v29, s60, v175
  v_pk_add_f32 v[222:223], v[222:223], v[28:29]
L_rs_b11:
  s_waitcnt vmcnt(6)
  s_cmp_eq_u32 s54, 12
  s_cbranch_scc1 L_rs_b12
  v_lshlrev_b32 v26, 16, v176
  v_and_b32 v27, s60, v176
  v_pk_add_f32 v[216:217], v[216:217], v[26:27]
  v_lshlrev_b32 v28, 16, v177
  v_and_b32 v29, s60, v177
  v_pk_add_f32 v[218:219], v[218:219], v[28:29]
  v_lshlrev_b32 v26, 16, v178
  v_and_b32 v27, s60, v178
  v_pk_add_f32 v[220:221], v[220:221], v[26:27]
  v_lshlrev_b32 v28, 16, v179
  v_and_b32 v29, s60, v179
  v_pk_add_f32 v[222:223], v[222:223], v[28:29]
L_rs_b12:
  s_waitcnt vmcnt(5)
  s_cmp_eq_u32 s54, 13
  s_cbranch_scc1 L_rs_b13
  v_lshlrev_b32 v26, 16, v180
  v_and_b32 v27, s60, v180
  v_pk_add_f32 v[216:217], v[216:217], v[26:27]
  v_lshlrev_b32 v28, 16, v181
  v_and_b32 v29, s60, v181
  v_pk_add_f32 v[218:219], v[218:219], v[28:29]
  v_lshlrev_b32 v26, 16, v182
  v_and_b32 v27, s60, v182
  v_pk_add_f32 v[220:221], v[220:221], v[26:27]
  v_lshlrev_b32 v28, 16, v183
  v_and_b32 v29, s60, v183
  v_pk_add_f32 v[222:223], v[222:223], v[28:29]
L_rs_b13:
  s_waitcnt vmcnt(4)
  s_cmp_eq_u32 s54, 14
  s_cbranch_scc1 L_rs_b14
  v_lshlrev_b32 v26, 16, v184
  v_and_b32 v27, s60, v184
  v_pk_add_f32 v[216:217], v[216:217], v[26:27]
  v_lshlrev_b32 v28, 16, v185
  v_and_b32 v29, s60, v185
  v_pk_add_f32 v[218:219], v[218:219], v[28:29]
  v_lshlrev_b32 v26, 16, v186
  v_and_b32 v27, s60, v186
  v_pk_add_f32 v[220:221], v[220:221], v[26:27]
  v_lshlrev_b32 v28, 16, v187
  v_and_b32 v29, s60, v187
  v_pk_add_f32 v[222:223], v[222:223], v[28:29]
L_rs_b14:
  s_waitcnt vmcnt(3)
  s_cmp_eq_u32 s54, 15
  s_cbranch_scc1 L_rs_b15
  v_lshlrev_b32 v26, 16, v188
  v_and_b32 v27, s60, v188
  v_pk_add_f32 v[216:217], v[216:217], v[26:27]
  v_lshlrev_b32 v28, 16, v189
  v_and_b32 v29, s60, v189
  v_pk_add_f32 v[218:219], v[218:219], v[28:29]
  v_lshlrev_b32 v26, 16, v190
  v_and_b32 v27, s60, v190
  v_pk_add_f32 v[220:221], v[220:221], v[26:27]
  v_lshlrev_b32 v28, 16, v191
  v_and_b32 v29, s60, v191
  v_pk_add_f32 v[222:223], v[222:223], v[28:29]
L_rs_b15:
  v_lshlrev_b32 v26, 16, v40
  v_and_b32 v27, s60, v40
  v_pk_add_f32 v[216:217], v[216:217], v[26:27]
  v_lshlrev_b32 v28, 16, v41
  v_and_b32 v29, s60, v41
  v_pk_add_f32 v[218:219], v[218:219], v[28:29]
  v_lshlrev_b32 v26, 16, v42
  v_and_b32 v27, s60, v42
  v_pk_add_f32 v[220:221], v[220:221], v[26:27]
  v_lshlrev_b32 v28, 16, v43
  v_and_b32 v29, s60, v43
  v_pk_add_f32 v[222:223], v[222:223], v[28:29]
  v_cvt_pk_bf16_f32 v68, v216, v217
  v_cvt_pk_bf16_f32 v69, v218, v219
  v_cvt_pk_bf16_f32 v70, v220, v221
  v_cvt_pk_bf16_f32 v71, v222, v223
  s_add_u32 s37, s37, 131072
  s_waitcnt vmcnt(1)
  s_add_u32 s50, s41, 0
  s_cmp_eq_u32 s54, s50
  s_cbranch_scc1 L_rs_c0
  v_lshlrev_b32 v26, 16, v192
  v_and_b32 v27, s60, v192
  v_pk_add_f32 v[224:225], v[224:225], v[26:27]
  v_lshlrev_b32 v28, 16, v193
  v_and_b32 v29, s60, v193
  v_pk_add_f32 v[226:227], v[226:227], v[28:29]
  v_lshlrev_b32 v26, 16, v194
  v_and_b32 v27, s60, v194
  v_pk_add_f32 v[228:229], v[228:229], v[26:27]
  v_lshlrev_b32 v28, 16, v195
  v_and_b32 v29, s60, v195
  v_pk_add_f32 v[230:231], v[230:231], v[28:29]
L_rs_c0:
  s_add_u32 s50, s41, 1
  s_cmp_eq_u32 s54, s50
  s_cbranch_scc1 L_rs_c1
  v_lshlrev_b32 v26, 16, v196
  v_and_b32 v27, s60, v196
  v_pk_add_f32 v[224:225], v[224:225], v[26:27]
  v_lshlrev_b32 v28, 16, v197
  v_and_b32 v29, s60, v197
  v_pk_add_f32 v[226:227], v[226:227], v[28:29]
  v_lshlrev_b32 v26, 16, v198
  v_and_b32 v27, s60, v198
  v_pk_add_f32 v[228:229], v[228:229], v[26:27]
  v_lshlrev_b32 v28, 16, v199
  v_and_b32 v29, s60, v199
  v_pk_add_f32 v[230:231], v[230:231], v[28:29]
L_rs_c1:
  s_add_u32 s50, s41, 2
  s_cmp_eq_u32 s54, s50
  s_cbranch_scc1 L_rs_c2
  v_lshlrev_b32 v26, 16, v200
  v_and_b32 v27, s60, v200
  v_pk_add_f32 v[224:225], v[224:225], v[26:27]
  v_lshlrev_b32 v28, 16, v201
  v_and_b32 v29, s60, v201
  v_pk_add_f32 v[226:227], v[226:227], v[28:29]
  v_lshlrev_b32 v26, 16, v202
  v_and_b32 v27, s60, v202
  v_pk_add_f32 v[228:229], v[228:229], v[26:27]
  v_lshlrev_b32 v28, 16, v203
  v_and_b32 v29, s60, v203
  v_pk_add_f32 v[230:231], v[230:231], v[28:29]
L_rs_c2:
  s_add_u32 s50, s41, 3
  s_cmp_eq_u32 s54, s50
  s_cbranch_scc1 L_rs_c3
  v_lshlrev_b32 v26, 16, v204
  v_and_b32 v27, s60, v204
  v_pk_add_f32 v[224:225], v[224:225], v[26:27]
  v_lshlrev_b32 v28, 16, v205
  v_and_b32 v29, s60, v205
  v_pk_add_f32 v[226:227], v[226:227], v[28:29]
  v_lshlrev_b32 v26, 16, v206
  v_and_b32 v27, s60, v206
  v_pk_add_f32 v[228:229], v[228:229], v[26:27]
  v_lshlrev_b32 v28, 16, v207
  v_and_b32 v29, s60, v207
  v_pk_add_f32 v[230:231], v[230:231], v[28:29]
L_rs_c3:
  buffer_store_dwordx4 v[68:71], v33, s[80:83], s37 offen nt
  s_lshl_b32 s50, s28, 11
  v_lshlrev_b32 v30, 5, v1
  v_add_u32 v30, 98304, v30
  v_add_u32 v31, s50, v30
  ds_write_b128 v31, v[224:227]
  ds_write_b128 v31, v[228:231] offset:16
  s_waitcnt lgkmcnt(0)
  s_barrier
  s_cmp_eq_u32 s28, 0
  s_cbranch_scc0 L_red_end
  ds_read_b128 v[80:83], v30 offset:0
  ds_read_b128 v[84:87], v30 offset:16
  ds_read_b128 v[88:91], v30 offset:2048
  ds_read_b128 v[92:95], v30 offset:2064
  ds_read_b128 v[96:99], v30 offset:4096
  ds_read_b128 v[100:103], v30 offset:4112
  ds_read_b128 v[104:107], v30 offset:6144
  ds_read_b128 v[108:111], v30 offset:6160
  ds_read_b128 v[36:39], v44 offset:8192
  s_waitcnt lgkmcnt(0)
  v_pk_add_f32 v[80:81], v[80:81], v[88:89]
  v_pk_add_f32 v[82:83], v[82:83], v[90:91]
  v_pk_add_f32 v[84:85], v[84:85], v[92:93]
  v_pk_add_f32 v[86:87], v[86:87], v[94:95]
  v_pk_add_f32 v[80:81], v[80:81], v[96:97]
  v_pk_add_f32 v[82:83], v[82:83], v[98:99]
  v_pk_add_f32 v[84:85], v[84:85], v[100:101]
  v_pk_add_f32 v[86:87], v[86:87], v[102:103]
  v_pk_add_f32 v[80:81], v[80:81], v[104:105]
  v_pk_add_f32 v[82:83], v[82:83], v[106:107]
  v_pk_add_f32 v[84:85], v[84:85], v[108:109]
  v_pk_add_f32 v[86:87], v[86:87], v[110:111]
  v_lshlrev_b32 v26, 16, v36
  v_and_b32 v27, s60, v36
  v_pk_add_f32 v[80:81], v[80:81], v[26:27]
  v_lshlrev_b32 v28, 16, v37
  v_and_b32 v29, s60, v37
  v_pk_add_f32 v[82:83], v[82:83], v[28:29]
  v_lshlrev_b32 v26, 16, v38
  v_and_b32 v27, s60, v38
  v_pk_add_f32 v[84:85], v[84:85], v[26:27]
  v_lshlrev_b32 v28, 16, v39
  v_and_b32 v29, s60, v39
  v_pk_add_f32 v[86:87], v[86:87], v[28:29]
  v_cvt_pk_bf16_f32 v72, v80, v81
  v_cvt_pk_bf16_f32 v73, v82, v83
  v_cvt_pk_bf16_f32 v74, v84, v85
  v_cvt_pk_bf16_f32 v75, v86, v87
  s_add_u32 s50, s32, 262144
  buffer_store_dwordx4 v[72:75], v33, s[80:83], s50 offen nt
L_red_end:
L_main_end:
  s_endpgm
L_safe_max:
  v_mov_b32 v2, 0xff800000
  v_mov_b32 v3, 0xff800000
  v_mov_b32 v4, 0xff800000
  v_mov_b32 v5, 0xff800000
  v_mov_b32 v6, 0xff800000
  s_mov_b32 s31, 0
L_safe_loop:
  s_waitcnt vmcnt(0) lgkmcnt(0)
  s_barrier
  s_and_b32 s50, s31, 15
  s_lshl_b32 s50, s50, 13
  s_add_u32 s51, s50, s43
  s_add_u32 m0, s47, 16384
  s_nop 0
  buffer_load_dwordx4 v16, s[12:15], s51 offen nt lds
  buffer_load_dwordx4 v17, s[12:15], s51 offen offset:1024 nt lds
  buffer_load_dwordx4 v18, s[12:15], s51 offen offset:2048 nt lds
  buffer_load_dwordx4 v19, s[12:15], s51 offen offset:3072 nt lds
  s_waitcnt vmcnt(0)
  s_barrier
  ds_read_b128 a[216:219], v22 offset:16384
  ds_read_b128 a[220:223], v23 offset:16384
  ds_read_b128 a[224:227], v24 offset:16384
  ds_read_b128 a[228:231], v25 offset:16384
  ds_read_b128 a[232:235], v22 offset:20480
  ds_read_b128 a[236:239], v23 offset:20480
  ds_read_b128 a[240:243], v24 offset:20480
  ds_read_b128 a[244:247], v25 offset:20480
  s_waitcnt lgkmcnt(0)
  s_cmp_eq_u32 s31, 16
  s_cbranch_scc1 L_safe_last
  v_mfma_f32_16x16x32_bf16 v[68:71], a[216:219], v[64:67], 0
  v_mfma_f32_16x16x32_bf16 v[100:103], a[216:219], v[96:99], 0
  v_mfma_f32_16x16x32_bf16 v[132:135], a[216:219], v[128:131], 0
  v_mfma_f32_16x16x32_bf16 v[164:167], a[216:219], v[160:163], 0
  v_mfma_f32_16x16x32_bf16 v[196:199], a[216:219], v[192:195], 0
  v_mfma_f32_16x16x32_bf16 v[68:71], a[220:223], v[72:75], v[68:71]
  v_mfma_f32_16x16x32_bf16 v[100:103], a[220:223], v[104:107], v[100:103]
  v_mfma_f32_16x16x32_bf16 v[132:135], a[220:223], v[136:139], v[132:135]
  v_mfma_f32_16x16x32_bf16 v[164:167], a[220:223], v[168:171], v[164:167]
  v_mfma_f32_16x16x32_bf16 v[196:199], a[220:223], v[200:203], v[196:199]
  v_mfma_f32_16x16x32_bf16 v[68:71], a[224:227], v[80:83], v[68:71]
  v_mfma_f32_16x16x32_bf16 v[100:103], a[224:227], v[112:115], v[100:103]
  v_mfma_f32_16x16x32_bf16 v[132:135], a[224:227], v[144:147], v[132:135]
  v_mfma_f32_16x16x32_bf16 v[164:167], a[224:227], v[176:179], v[164:167]
  v_mfma_f32_16x16x32_bf16 v[196:199], a[224:227], v[208:211], v[196:199]
  v_mfma_f32_16x16x32_bf16 v[68:71], a[228:231], v[88:91], v[68:71]
  v_mfma_f32_16x16x32_bf16 v[100:103], a[228:231], v[120:123], v[100:103]
  v_mfma_f32_16x16x32_bf16 v[132:135], a[228:231], v[152:155], v[132:135]
  v_mfma_f32_16x16x32_bf16 v[164:167], a[228:231], v[184:187], v[164:167]
  v_mfma_f32_16x16x32_bf16 v[196:199], a[228:231], v[216:219], v[196:199]
  v_mfma_f32_16x16x32_bf16 v[76:79], a[232:235], v[64:67], 0
  v_mfma_f32_16x16x32_bf16 v[108:111], a[232:235], v[96:99], 0
  v_mfma_f32_16x16x32_bf16 v[140:143], a[232:235], v[128:131], 0
  v_mfma_f32_16x16x32_bf16 v[172:175], a[232:235], v[160:163], 0
  v_mfma_f32_16x16x32_bf16 v[204:207], a[232:235], v[192:195], 0
  v_mfma_f32_16x16x32_bf16 v[76:79], a[236:239], v[72:75], v[76:79]
  v_mfma_f32_16x16x32_bf16 v[108:111], a[236:239], v[104:107], v[108:111]
  v_mfma_f32_16x16x32_bf16 v[140:143], a[236:239], v[136:139], v[140:143]
  v_mfma_f32_16x16x32_bf16 v[172:175], a[236:239], v[168:171], v[172:175]
  v_mfma_f32_16x16x32_bf16 v[204:207], a[236:239], v[200:203], v[204:207]
  v_mfma_f32_16x16x32_bf16 v[76:79], a[240:243], v[80:83], v[76:79]
  v_mfma_f32_16x16x32_bf16 v[108:111], a[240:243], v[112:115], v[108:111]
  v_mfma_f32_16x16x32_bf16 v[140:143], a[240:243], v[144:147], v[140:143]
  v_mfma_f32_16x16x32_bf16 v[172:175], a[240:243], v[176:179], v[172:175]
  v_mfma_f32_16x16x32_bf16 v[204:207], a[240:243], v[208:211], v[204:207]
  v_mfma_f32_16x16x32_bf16 v[76:79], a[244:247], v[88:91], v[76:79]
  v_mfma_f32_16x16x32_bf16 v[108:111], a[244:247], v[120:123], v[108:111]
  v_mfma_f32_16x16x32_bf16 v[140:143], a[244:247], v[152:155], v[140:143]
  v_mfma_f32_16x16x32_bf16 v[172:175], a[244:247], v[184:187], v[172:175]
  v_mfma_f32_16x16x32_bf16 v[204:207], a[244:247], v[216:219], v[204:207]
  s_nop 7
  s_nop 7
  v_max3_f32 v2, v2, v68, v69
  v_max3_f32 v2, v2, v70, v71
  v_max3_f32 v2, v2, v76, v77
  v_max3_f32 v2, v2, v78, v79
  v_max3_f32 v3, v3, v100, v101
  v_max3_f32 v3, v3, v102, v103
  v_max3_f32 v3, v3, v108, v109
  v_max3_f32 v3, v3, v110, v111
  v_max3_f32 v4, v4, v132, v133
  v_max3_f32 v4, v4, v134, v135
  v_max3_f32 v4, v4, v140, v141
  v_max3_f32 v4, v4, v142, v143
  v_max3_f32 v5, v5, v164, v165
  v_max3_f32 v5, v5, v166, v167
  v_max3_f32 v5, v5, v172, v173
  v_max3_f32 v5, v5, v174, v175
  v_max3_f32 v6, v6, v196, v197
  v_max3_f32 v6, v6, v198, v199
  v_max3_f32 v6, v6, v204, v205
  v_max3_f32 v6, v6, v206, v207
  s_add_u32 s31, s31, 1
  s_cmp_lt_u32 s31, 16
  s_cbranch_scc1 L_safe_loop
  s_nop 3
  v_mov_b32 v7, v2
  v_mov_b32 v8, v3
  v_mov_b32 v9, v4
  v_mov_b32 v10, v5
  v_mov_b32 v11, v6
  v_permlane32_swap_b32 v2, v7
  v_permlane32_swap_b32 v3, v8
  v_permlane32_swap_b32 v4, v9
  v_permlane32_swap_b32 v5, v10
  v_permlane32_swap_b32 v6, v11
  v_max_f32 v2, v2, v7
  v_max_f32 v3, v3, v8
  v_max_f32 v4, v4, v9
  v_max_f32 v5, v5, v10
  v_max_f32 v6, v6, v11
  v_mov_b32 v7, v2
  v_mov_b32 v8, v3
  v_mov_b32 v9, v4
  v_mov_b32 v10, v5
  v_mov_b32 v11, v6
  v_permlane16_swap_b32 v2, v7
  v_permlane16_swap_b32 v3, v8
  v_permlane16_swap_b32 v4, v9
  v_permlane16_swap_b32 v5, v10
  v_permlane16_swap_b32 v6, v11
  v_max_f32 v2, v2, v7
  v_max_f32 v3, v3, v8
  v_max_f32 v4, v4, v9
  v_max_f32 v5, v5, v10
  v_max_f32 v6, v6, v11
  v_sub_f32 v224, 0, v2
  v_sub_f32 v225, 0, v2
  v_sub_f32 v226, 0, v2
  v_sub_f32 v227, 0, v2
  v_sub_f32 v228, 0, v3
  v_sub_f32 v229, 0, v3
  v_sub_f32 v230, 0, v3
  v_sub_f32 v231, 0, v3
  v_sub_f32 v232, 0, v4
  v_sub_f32 v233, 0, v4
  v_sub_f32 v234, 0, v4
  v_sub_f32 v235, 0, v4
  v_sub_f32 v236, 0, v5
  v_sub_f32 v237, 0, v5
  v_sub_f32 v238, 0, v5
  v_sub_f32 v239, 0, v5
  v_sub_f32 v240, 0, v6
  v_sub_f32 v241, 0, v6
  v_sub_f32 v242, 0, v6
  v_sub_f32 v243, 0, v6
  s_branch L_safe_loop
L_safe_last:
  s_nop 3
  v_mfma_f32_16x16x32_bf16 v[68:71], a[216:219], v[64:67], v[224:227]
  v_mfma_f32_16x16x32_bf16 v[100:103], a[216:219], v[96:99], v[228:231]
  v_mfma_f32_16x16x32_bf16 v[132:135], a[216:219], v[128:131], v[232:235]
  v_mfma_f32_16x16x32_bf16 v[164:167], a[216:219], v[160:163], v[236:239]
  v_mfma_f32_16x16x32_bf16 v[196:199], a[216:219], v[192:195], v[240:243]
  v_mfma_f32_16x16x32_bf16 v[68:71], a[220:223], v[72:75], v[68:71]
  v_mfma_f32_16x16x32_bf16 v[100:103], a[220:223], v[104:107], v[100:103]
  v_mfma_f32_16x16x32_bf16 v[132:135], a[220:223], v[136:139], v[132:135]
  v_mfma_f32_16x16x32_bf16 v[164:167], a[220:223], v[168:171], v[164:167]
  v_mfma_f32_16x16x32_bf16 v[196:199], a[220:223], v[200:203], v[196:199]
  v_mfma_f32_16x16x32_bf16 v[68:71], a[224:227], v[80:83], v[68:71]
  v_mfma_f32_16x16x32_bf16 v[100:103], a[224:227], v[112:115], v[100:103]
  v_mfma_f32_16x16x32_bf16 v[132:135], a[224:227], v[144:147], v[132:135]
  v_mfma_f32_16x16x32_bf16 v[164:167], a[224:227], v[176:179], v[164:167]
  v_mfma_f32_16x16x32_bf16 v[196:199], a[224:227], v[208:211], v[196:199]
  v_mfma_f32_16x16x32_bf16 v[68:71], a[228:231], v[88:91], v[68:71]
  v_mfma_f32_16x16x32_bf16 v[100:103], a[228:231], v[120:123], v[100:103]
  v_mfma_f32_16x16x32_bf16 v[132:135], a[228:231], v[152:155], v[132:135]
  v_mfma_f32_16x16x32_bf16 v[164:167], a[228:231], v[184:187], v[164:167]
  v_mfma_f32_16x16x32_bf16 v[196:199], a[228:231], v[216:219], v[196:199]
  v_mfma_f32_16x16x32_bf16 v[76:79], a[232:235], v[64:67], v[224:227]
  v_mfma_f32_16x16x32_bf16 v[108:111], a[232:235], v[96:99], v[228:231]
  v_mfma_f32_16x16x32_bf16 v[140:143], a[232:235], v[128:131], v[232:235]
  v_mfma_f32_16x16x32_bf16 v[172:175], a[232:235], v[160:163], v[236:239]
  v_mfma_f32_16x16x32_bf16 v[204:207], a[232:235], v[192:195], v[240:243]
  v_mfma_f32_16x16x32_bf16 v[76:79], a[236:239], v[72:75], v[76:79]
  v_mfma_f32_16x16x32_bf16 v[108:111], a[236:239], v[104:107], v[108:111]
  v_mfma_f32_16x16x32_bf16 v[140:143], a[236:239], v[136:139], v[140:143]
  v_mfma_f32_16x16x32_bf16 v[172:175], a[236:239], v[168:171], v[172:175]
  v_mfma_f32_16x16x32_bf16 v[204:207], a[236:239], v[200:203], v[204:207]
  v_mfma_f32_16x16x32_bf16 v[76:79], a[240:243], v[80:83], v[76:79]
  v_mfma_f32_16x16x32_bf16 v[108:111], a[240:243], v[112:115], v[108:111]
  v_mfma_f32_16x16x32_bf16 v[140:143], a[240:243], v[144:147], v[140:143]
  v_mfma_f32_16x16x32_bf16 v[172:175], a[240:243], v[176:179], v[172:175]
  v_mfma_f32_16x16x32_bf16 v[204:207], a[240:243], v[208:211], v[204:207]
  v_mfma_f32_16x16x32_bf16 v[76:79], a[244:247], v[88:91], v[76:79]
  v_mfma_f32_16x16x32_bf16 v[108:111], a[244:247], v[120:123], v[108:111]
  v_mfma_f32_16x16x32_bf16 v[140:143], a[244:247], v[152:155], v[140:143]
  v_mfma_f32_16x16x32_bf16 v[172:175], a[244:247], v[184:187], v[172:175]
  v_mfma_f32_16x16x32_bf16 v[204:207], a[244:247], v[216:219], v[204:207]
  s_nop 7
  s_nop 7
  s_barrier
  v_exp_f32 v68, v68
  v_exp_f32 v69, v69
  v_exp_f32 v70, v70
  v_exp_f32 v71, v71
  v_exp_f32 v76, v76
  v_exp_f32 v77, v77
  v_exp_f32 v78, v78
  v_exp_f32 v79, v79
  v_exp_f32 v100, v100
  v_exp_f32 v101, v101
  v_exp_f32 v102, v102
  v_exp_f32 v103, v103
  v_exp_f32 v108, v108
  v_exp_f32 v109, v109
  v_exp_f32 v110, v110
  v_exp_f32 v111, v111
  v_exp_f32 v132, v132
  v_exp_f32 v133, v133
  v_exp_f32 v134, v134
  v_exp_f32 v135, v135
  v_exp_f32 v140, v140
  v_exp_f32 v141, v141
  v_exp_f32 v142, v142
  v_exp_f32 v143, v143
  v_exp_f32 v164, v164
  v_exp_f32 v165, v165
  v_exp_f32 v166, v166
  v_exp_f32 v167, v167
  v_exp_f32 v172, v172
  v_exp_f32 v173, v173
  v_exp_f32 v174, v174
  v_exp_f32 v175, v175
  v_exp_f32 v196, v196
  v_exp_f32 v197, v197
  v_exp_f32 v198, v198
  v_exp_f32 v199, v199
  v_exp_f32 v204, v204
  v_exp_f32 v205, v205
  v_exp_f32 v206, v206
  v_exp_f32 v207, v207
  s_nop 1
  s_branch L_max_done
L_cnt_spin:
  s_mov_b32 s53, 262144
L_cnt_spin_loop:
  s_sleep 2
  buffer_load_dword v15, v14, s[72:75], 0 offen sc1
  s_waitcnt vmcnt(0)
  v_readfirstlane_b32 s52, v15
  s_nop 3
  s_cmp_ge_u32 s52, 16
  s_cbranch_scc1 L_cnt_ok
  s_sub_u32 s53, s53, 1
  s_cmp_lg_u32 s53, 0
  s_cbranch_scc1 L_cnt_spin_loop
  s_branch L_cnt_ok
L_restart:
  s_mov_b32 s61, 1
  s_waitcnt vmcnt(0) lgkmcnt(0)
  s_barrier
  v_lshrrev_b32 v46, 4, v1
  v_bfe_u32 v47, v1, 2, 2
  v_and_b32 v48, 3, v1
  v_and_b32 v49, 15, v1
  v_lshrrev_b32 v50, 5, v1
  v_bfe_u32 v51, v1, 4, 1
  v_lshlrev_b32 v7, 2, v50
  v_xor_b32 v7, v7, v49
  v_lshlrev_b32 v7, 4, v7
  v_lshl_add_u32 v7, v51, 8, v7
  v_lshl_add_u32 v7, v50, 13, v7
  v_xor_b32 v8, 0x80, v7
  v_add_u32 v8, 15360, v8
  v_add_u32 v9, 30720, v7
  v_add_u32 v10, 30720, v8
  v_lshlrev_b32 v50, 1, v46
  v_mov_b32 v51, 0x78
  v_lshrrev_b32 v50, v50, v51
  v_and_b32 v50, 3, v50
  v_xor_b32 v50, v50, v48
  v_lshlrev_b32 v50, 4, v50
  v_lshrrev_b32 v51, 2, v1
  v_lshl_add_u32 v50, v51, 10, v50
  v_add_u32 v11, 0, v50
  v_add_u32 v12, 15360, v50
  s_lshl_b32 s50, s28, 1
  s_lshr_b32 s50, 0x78, s50
  s_and_b32 s50, s50, 3
  v_xor_b32 v50, s50, v48
  v_lshlrev_b32 v50, 4, v50
  v_lshl_add_u32 v50, v51, 10, v50
  s_lshl_b32 s50, s28, 12
  s_lshl_b32 s51, s28, 15
  s_sub_u32 s50, s50, s51
  s_add_u32 s50, s50, 131072
  v_add_u32 v13, s50, v50
  s_branch L_phase_q
.section .rodata,"a"
.p2align 6
.amdhsa_kernel concat_heads__gqa_block_cached__mha_block_cached__near_ridge_kernel
  .amdhsa_next_free_vgpr 512
  .amdhsa_next_free_sgpr 102
  .amdhsa_accum_offset 256
  .amdhsa_group_segment_fixed_size 0
  .amdhsa_kernarg_size 104
  .amdhsa_user_sgpr_count 2
  .amdhsa_user_sgpr_kernarg_segment_ptr 1
  .amdhsa_system_sgpr_workgroup_id_x 1
.end_amdhsa_kernel
```
